```python
import torch

def _softmax(x, axis=-1):
    return torch.softmax(x, dim=axis)
def _gelu(x):
    return torch.nn.functional.gelu(x, approximate="tanh")
def _silu(x):
    return torch.nn.functional.silu(x)
def _sigmoid(x):
    return torch.sigmoid(x)
def _layernorm(x, axis=-1, eps=1e-5):
    m = x.mean(dim=axis, keepdim=True)
    v = x.var(dim=axis, keepdim=True, unbiased=False)
    return (x - m) / torch.sqrt(v + eps)
def _scatter_add(tgt, idx, src, axis=0):
    return tgt.clone().index_add_(axis, idx, src)
def _segment_sum(src, seg, n):
    out = torch.zeros((n,) + src.shape[1:], dtype=src.dtype)
    return out.index_add_(0, seg, src)
def _pad(x, pw):
    flat = tuple(v for pair in reversed(pw) for v in pair)
    return torch.nn.functional.pad(x, flat)

kernel_name = 'standalone__gqa_block_cached__near_ridge'

def setup_inputs():

    _w = (lambda a: (lambda t: t.to(torch.bfloat16) if t.is_floating_point() else t)(torch.as_tensor(a)))
    B, Sq, D = 8, 96, 448
    Hq, Hkv, Sk, Dh = 16, 8, 1024, 256
    assert Hq % Hkv == 0, (Hq, Hkv)
    return {
        "x": _w((lambda *s: torch.randn(*s, dtype=torch.bfloat16) * 0.8)(B, Sq, D)),
        "k_cache": _w((lambda *s: torch.randn(*s, dtype=torch.bfloat16) * 0.8)(B, Hkv, Sk, Dh)),
        "v_cache": _w((lambda *s: torch.randn(*s, dtype=torch.bfloat16) * 0.05)(B, Hkv, Sk, Dh)),
        "wq": _w((lambda *s: torch.randn(*s, dtype=torch.bfloat16) * 0.8)(D, Hq * Dh) * (D ** -0.5)),
        "wo": _w((lambda *s: torch.randn(*s, dtype=torch.bfloat16) * 0.05)(Hq * Dh, D) * ((Hq * Dh) ** -0.5)),
    }

def reference(x, k_cache, v_cache, wq, wo):
    B, Sq, D = x.shape
    Hq, Dh = 16, 256
    Hkv = k_cache.shape[1]
    rep = Hq // Hkv
    q = (lambda x, *d: x.permute(*d))((x @ wq).reshape(B, Sq, Hq, Dh), 0, 2, 1, 3)
    k = (lambda x, n, axis: torch.repeat_interleave(x, n, dim=axis))(k_cache, rep, axis=1)
    v = (lambda x, n, axis: torch.repeat_interleave(x, n, dim=axis))(v_cache, rep, axis=1)
    scores = torch.einsum("bhqd,bhkd->bhqk", q, k) * (Dh ** -0.5)
    p = _softmax(scores, axis=-1)
    o = torch.einsum("bhqk,bhkd->bhqd", p, v)
    return (lambda x, *d: x.permute(*d))(o, 0, 2, 1, 3).reshape(B, Sq, Hq * Dh) @ wo
```

```asm
; @launch grid=(256,1,1) block=(256,1,1) lds=163840
.amdgcn_target "amdgcn-amd-amdhsa--gfx950"
.text
.globl standalone__gqa_block_cached__near_ridge_kernel
.p2align 8
.type standalone__gqa_block_cached__near_ridge_kernel,@function
standalone__gqa_block_cached__near_ridge_kernel:
    s_cmp_ge_u32 s2, 256
    s_cbranch_scc1 M_end
    s_load_dwordx16 s[4:19], s[0:1], 0
    s_getpc_b64 s[60:61]
    s_and_b32 s60, s60, 0xffffff00
    s_mov_b32 s62, CODE_END-standalone__gqa_block_cached__near_ridge_kernel
    s_mov_b32 s63, 0x20000
    v_lshrrev_b32 v1, 6, v0
    v_and_b32 v2, 63, v0
    v_readfirstlane_b32 s45, v1
    s_lshr_b32 s46, s2, 3
    s_lshl_b32 s47, s46, 2
    s_add_u32 s47, s47, s45
    s_lshl_b32 s47, s47, 9
    v_lshlrev_b32 v3, 7, v2
    s_mov_b64 exec, 15
    buffer_load_dword v63, v3, s[60:63], s47 offen
    s_mov_b64 exec, -1
    s_and_b32 s40, s2, 7
    s_lshr_b32 s41, s46, 2
    s_bfe_u32 s42, s46, 0x10001
    s_and_b32 s43, s46, 1
    s_lshl_b32 s44, s40, 1
    s_add_u32 s44, s44, s43
    s_cmp_lg_u32 s45, 0
    s_cbranch_scc1 M_compute
    v_lshrrev_b32 v5, 3, v2
    v_mul_u32_u24 v5, 896, v5
    v_and_b32 v6, 7, v2
    v_lshrrev_b32 v7, 4, v2
    v_xor_b32 v32, v6, v7
    v_lshl_add_u32 v8, v32, 4, v5
    v_xor_b32 v9, 64, v8
    v_add_u32 v10, 12288, v8
    v_add_u32 v11, 18432, v9
    v_add_u32 v9, 6144, v9
    v_lshrrev_b32 v33, 5, v2
    v_and_b32 v34, 31, v2
    v_lshlrev_b32 v35, 2, v33
    v_xor_b32 v35, v34, v35
    v_lshlrev_b32 v35, 4, v35
    v_lshl_add_u32 v12, v33, 13, v35
    v_xor_b32 v13, 128, v12
    v_add_u32 v14, 30720, v12
    v_add_u32 v15, 46080, v13
    v_add_u32 v13, 15360, v13
    v_xor_b32 v64, 32, v12
    v_xor_b32 v65, 32, v13
    v_xor_b32 v66, 32, v14
    v_xor_b32 v67, 32, v15
    s_and_b32 s48, s46, 3
    s_lshl_b32 s48, s48, 1
    s_add_u32 s48, s48, s41
    s_cmp_ge_u32 s48, 7
    s_cselect_b32 s49, 7, 0
    s_sub_u32 s48, s48, s49
    s_lshl_b32 s50, s48, 7
    s_lshl_b32 s51, s48, 19
    s_mul_i32 s52, s41, 86016
    s_lshl_b32 s53, s44, 9
    s_lshl_b32 s49, s42, 18
    s_add_u32 s53, s53, s49
    s_xor_b32 s54, s53, 0x40000
    s_waitcnt lgkmcnt(0)
    s_mov_b32 s20, s4
    s_mov_b32 s21, s5
    s_mov_b32 s22, 688128
    s_mov_b32 s23, 0x20000
    s_mov_b32 s24, s10
    s_mov_b32 s25, s11
    s_mov_b32 s26, 3670016
    s_mov_b32 s27, 0x20000
    s_mov_b32 m0, 0
    s_add_u32 s58, s52, s50
    buffer_load_dwordx4 v8, s[20:23], s58 offen offset:0 lds
    buffer_load_dwordx4 v9, s[20:23], s58 offen offset:1024 lds
    buffer_load_dwordx4 v10, s[20:23], s58 offen offset:2048 lds
    buffer_load_dwordx4 v11, s[20:23], s58 offen offset:3072 lds
    s_mov_b32 m0, 4096
    s_add_u32 s58, s58, 28672
    buffer_load_dwordx4 v8, s[20:23], s58 offen offset:0 lds
    buffer_load_dwordx4 v9, s[20:23], s58 offen offset:1024 lds
    buffer_load_dwordx4 v10, s[20:23], s58 offen offset:2048 lds
    buffer_load_dwordx4 v11, s[20:23], s58 offen offset:3072 lds
    s_mov_b32 m0, 8192
    s_add_u32 s58, s58, 28672
    buffer_load_dwordx4 v8, s[20:23], s58 offen offset:0 lds
    buffer_load_dwordx4 v9, s[20:23], s58 offen offset:1024 lds
    buffer_load_dwordx4 v10, s[20:23], s58 offen offset:2048 lds
    buffer_load_dwordx4 v11, s[20:23], s58 offen offset:3072 lds
    s_add_u32 s50, s50, 128
    s_cmp_eq_u32 s50, 896
    s_cselect_b32 s50, 0, s50
    s_mov_b32 m0, 16384
    s_add_u32 s58, s53, s51
    buffer_load_dwordx4 v12, s[24:27], s58 offen offset:0 lds
    buffer_load_dwordx4 v13, s[24:27], s58 offen offset:1024 lds
    buffer_load_dwordx4 v14, s[24:27], s58 offen offset:2048 lds
    buffer_load_dwordx4 v15, s[24:27], s58 offen offset:3072 lds
    s_mov_b32 m0, 20480
    s_add_u32 s58, s58, 65536
    buffer_load_dwordx4 v64, s[24:27], s58 offen offset:0 lds
    buffer_load_dwordx4 v65, s[24:27], s58 offen offset:1024 lds
    buffer_load_dwordx4 v66, s[24:27], s58 offen offset:2048 lds
    buffer_load_dwordx4 v67, s[24:27], s58 offen offset:3072 lds
    s_mov_b32 m0, 24576
    s_add_u32 s58, s58, 65536
    buffer_load_dwordx4 v12, s[24:27], s58 offen offset:0 lds
    buffer_load_dwordx4 v13, s[24:27], s58 offen offset:1024 lds
    buffer_load_dwordx4 v14, s[24:27], s58 offen offset:2048 lds
    buffer_load_dwordx4 v15, s[24:27], s58 offen offset:3072 lds
    s_mov_b32 m0, 28672
    s_add_u32 s58, s58, 65536
    buffer_load_dwordx4 v64, s[24:27], s58 offen offset:0 lds
    buffer_load_dwordx4 v65, s[24:27], s58 offen offset:1024 lds
    buffer_load_dwordx4 v66, s[24:27], s58 offen offset:2048 lds
    buffer_load_dwordx4 v67, s[24:27], s58 offen offset:3072 lds
    s_mov_b32 m0, 32768
    s_add_u32 s58, s54, s51
    buffer_load_dwordx4 v12, s[24:27], s58 offen offset:0 lds
    buffer_load_dwordx4 v13, s[24:27], s58 offen offset:1024 lds
    buffer_load_dwordx4 v14, s[24:27], s58 offen offset:2048 lds
    buffer_load_dwordx4 v15, s[24:27], s58 offen offset:3072 lds
    s_mov_b32 m0, 36864
    s_add_u32 s58, s58, 65536
    buffer_load_dwordx4 v64, s[24:27], s58 offen offset:0 lds
    buffer_load_dwordx4 v65, s[24:27], s58 offen offset:1024 lds
    buffer_load_dwordx4 v66, s[24:27], s58 offen offset:2048 lds
    buffer_load_dwordx4 v67, s[24:27], s58 offen offset:3072 lds
    s_mov_b32 m0, 40960
    s_add_u32 s58, s58, 65536
    buffer_load_dwordx4 v12, s[24:27], s58 offen offset:0 lds
    buffer_load_dwordx4 v13, s[24:27], s58 offen offset:1024 lds
    buffer_load_dwordx4 v14, s[24:27], s58 offen offset:2048 lds
    buffer_load_dwordx4 v15, s[24:27], s58 offen offset:3072 lds
    s_mov_b32 s32, s8
    s_mov_b32 s33, s9
    s_mov_b32 s34, 33554432
    s_mov_b32 s35, 0x20000
    s_mov_b32 s36, s12
    s_mov_b32 s37, s13
    s_mov_b32 s38, 3670016
    s_mov_b32 s39, 0x20000
    s_mov_b32 s64, s18
    s_mov_b32 s65, s19
    s_mov_b32 s66, 268435456
    s_mov_b32 s67, 0x20000
    s_sub_u32 s28, s6, 2688
    s_subb_u32 s29, s7, 0
    s_mov_b32 s30, 33557120
    s_mov_b32 s31, 0x20000
    v_lshrrev_b32 v36, 3, v2
    v_lshlrev_b32 v36, 9, v36
    v_lshl_add_u32 v19, v32, 4, v36
    v_xor_b32 v23, 64, v19
    v_add_u32 v16, 2688, v19
    v_add_u32 v20, 2688, v23
    v_add_u32 v17, 1792, v19
    v_add_u32 v21, 1792, v23
    v_add_u32 v18, 896, v19
    v_add_u32 v22, 896, v23
    v_and_b32 v36, 15, v2
    v_lshlrev_b32 v37, 2, v7
    v_xor_b32 v36, v36, v37
    v_lshlrev_b32 v36, 4, v36
    v_lshl_add_u32 v24, v7, 9, v36
    v_add_u32 v25, 1024, v24
    v_add_u32 v26, 2048, v24
    v_add_u32 v27, 3072, v24
    v_and_b32 v36, 1, v7
    v_lshlrev_b32 v36, 2, v36
    v_xor_b32 v36, v6, v36
    v_lshl_add_u32 v28, v36, 4, v5
    v_add_u32 v29, 6144, v28
    v_add_u32 v30, 12288, v28
    v_add_u32 v31, 18432, v28
    s_lshl_b32 s55, s41, 3
    s_add_u32 s55, s55, s40
    s_lshl_b32 s55, s55, 19
    s_lshl_b32 s49, s42, 18
    s_add_u32 s55, s55, s49
    s_lshl_b32 s49, s42, 8
    s_add_u32 s57, s55, s49
    s_xor_b32 s56, s57, 256
    s_mul_i32 s59, s40, 458752
    s_mul_i32 s72, s46, 14336
    s_add_u32 s72, s72, s59
    s_add_u32 s76, s12, s72
    s_addc_u32 s77, s13, 0
    s_and_b32 s48, s46, 3
    s_lshl_b32 s49, s48, 8
    s_add_u32 s59, s59, s49
    s_xor_b32 s49, s43, 0
    s_mul_i32 s68, s49, 229376
    s_xor_b32 s49, s42, 0
    s_mul_i32 s49, s49, 114688
    s_add_u32 s68, s68, s49
    s_add_u32 s68, s68, s59
    s_xor_b32 s49, s43, 1
    s_mul_i32 s69, s49, 229376
    s_xor_b32 s49, s42, 0
    s_mul_i32 s49, s49, 114688
    s_add_u32 s69, s69, s49
    s_add_u32 s69, s69, s59
    s_xor_b32 s49, s43, 0
    s_mul_i32 s70, s49, 229376
    s_xor_b32 s49, s42, 1
    s_mul_i32 s49, s49, 114688
    s_add_u32 s70, s70, s49
    s_add_u32 s70, s70, s59
    s_xor_b32 s49, s43, 1
    s_mul_i32 s71, s49, 229376
    s_xor_b32 s49, s42, 1
    s_mul_i32 s49, s49, 114688
    s_add_u32 s71, s71, s49
    s_add_u32 s71, s71, s59
    s_cmp_eq_u32 s48, 3
    s_cselect_b32 s49, 0x20000000, 0
    s_add_u32 s76, s68, s49
    s_add_u32 s77, s69, s49
    s_add_u32 s78, s70, s49
    s_add_u32 s79, s71, s49
    s_mov_b32 s80, s16
    s_mov_b32 s81, s17
    s_mov_b32 s82, 256
    s_mov_b32 s83, 0x20000
    s_lshl_b32 s84, s41, 11
    s_add_u32 s84, s84, 20971520
    s_lshl_b32 s85, s41, 5
    s_and_b32 s48, s46, 3
    s_xor_b32 s49, s40, s41
    s_or_b32 s49, s49, s48
    s_cselect_b32 s86, 0x20000000, s84
    s_cselect_b32 s87, 0x1000, s85
    s_lshl_b32 s88, s40, 5
    s_add_u32 s88, s88, s46
    s_lshl_b32 s88, s88, 9
    s_add_u32 s88, s88, 21102592
    s_lshl_b32 s89, s40, 7
    s_add_u32 s89, s89, s84
    s_lshl_b32 s48, s48, 2
    s_add_u32 s90, s89, s48
    s_getreg_b32 s91, hwreg(HW_REG_XCC_ID, 0, 4)
    s_or_b32 s91, s91, 16
    s_mov_b32 s92, 2000000
    s_and_b32 s48, s46, 3
    s_mul_i32 s93, s41, 7
    s_lshl_b32 s49, s48, 1
    s_add_u32 s93, s93, s49
    s_add_u32 s93, s93, 1
    s_mul_i32 s93, s93, 96
    s_add_u32 s93, s93, s40
    s_lshl_b32 s93, s93, 10
    s_cmp_eq_u32 s48, 3
    s_cselect_b32 s93, 0x20000000, s93
    v_mov_b32 v58, 0x7f817f81
    v_mov_b32 v59, v58
    v_mov_b32 v60, v58
    v_mov_b32 v61, v58
    v_lshlrev_b32 v57, 4, v2
    s_add_u32 s49, s40, s41
    s_and_b32 s49, s49, 7
    s_xor_b32 s49, s49, 4
    v_bfe_u32 v62, v2, 3, 2
    v_cmp_eq_u32 vcc, s49, v62
    v_mov_b32 v62, 0x40000000
    s_nop 0
    v_cndmask_b32 v57, v57, v62, vcc
    v_lshrrev_b32 v44, 2, v2
    v_and_b32 v45, 3, v2
    v_lshlrev_b32 v46, 7, v44
    v_lshl_add_u32 v46, v45, 4, v46
    v_and_b32 v44, 7, v44
    v_lshlrev_b32 v47, 7, v44
    v_lshl_add_u32 v47, v45, 2, v47
    v_mov_b32 v48, 0
    v_mov_b32 v49, 0
    v_mov_b32 v50, 0
    v_mov_b32 v51, 0
    v_mov_b32 v52, 1
    v_mov_b32 v53, s91
    s_branch L_al
.p2align 12
L_al:
    s_waitcnt vmcnt(32)
    s_mov_b32 m0, 45056
    s_add_u32 s58, s58, 65536
    buffer_load_dwordx4 v64, s[24:27], s58 offen offset:0 lds
    buffer_load_dwordx4 v65, s[24:27], s58 offen offset:1024 lds
    buffer_load_dwordx4 v66, s[24:27], s58 offen offset:2048 lds
    buffer_load_dwordx4 v67, s[24:27], s58 offen offset:3072 lds
    s_add_u32 s51, s51, 0x80000
    s_cmp_eq_u32 s51, 0x380000
    s_cselect_b32 s51, 0, s51
    s_waitcnt vmcnt(32)
    s_mov_b32 m0, 49152
    s_add_u32 s58, s52, s50
    buffer_load_dwordx4 v8, s[20:23], s58 offen offset:0 lds
    buffer_load_dwordx4 v9, s[20:23], s58 offen offset:1024 lds
    buffer_load_dwordx4 v10, s[20:23], s58 offen offset:2048 lds
    buffer_load_dwordx4 v11, s[20:23], s58 offen offset:3072 lds
    s_waitcnt vmcnt(32)
    s_mov_b32 m0, 53248
    s_add_u32 s58, s58, 28672
    buffer_load_dwordx4 v8, s[20:23], s58 offen offset:0 lds
    buffer_load_dwordx4 v9, s[20:23], s58 offen offset:1024 lds
    buffer_load_dwordx4 v10, s[20:23], s58 offen offset:2048 lds
    buffer_load_dwordx4 v11, s[20:23], s58 offen offset:3072 lds
    s_waitcnt vmcnt(32)
    s_mov_b32 m0, 57344
    s_add_u32 s58, s58, 28672
    buffer_load_dwordx4 v8, s[20:23], s58 offen offset:0 lds
    buffer_load_dwordx4 v9, s[20:23], s58 offen offset:1024 lds
    buffer_load_dwordx4 v10, s[20:23], s58 offen offset:2048 lds
    buffer_load_dwordx4 v11, s[20:23], s58 offen offset:3072 lds
    s_add_u32 s50, s50, 128
    s_cmp_eq_u32 s50, 896
    s_cselect_b32 s50, 0, s50
    s_waitcnt vmcnt(32)
    s_waitcnt vmcnt(28)
    s_barrier
    s_mov_b32 m0, 65536
    s_add_u32 s58, s53, s51
    buffer_load_dwordx4 v12, s[24:27], s58 offen offset:0 lds
    buffer_load_dwordx4 v13, s[24:27], s58 offen offset:1024 lds
    buffer_load_dwordx4 v14, s[24:27], s58 offen offset:2048 lds
    buffer_load_dwordx4 v15, s[24:27], s58 offen offset:3072 lds
    s_waitcnt vmcnt(32)
    s_mov_b32 m0, 69632
    s_add_u32 s58, s58, 65536
    buffer_load_dwordx4 v64, s[24:27], s58 offen offset:0 lds
    buffer_load_dwordx4 v65, s[24:27], s58 offen offset:1024 lds
    buffer_load_dwordx4 v66, s[24:27], s58 offen offset:2048 lds
    buffer_load_dwordx4 v67, s[24:27], s58 offen offset:3072 lds
    s_waitcnt vmcnt(32)
    s_mov_b32 m0, 73728
    s_add_u32 s58, s58, 65536
    buffer_load_dwordx4 v12, s[24:27], s58 offen offset:0 lds
    buffer_load_dwordx4 v13, s[24:27], s58 offen offset:1024 lds
    buffer_load_dwordx4 v14, s[24:27], s58 offen offset:2048 lds
    buffer_load_dwordx4 v15, s[24:27], s58 offen offset:3072 lds
    s_waitcnt vmcnt(32)
    s_mov_b32 m0, 77824
    s_add_u32 s58, s58, 65536
    buffer_load_dwordx4 v64, s[24:27], s58 offen offset:0 lds
    buffer_load_dwordx4 v65, s[24:27], s58 offen offset:1024 lds
    buffer_load_dwordx4 v66, s[24:27], s58 offen offset:2048 lds
    buffer_load_dwordx4 v67, s[24:27], s58 offen offset:3072 lds
    s_waitcnt vmcnt(32)
    s_waitcnt vmcnt(28)
    s_barrier
    s_mov_b32 m0, 81920
    s_add_u32 s58, s52, s50
    buffer_load_dwordx4 v8, s[20:23], s58 offen offset:0 lds
    buffer_load_dwordx4 v9, s[20:23], s58 offen offset:1024 lds
    buffer_load_dwordx4 v10, s[20:23], s58 offen offset:2048 lds
    buffer_load_dwordx4 v11, s[20:23], s58 offen offset:3072 lds
    s_waitcnt vmcnt(32)
    s_mov_b32 m0, 86016
    s_add_u32 s58, s58, 28672
    buffer_load_dwordx4 v8, s[20:23], s58 offen offset:0 lds
    buffer_load_dwordx4 v9, s[20:23], s58 offen offset:1024 lds
    buffer_load_dwordx4 v10, s[20:23], s58 offen offset:2048 lds
    buffer_load_dwordx4 v11, s[20:23], s58 offen offset:3072 lds
    s_waitcnt vmcnt(32)
    s_mov_b32 m0, 90112
    s_add_u32 s58, s58, 28672
    buffer_load_dwordx4 v8, s[20:23], s58 offen offset:0 lds
    buffer_load_dwordx4 v9, s[20:23], s58 offen offset:1024 lds
    buffer_load_dwordx4 v10, s[20:23], s58 offen offset:2048 lds
    buffer_load_dwordx4 v11, s[20:23], s58 offen offset:3072 lds
    s_add_u32 s50, s50, 128
    s_cmp_eq_u32 s50, 896
    s_cselect_b32 s50, 0, s50
    s_waitcnt vmcnt(32)
    s_mov_b32 m0, 98304
    s_add_u32 s58, s54, s51
    buffer_load_dwordx4 v12, s[24:27], s58 offen offset:0 lds
    buffer_load_dwordx4 v13, s[24:27], s58 offen offset:1024 lds
    buffer_load_dwordx4 v14, s[24:27], s58 offen offset:2048 lds
    buffer_load_dwordx4 v15, s[24:27], s58 offen offset:3072 lds
    s_waitcnt vmcnt(32)
    s_mov_b32 m0, 102400
    s_add_u32 s58, s58, 65536
    buffer_load_dwordx4 v64, s[24:27], s58 offen offset:0 lds
    buffer_load_dwordx4 v65, s[24:27], s58 offen offset:1024 lds
    buffer_load_dwordx4 v66, s[24:27], s58 offen offset:2048 lds
    buffer_load_dwordx4 v67, s[24:27], s58 offen offset:3072 lds
    s_waitcnt vmcnt(32)
    s_mov_b32 m0, 106496
    s_add_u32 s58, s58, 65536
    buffer_load_dwordx4 v12, s[24:27], s58 offen offset:0 lds
    buffer_load_dwordx4 v13, s[24:27], s58 offen offset:1024 lds
    buffer_load_dwordx4 v14, s[24:27], s58 offen offset:2048 lds
    buffer_load_dwordx4 v15, s[24:27], s58 offen offset:3072 lds
    s_waitcnt vmcnt(32)
    s_mov_b32 m0, 110592
    s_add_u32 s58, s58, 65536
    buffer_load_dwordx4 v64, s[24:27], s58 offen offset:0 lds
    buffer_load_dwordx4 v65, s[24:27], s58 offen offset:1024 lds
    buffer_load_dwordx4 v66, s[24:27], s58 offen offset:2048 lds
    buffer_load_dwordx4 v67, s[24:27], s58 offen offset:3072 lds
    s_add_u32 s51, s51, 0x80000
    s_cmp_eq_u32 s51, 0x380000
    s_cselect_b32 s51, 0, s51
    s_waitcnt vmcnt(32)
    s_waitcnt vmcnt(28)
    s_barrier
    s_mov_b32 m0, 114688
    s_add_u32 s58, s53, s51
    buffer_load_dwordx4 v12, s[24:27], s58 offen offset:0 lds
    buffer_load_dwordx4 v13, s[24:27], s58 offen offset:1024 lds
    buffer_load_dwordx4 v14, s[24:27], s58 offen offset:2048 lds
    buffer_load_dwordx4 v15, s[24:27], s58 offen offset:3072 lds
    s_waitcnt vmcnt(32)
    s_mov_b32 m0, 118784
    s_add_u32 s58, s58, 65536
    buffer_load_dwordx4 v64, s[24:27], s58 offen offset:0 lds
    buffer_load_dwordx4 v65, s[24:27], s58 offen offset:1024 lds
    buffer_load_dwordx4 v66, s[24:27], s58 offen offset:2048 lds
    buffer_load_dwordx4 v67, s[24:27], s58 offen offset:3072 lds
    s_waitcnt vmcnt(32)
    s_mov_b32 m0, 122880
    s_add_u32 s58, s58, 65536
    buffer_load_dwordx4 v12, s[24:27], s58 offen offset:0 lds
    buffer_load_dwordx4 v13, s[24:27], s58 offen offset:1024 lds
    buffer_load_dwordx4 v14, s[24:27], s58 offen offset:2048 lds
    buffer_load_dwordx4 v15, s[24:27], s58 offen offset:3072 lds
    s_waitcnt vmcnt(32)
    s_mov_b32 m0, 126976
    s_add_u32 s58, s58, 65536
    buffer_load_dwordx4 v64, s[24:27], s58 offen offset:0 lds
    buffer_load_dwordx4 v65, s[24:27], s58 offen offset:1024 lds
    buffer_load_dwordx4 v66, s[24:27], s58 offen offset:2048 lds
    buffer_load_dwordx4 v67, s[24:27], s58 offen offset:3072 lds
    buffer_store_dwordx4 v[48:51], v46, s[64:67], s86 offen sc1
    s_mov_b64 exec, 15
    buffer_store_dwordx4 v[48:51], v46, s[64:67], s88 offen sc1
    s_mov_b64 exec, -1
    s_waitcnt vmcnt(32)
    s_mov_b32 m0, 131072
    s_add_u32 s58, s52, s50
    buffer_load_dwordx4 v8, s[20:23], s58 offen offset:0 lds
    buffer_load_dwordx4 v9, s[20:23], s58 offen offset:1024 lds
    buffer_load_dwordx4 v10, s[20:23], s58 offen offset:2048 lds
    buffer_load_dwordx4 v11, s[20:23], s58 offen offset:3072 lds
    s_waitcnt vmcnt(32)
    s_mov_b32 m0, 135168
    s_add_u32 s58, s58, 28672
    buffer_load_dwordx4 v8, s[20:23], s58 offen offset:0 lds
    buffer_load_dwordx4 v9, s[20:23], s58 offen offset:1024 lds
    buffer_load_dwordx4 v10, s[20:23], s58 offen offset:2048 lds
    buffer_load_dwordx4 v11, s[20:23], s58 offen offset:3072 lds
    s_waitcnt vmcnt(32)
    s_mov_b32 m0, 139264
    s_add_u32 s58, s58, 28672
    buffer_load_dwordx4 v8, s[20:23], s58 offen offset:0 lds
    buffer_load_dwordx4 v9, s[20:23], s58 offen offset:1024 lds
    buffer_load_dwordx4 v10, s[20:23], s58 offen offset:2048 lds
    buffer_load_dwordx4 v11, s[20:23], s58 offen offset:3072 lds
    s_add_u32 s50, s50, 128
    s_cmp_eq_u32 s50, 896
    s_cselect_b32 s50, 0, s50
    s_waitcnt vmcnt(32)
    s_mov_b32 m0, 147456
    s_add_u32 s58, s54, s51
    buffer_load_dwordx4 v12, s[24:27], s58 offen offset:0 lds
    buffer_load_dwordx4 v13, s[24:27], s58 offen offset:1024 lds
    buffer_load_dwordx4 v14, s[24:27], s58 offen offset:2048 lds
    buffer_load_dwordx4 v15, s[24:27], s58 offen offset:3072 lds
    s_waitcnt vmcnt(32)
    s_mov_b32 m0, 151552
    s_add_u32 s58, s58, 65536
    buffer_load_dwordx4 v64, s[24:27], s58 offen offset:0 lds
    buffer_load_dwordx4 v65, s[24:27], s58 offen offset:1024 lds
    buffer_load_dwordx4 v66, s[24:27], s58 offen offset:2048 lds
    buffer_load_dwordx4 v67, s[24:27], s58 offen offset:3072 lds
    s_waitcnt vmcnt(32)
    s_barrier
    s_mov_b32 m0, 155648
    s_add_u32 s58, s58, 65536
    buffer_load_dwordx4 v12, s[24:27], s58 offen offset:0 lds
    buffer_load_dwordx4 v13, s[24:27], s58 offen offset:1024 lds
    buffer_load_dwordx4 v14, s[24:27], s58 offen offset:2048 lds
    buffer_load_dwordx4 v15, s[24:27], s58 offen offset:3072 lds
    s_waitcnt vmcnt(32)
    s_mov_b32 m0, 159744
    s_add_u32 s58, s58, 65536
    buffer_load_dwordx4 v64, s[24:27], s58 offen offset:0 lds
    buffer_load_dwordx4 v65, s[24:27], s58 offen offset:1024 lds
    buffer_load_dwordx4 v66, s[24:27], s58 offen offset:2048 lds
    buffer_load_dwordx4 v67, s[24:27], s58 offen offset:3072 lds
    s_add_u32 s51, s51, 0x80000
    s_cmp_eq_u32 s51, 0x380000
    s_cselect_b32 s51, 0, s51
    s_waitcnt vmcnt(32)
    s_mov_b32 m0, 0
    s_add_u32 s58, s53, s51
    buffer_load_dwordx4 v12, s[24:27], s58 offen offset:0 lds
    buffer_load_dwordx4 v13, s[24:27], s58 offen offset:1024 lds
    buffer_load_dwordx4 v14, s[24:27], s58 offen offset:2048 lds
    buffer_load_dwordx4 v15, s[24:27], s58 offen offset:3072 lds
    s_waitcnt vmcnt(32)
    s_mov_b32 m0, 4096
    s_add_u32 s58, s58, 65536
    buffer_load_dwordx4 v64, s[24:27], s58 offen offset:0 lds
    buffer_load_dwordx4 v65, s[24:27], s58 offen offset:1024 lds
    buffer_load_dwordx4 v66, s[24:27], s58 offen offset:2048 lds
    buffer_load_dwordx4 v67, s[24:27], s58 offen offset:3072 lds
    s_waitcnt vmcnt(32)
    s_mov_b32 m0, 8192
    s_add_u32 s58, s58, 65536
    buffer_load_dwordx4 v12, s[24:27], s58 offen offset:0 lds
    buffer_load_dwordx4 v13, s[24:27], s58 offen offset:1024 lds
    buffer_load_dwordx4 v14, s[24:27], s58 offen offset:2048 lds
    buffer_load_dwordx4 v15, s[24:27], s58 offen offset:3072 lds
    s_waitcnt vmcnt(32)
    s_mov_b32 m0, 12288
    s_add_u32 s58, s58, 65536
    buffer_load_dwordx4 v64, s[24:27], s58 offen offset:0 lds
    buffer_load_dwordx4 v65, s[24:27], s58 offen offset:1024 lds
    buffer_load_dwordx4 v66, s[24:27], s58 offen offset:2048 lds
    buffer_load_dwordx4 v67, s[24:27], s58 offen offset:3072 lds
    s_waitcnt vmcnt(32)
    s_mov_b32 m0, 16384
    s_add_u32 s58, s52, s50
    buffer_load_dwordx4 v8, s[20:23], s58 offen offset:0 lds
    buffer_load_dwordx4 v9, s[20:23], s58 offen offset:1024 lds
    buffer_load_dwordx4 v10, s[20:23], s58 offen offset:2048 lds
    buffer_load_dwordx4 v11, s[20:23], s58 offen offset:3072 lds
    s_waitcnt vmcnt(32)
    s_barrier
    s_mov_b32 m0, 20480
    s_add_u32 s58, s58, 28672
    buffer_load_dwordx4 v8, s[20:23], s58 offen offset:0 lds
    buffer_load_dwordx4 v9, s[20:23], s58 offen offset:1024 lds
    buffer_load_dwordx4 v10, s[20:23], s58 offen offset:2048 lds
    buffer_load_dwordx4 v11, s[20:23], s58 offen offset:3072 lds
    s_waitcnt vmcnt(32)
    s_mov_b32 m0, 24576
    s_add_u32 s58, s58, 28672
    buffer_load_dwordx4 v8, s[20:23], s58 offen offset:0 lds
    buffer_load_dwordx4 v9, s[20:23], s58 offen offset:1024 lds
    buffer_load_dwordx4 v10, s[20:23], s58 offen offset:2048 lds
    buffer_load_dwordx4 v11, s[20:23], s58 offen offset:3072 lds
    s_add_u32 s50, s50, 128
    s_cmp_eq_u32 s50, 896
    s_cselect_b32 s50, 0, s50
    s_waitcnt vmcnt(32)
    s_mov_b32 m0, 32768
    s_add_u32 s58, s54, s51
    buffer_load_dwordx4 v12, s[24:27], s58 offen offset:0 lds
    buffer_load_dwordx4 v13, s[24:27], s58 offen offset:1024 lds
    buffer_load_dwordx4 v14, s[24:27], s58 offen offset:2048 lds
    buffer_load_dwordx4 v15, s[24:27], s58 offen offset:3072 lds
    s_waitcnt vmcnt(32)
    s_mov_b32 m0, 36864
    s_add_u32 s58, s58, 65536
    buffer_load_dwordx4 v64, s[24:27], s58 offen offset:0 lds
    buffer_load_dwordx4 v65, s[24:27], s58 offen offset:1024 lds
    buffer_load_dwordx4 v66, s[24:27], s58 offen offset:2048 lds
    buffer_load_dwordx4 v67, s[24:27], s58 offen offset:3072 lds
    s_waitcnt vmcnt(32)
    s_mov_b32 m0, 40960
    s_add_u32 s58, s58, 65536
    buffer_load_dwordx4 v12, s[24:27], s58 offen offset:0 lds
    buffer_load_dwordx4 v13, s[24:27], s58 offen offset:1024 lds
    buffer_load_dwordx4 v14, s[24:27], s58 offen offset:2048 lds
    buffer_load_dwordx4 v15, s[24:27], s58 offen offset:3072 lds
    s_waitcnt vmcnt(32)
    s_mov_b32 m0, 45056
    s_add_u32 s58, s58, 65536
    buffer_load_dwordx4 v64, s[24:27], s58 offen offset:0 lds
    buffer_load_dwordx4 v65, s[24:27], s58 offen offset:1024 lds
    buffer_load_dwordx4 v66, s[24:27], s58 offen offset:2048 lds
    buffer_load_dwordx4 v67, s[24:27], s58 offen offset:3072 lds
    s_add_u32 s51, s51, 0x80000
    s_cmp_eq_u32 s51, 0x380000
    s_cselect_b32 s51, 0, s51
    s_waitcnt vmcnt(32)
    s_mov_b32 m0, 49152
    s_add_u32 s58, s53, s51
    buffer_load_dwordx4 v12, s[24:27], s58 offen offset:0 lds
    buffer_load_dwordx4 v13, s[24:27], s58 offen offset:1024 lds
    buffer_load_dwordx4 v14, s[24:27], s58 offen offset:2048 lds
    buffer_load_dwordx4 v15, s[24:27], s58 offen offset:3072 lds
    s_waitcnt vmcnt(32)
    s_mov_b32 m0, 53248
    s_add_u32 s58, s58, 65536
    buffer_load_dwordx4 v64, s[24:27], s58 offen offset:0 lds
    buffer_load_dwordx4 v65, s[24:27], s58 offen offset:1024 lds
    buffer_load_dwordx4 v66, s[24:27], s58 offen offset:2048 lds
    buffer_load_dwordx4 v67, s[24:27], s58 offen offset:3072 lds
    s_waitcnt vmcnt(32)
    s_mov_b32 m0, 57344
    s_add_u32 s58, s58, 65536
    buffer_load_dwordx4 v12, s[24:27], s58 offen offset:0 lds
    buffer_load_dwordx4 v13, s[24:27], s58 offen offset:1024 lds
    buffer_load_dwordx4 v14, s[24:27], s58 offen offset:2048 lds
    buffer_load_dwordx4 v15, s[24:27], s58 offen offset:3072 lds
    s_waitcnt vmcnt(32)
    s_barrier
    s_mov_b32 m0, 61440
    s_add_u32 s58, s58, 65536
    buffer_load_dwordx4 v64, s[24:27], s58 offen offset:0 lds
    buffer_load_dwordx4 v65, s[24:27], s58 offen offset:1024 lds
    buffer_load_dwordx4 v66, s[24:27], s58 offen offset:2048 lds
    buffer_load_dwordx4 v67, s[24:27], s58 offen offset:3072 lds
    s_waitcnt vmcnt(32)
    s_mov_b32 m0, 65536
    s_add_u32 s58, s52, s50
    buffer_load_dwordx4 v8, s[20:23], s58 offen offset:0 lds
    buffer_load_dwordx4 v9, s[20:23], s58 offen offset:1024 lds
    buffer_load_dwordx4 v10, s[20:23], s58 offen offset:2048 lds
    buffer_load_dwordx4 v11, s[20:23], s58 offen offset:3072 lds
    s_waitcnt vmcnt(32)
    s_mov_b32 m0, 69632
    s_add_u32 s58, s58, 28672
    buffer_load_dwordx4 v8, s[20:23], s58 offen offset:0 lds
    buffer_load_dwordx4 v9, s[20:23], s58 offen offset:1024 lds
    buffer_load_dwordx4 v10, s[20:23], s58 offen offset:2048 lds
    buffer_load_dwordx4 v11, s[20:23], s58 offen offset:3072 lds
    s_waitcnt vmcnt(32)
    s_mov_b32 m0, 73728
    s_add_u32 s58, s58, 28672
    buffer_load_dwordx4 v8, s[20:23], s58 offen offset:0 lds
    buffer_load_dwordx4 v9, s[20:23], s58 offen offset:1024 lds
    buffer_load_dwordx4 v10, s[20:23], s58 offen offset:2048 lds
    buffer_load_dwordx4 v11, s[20:23], s58 offen offset:3072 lds
    s_add_u32 s50, s50, 128
    s_cmp_eq_u32 s50, 896
    s_cselect_b32 s50, 0, s50
    s_waitcnt vmcnt(32)
    s_mov_b32 m0, 81920
    s_add_u32 s58, s54, s51
    buffer_load_dwordx4 v12, s[24:27], s58 offen offset:0 lds
    buffer_load_dwordx4 v13, s[24:27], s58 offen offset:1024 lds
    buffer_load_dwordx4 v14, s[24:27], s58 offen offset:2048 lds
    buffer_load_dwordx4 v15, s[24:27], s58 offen offset:3072 lds
    s_waitcnt vmcnt(32)
    s_mov_b32 m0, 86016
    s_add_u32 s58, s58, 65536
    buffer_load_dwordx4 v64, s[24:27], s58 offen offset:0 lds
    buffer_load_dwordx4 v65, s[24:27], s58 offen offset:1024 lds
    buffer_load_dwordx4 v66, s[24:27], s58 offen offset:2048 lds
    buffer_load_dwordx4 v67, s[24:27], s58 offen offset:3072 lds
    s_waitcnt vmcnt(32)
    s_mov_b32 m0, 90112
    s_add_u32 s58, s58, 65536
    buffer_load_dwordx4 v12, s[24:27], s58 offen offset:0 lds
    buffer_load_dwordx4 v13, s[24:27], s58 offen offset:1024 lds
    buffer_load_dwordx4 v14, s[24:27], s58 offen offset:2048 lds
    buffer_load_dwordx4 v15, s[24:27], s58 offen offset:3072 lds
    s_waitcnt vmcnt(32)
    s_barrier
    s_mov_b32 m0, 94208
    s_add_u32 s58, s58, 65536
    buffer_load_dwordx4 v64, s[24:27], s58 offen offset:0 lds
    buffer_load_dwordx4 v65, s[24:27], s58 offen offset:1024 lds
    buffer_load_dwordx4 v66, s[24:27], s58 offen offset:2048 lds
    buffer_load_dwordx4 v67, s[24:27], s58 offen offset:3072 lds
    s_add_u32 s51, s51, 0x80000
    s_cmp_eq_u32 s51, 0x380000
    s_cselect_b32 s51, 0, s51
    s_waitcnt vmcnt(32)
    s_mov_b32 m0, 98304
    s_add_u32 s58, s53, s51
    buffer_load_dwordx4 v12, s[24:27], s58 offen offset:0 lds
    buffer_load_dwordx4 v13, s[24:27], s58 offen offset:1024 lds
    buffer_load_dwordx4 v14, s[24:27], s58 offen offset:2048 lds
    buffer_load_dwordx4 v15, s[24:27], s58 offen offset:3072 lds
    s_waitcnt vmcnt(32)
    s_mov_b32 m0, 102400
    s_add_u32 s58, s58, 65536
    buffer_load_dwordx4 v64, s[24:27], s58 offen offset:0 lds
    buffer_load_dwordx4 v65, s[24:27], s58 offen offset:1024 lds
    buffer_load_dwordx4 v66, s[24:27], s58 offen offset:2048 lds
    buffer_load_dwordx4 v67, s[24:27], s58 offen offset:3072 lds
    s_waitcnt vmcnt(32)
    s_mov_b32 m0, 106496
    s_add_u32 s58, s58, 65536
    buffer_load_dwordx4 v12, s[24:27], s58 offen offset:0 lds
    buffer_load_dwordx4 v13, s[24:27], s58 offen offset:1024 lds
    buffer_load_dwordx4 v14, s[24:27], s58 offen offset:2048 lds
    buffer_load_dwordx4 v15, s[24:27], s58 offen offset:3072 lds
    s_waitcnt vmcnt(32)
    s_mov_b32 m0, 110592
    s_add_u32 s58, s58, 65536
    buffer_load_dwordx4 v64, s[24:27], s58 offen offset:0 lds
    buffer_load_dwordx4 v65, s[24:27], s58 offen offset:1024 lds
    buffer_load_dwordx4 v66, s[24:27], s58 offen offset:2048 lds
    buffer_load_dwordx4 v67, s[24:27], s58 offen offset:3072 lds
    s_waitcnt vmcnt(32)
    s_mov_b32 m0, 114688
    s_add_u32 s58, s52, s50
    buffer_load_dwordx4 v8, s[20:23], s58 offen offset:0 lds
    buffer_load_dwordx4 v9, s[20:23], s58 offen offset:1024 lds
    buffer_load_dwordx4 v10, s[20:23], s58 offen offset:2048 lds
    buffer_load_dwordx4 v11, s[20:23], s58 offen offset:3072 lds
    s_waitcnt vmcnt(32)
    s_mov_b32 m0, 118784
    s_add_u32 s58, s58, 28672
    buffer_load_dwordx4 v8, s[20:23], s58 offen offset:0 lds
    buffer_load_dwordx4 v9, s[20:23], s58 offen offset:1024 lds
    buffer_load_dwordx4 v10, s[20:23], s58 offen offset:2048 lds
    buffer_load_dwordx4 v11, s[20:23], s58 offen offset:3072 lds
    s_waitcnt vmcnt(32)
    s_mov_b32 m0, 122880
    s_add_u32 s58, s58, 28672
    buffer_load_dwordx4 v8, s[20:23], s58 offen offset:0 lds
    buffer_load_dwordx4 v9, s[20:23], s58 offen offset:1024 lds
    buffer_load_dwordx4 v10, s[20:23], s58 offen offset:2048 lds
    buffer_load_dwordx4 v11, s[20:23], s58 offen offset:3072 lds
    s_add_u32 s50, s50, 128
    s_cmp_eq_u32 s50, 896
    s_cselect_b32 s50, 0, s50
    s_waitcnt vmcnt(32)
    s_mov_b32 m0, 131072
    s_add_u32 s58, s54, s51
    buffer_load_dwordx4 v12, s[24:27], s58 offen offset:0 lds
    buffer_load_dwordx4 v13, s[24:27], s58 offen offset:1024 lds
    buffer_load_dwordx4 v14, s[24:27], s58 offen offset:2048 lds
    buffer_load_dwordx4 v15, s[24:27], s58 offen offset:3072 lds
    s_waitcnt vmcnt(32)
    s_barrier
    s_mov_b32 m0, 135168
    s_add_u32 s58, s58, 65536
    buffer_load_dwordx4 v64, s[24:27], s58 offen offset:0 lds
    buffer_load_dwordx4 v65, s[24:27], s58 offen offset:1024 lds
    buffer_load_dwordx4 v66, s[24:27], s58 offen offset:2048 lds
    buffer_load_dwordx4 v67, s[24:27], s58 offen offset:3072 lds
    s_waitcnt vmcnt(32)
    s_mov_b32 m0, 139264
    s_add_u32 s58, s58, 65536
    buffer_load_dwordx4 v12, s[24:27], s58 offen offset:0 lds
    buffer_load_dwordx4 v13, s[24:27], s58 offen offset:1024 lds
    buffer_load_dwordx4 v14, s[24:27], s58 offen offset:2048 lds
    buffer_load_dwordx4 v15, s[24:27], s58 offen offset:3072 lds
    s_waitcnt vmcnt(32)
    s_mov_b32 m0, 143360
    s_add_u32 s58, s58, 65536
    buffer_load_dwordx4 v64, s[24:27], s58 offen offset:0 lds
    buffer_load_dwordx4 v65, s[24:27], s58 offen offset:1024 lds
    buffer_load_dwordx4 v66, s[24:27], s58 offen offset:2048 lds
    buffer_load_dwordx4 v67, s[24:27], s58 offen offset:3072 lds
    s_add_u32 s51, s51, 0x80000
    s_cmp_eq_u32 s51, 0x380000
    s_cselect_b32 s51, 0, s51
    s_waitcnt vmcnt(32)
    s_mov_b32 m0, 147456
    s_add_u32 s58, s53, s51
    buffer_load_dwordx4 v12, s[24:27], s58 offen offset:0 lds
    buffer_load_dwordx4 v13, s[24:27], s58 offen offset:1024 lds
    buffer_load_dwordx4 v14, s[24:27], s58 offen offset:2048 lds
    buffer_load_dwordx4 v15, s[24:27], s58 offen offset:3072 lds
    s_waitcnt vmcnt(32)
    s_mov_b32 m0, 151552
    s_add_u32 s58, s58, 65536
    buffer_load_dwordx4 v64, s[24:27], s58 offen offset:0 lds
    buffer_load_dwordx4 v65, s[24:27], s58 offen offset:1024 lds
    buffer_load_dwordx4 v66, s[24:27], s58 offen offset:2048 lds
    buffer_load_dwordx4 v67, s[24:27], s58 offen offset:3072 lds
    s_waitcnt vmcnt(32)
    s_mov_b32 m0, 155648
    s_add_u32 s58, s58, 65536
    buffer_load_dwordx4 v12, s[24:27], s58 offen offset:0 lds
    buffer_load_dwordx4 v13, s[24:27], s58 offen offset:1024 lds
    buffer_load_dwordx4 v14, s[24:27], s58 offen offset:2048 lds
    buffer_load_dwordx4 v15, s[24:27], s58 offen offset:3072 lds
    s_waitcnt vmcnt(32)
    s_mov_b32 m0, 159744
    s_add_u32 s58, s58, 65536
    buffer_load_dwordx4 v64, s[24:27], s58 offen offset:0 lds
    buffer_load_dwordx4 v65, s[24:27], s58 offen offset:1024 lds
    buffer_load_dwordx4 v66, s[24:27], s58 offen offset:2048 lds
    buffer_load_dwordx4 v67, s[24:27], s58 offen offset:3072 lds
    s_waitcnt vmcnt(32)
    s_barrier
    s_mov_b32 m0, 0
    s_add_u32 s58, s54, s51
    buffer_load_dwordx4 v12, s[24:27], s58 offen offset:0 lds
    buffer_load_dwordx4 v13, s[24:27], s58 offen offset:1024 lds
    buffer_load_dwordx4 v14, s[24:27], s58 offen offset:2048 lds
    buffer_load_dwordx4 v15, s[24:27], s58 offen offset:3072 lds
    s_waitcnt vmcnt(32)
    s_mov_b32 m0, 4096
    s_add_u32 s58, s58, 65536
    buffer_load_dwordx4 v64, s[24:27], s58 offen offset:0 lds
    buffer_load_dwordx4 v65, s[24:27], s58 offen offset:1024 lds
    buffer_load_dwordx4 v66, s[24:27], s58 offen offset:2048 lds
    buffer_load_dwordx4 v67, s[24:27], s58 offen offset:3072 lds
    s_waitcnt vmcnt(32)
    s_mov_b32 m0, 8192
    s_add_u32 s58, s58, 65536
    buffer_load_dwordx4 v12, s[24:27], s58 offen offset:0 lds
    buffer_load_dwordx4 v13, s[24:27], s58 offen offset:1024 lds
    buffer_load_dwordx4 v14, s[24:27], s58 offen offset:2048 lds
    buffer_load_dwordx4 v15, s[24:27], s58 offen offset:3072 lds
    s_waitcnt vmcnt(32)
    s_mov_b32 m0, 12288
    s_add_u32 s58, s58, 65536
    buffer_load_dwordx4 v64, s[24:27], s58 offen offset:0 lds
    buffer_load_dwordx4 v65, s[24:27], s58 offen offset:1024 lds
    buffer_load_dwordx4 v66, s[24:27], s58 offen offset:2048 lds
    buffer_load_dwordx4 v67, s[24:27], s58 offen offset:3072 lds
    s_add_u32 s51, s51, 0x80000
    s_cmp_eq_u32 s51, 0x380000
    s_cselect_b32 s51, 0, s51
    s_waitcnt vmcnt(32)
    s_mov_b32 m0, 16384
    s_xor_b32 s58, s55, 0
    buffer_load_dwordx4 v16, s[28:31], s58 offen offset:0 nt lds
    buffer_load_dwordx4 v17, s[28:31], s58 offen offset:1024 nt lds
    buffer_load_dwordx4 v18, s[28:31], s58 offen offset:2048 nt lds
    buffer_load_dwordx4 v19, s[28:31], s58 offen offset:3072 nt lds
    s_waitcnt vmcnt(44)
    s_mov_b32 m0, 20480
    s_xor_b32 s58, s55, 4096
    buffer_load_dwordx4 v20, s[28:31], s58 offen offset:0 nt lds
    buffer_load_dwordx4 v21, s[28:31], s58 offen offset:1024 nt lds
    buffer_load_dwordx4 v22, s[28:31], s58 offen offset:2048 nt lds
    buffer_load_dwordx4 v23, s[28:31], s58 offen offset:3072 nt lds
    s_waitcnt vmcnt(44)
    s_mov_b32 m0, 24576
    s_xor_b32 s58, s55, 8192
    buffer_load_dwordx4 v16, s[28:31], s58 offen offset:0 nt lds
    buffer_load_dwordx4 v17, s[28:31], s58 offen offset:1024 nt lds
    buffer_load_dwordx4 v18, s[28:31], s58 offen offset:2048 nt lds
    buffer_load_dwordx4 v19, s[28:31], s58 offen offset:3072 nt lds
    s_waitcnt vmcnt(44)
    s_mov_b32 m0, 28672
    s_xor_b32 s58, s55, 12288
    buffer_load_dwordx4 v20, s[28:31], s58 offen offset:0 nt lds
    buffer_load_dwordx4 v21, s[28:31], s58 offen offset:1024 nt lds
    buffer_load_dwordx4 v22, s[28:31], s58 offen offset:2048 nt lds
    buffer_load_dwordx4 v23, s[28:31], s58 offen offset:3072 nt lds
    s_waitcnt vmcnt(44)
    s_barrier
    s_mov_b32 m0, 32768
    s_xor_b32 s58, s55, 16384
    buffer_load_dwordx4 v16, s[28:31], s58 offen offset:0 nt lds
    buffer_load_dwordx4 v17, s[28:31], s58 offen offset:1024 nt lds
    buffer_load_dwordx4 v18, s[28:31], s58 offen offset:2048 nt lds
    buffer_load_dwordx4 v19, s[28:31], s58 offen offset:3072 nt lds
    s_waitcnt vmcnt(44)
    s_mov_b32 m0, 36864
    s_xor_b32 s58, s55, 20480
    buffer_load_dwordx4 v20, s[28:31], s58 offen offset:0 nt lds
    buffer_load_dwordx4 v21, s[28:31], s58 offen offset:1024 nt lds
    buffer_load_dwordx4 v22, s[28:31], s58 offen offset:2048 nt lds
    buffer_load_dwordx4 v23, s[28:31], s58 offen offset:3072 nt lds
    s_waitcnt vmcnt(44)
    s_mov_b32 m0, 40960
    s_xor_b32 s58, s55, 24576
    buffer_load_dwordx4 v16, s[28:31], s58 offen offset:0 nt lds
    buffer_load_dwordx4 v17, s[28:31], s58 offen offset:1024 nt lds
    buffer_load_dwordx4 v18, s[28:31], s58 offen offset:2048 nt lds
    buffer_load_dwordx4 v19, s[28:31], s58 offen offset:3072 nt lds
    s_waitcnt vmcnt(44)
    s_mov_b32 m0, 45056
    s_xor_b32 s58, s55, 28672
    buffer_load_dwordx4 v20, s[28:31], s58 offen offset:0 nt lds
    buffer_load_dwordx4 v21, s[28:31], s58 offen offset:1024 nt lds
    buffer_load_dwordx4 v22, s[28:31], s58 offen offset:2048 nt lds
    buffer_load_dwordx4 v23, s[28:31], s58 offen offset:3072 nt lds
    s_waitcnt vmcnt(44)
    s_barrier
    s_mov_b32 m0, 49152
    s_xor_b32 s58, s55, 32768
    buffer_load_dwordx4 v16, s[28:31], s58 offen offset:0 nt lds
    buffer_load_dwordx4 v17, s[28:31], s58 offen offset:1024 nt lds
    buffer_load_dwordx4 v18, s[28:31], s58 offen offset:2048 nt lds
    buffer_load_dwordx4 v19, s[28:31], s58 offen offset:3072 nt lds
    s_waitcnt vmcnt(44)
    s_mov_b32 m0, 53248
    s_xor_b32 s58, s55, 36864
    buffer_load_dwordx4 v20, s[28:31], s58 offen offset:0 nt lds
    buffer_load_dwordx4 v21, s[28:31], s58 offen offset:1024 nt lds
    buffer_load_dwordx4 v22, s[28:31], s58 offen offset:2048 nt lds
    buffer_load_dwordx4 v23, s[28:31], s58 offen offset:3072 nt lds
    s_waitcnt vmcnt(44)
    s_mov_b32 m0, 57344
    s_xor_b32 s58, s55, 40960
    buffer_load_dwordx4 v16, s[28:31], s58 offen offset:0 nt lds
    buffer_load_dwordx4 v17, s[28:31], s58 offen offset:1024 nt lds
    buffer_load_dwordx4 v18, s[28:31], s58 offen offset:2048 nt lds
    buffer_load_dwordx4 v19, s[28:31], s58 offen offset:3072 nt lds
    s_waitcnt vmcnt(44)
    s_mov_b32 m0, 61440
    s_xor_b32 s58, s55, 45056
    buffer_load_dwordx4 v20, s[28:31], s58 offen offset:0 nt lds
    buffer_load_dwordx4 v21, s[28:31], s58 offen offset:1024 nt lds
    buffer_load_dwordx4 v22, s[28:31], s58 offen offset:2048 nt lds
    buffer_load_dwordx4 v23, s[28:31], s58 offen offset:3072 nt lds
    s_waitcnt vmcnt(44)
    s_mov_b32 m0, 65536
    s_xor_b32 s58, s55, 49152
    buffer_load_dwordx4 v16, s[28:31], s58 offen offset:0 nt lds
    buffer_load_dwordx4 v17, s[28:31], s58 offen offset:1024 nt lds
    buffer_load_dwordx4 v18, s[28:31], s58 offen offset:2048 nt lds
    buffer_load_dwordx4 v19, s[28:31], s58 offen offset:3072 nt lds
    s_waitcnt vmcnt(44)
    s_mov_b32 m0, 69632
    s_xor_b32 s58, s55, 53248
    buffer_load_dwordx4 v20, s[28:31], s58 offen offset:0 nt lds
    buffer_load_dwordx4 v21, s[28:31], s58 offen offset:1024 nt lds
    buffer_load_dwordx4 v22, s[28:31], s58 offen offset:2048 nt lds
    buffer_load_dwordx4 v23, s[28:31], s58 offen offset:3072 nt lds
    s_waitcnt vmcnt(44)
    s_mov_b32 m0, 73728
    s_xor_b32 s58, s55, 57344
    buffer_load_dwordx4 v16, s[28:31], s58 offen offset:0 nt lds
    buffer_load_dwordx4 v17, s[28:31], s58 offen offset:1024 nt lds
    buffer_load_dwordx4 v18, s[28:31], s58 offen offset:2048 nt lds
    buffer_load_dwordx4 v19, s[28:31], s58 offen offset:3072 nt lds
    s_waitcnt vmcnt(44)
    s_barrier
    s_mov_b32 m0, 77824
    s_xor_b32 s58, s55, 61440
    buffer_load_dwordx4 v20, s[28:31], s58 offen offset:0 nt lds
    buffer_load_dwordx4 v21, s[28:31], s58 offen offset:1024 nt lds
    buffer_load_dwordx4 v22, s[28:31], s58 offen offset:2048 nt lds
    buffer_load_dwordx4 v23, s[28:31], s58 offen offset:3072 nt lds
    s_mov_b64 exec, 1
    buffer_store_dword v52, v48, s[80:83], s87 offen sc1
    s_mov_b64 exec, -1
    s_waitcnt vmcnt(44)
    s_mov_b32 m0, 81920
    s_xor_b32 s58, s55, 65536
    buffer_load_dwordx4 v16, s[28:31], s58 offen offset:0 nt lds
    buffer_load_dwordx4 v17, s[28:31], s58 offen offset:1024 nt lds
    buffer_load_dwordx4 v18, s[28:31], s58 offen offset:2048 nt lds
    buffer_load_dwordx4 v19, s[28:31], s58 offen offset:3072 nt lds
    s_waitcnt vmcnt(44)
    s_mov_b32 m0, 86016
    s_xor_b32 s58, s55, 69632
    buffer_load_dwordx4 v20, s[28:31], s58 offen offset:0 nt lds
    buffer_load_dwordx4 v21, s[28:31], s58 offen offset:1024 nt lds
    buffer_load_dwordx4 v22, s[28:31], s58 offen offset:2048 nt lds
    buffer_load_dwordx4 v23, s[28:31], s58 offen offset:3072 nt lds
    s_waitcnt vmcnt(44)
    s_barrier
    s_mov_b32 m0, 90112
    s_xor_b32 s58, s55, 73728
    buffer_load_dwordx4 v16, s[28:31], s58 offen offset:0 nt lds
    buffer_load_dwordx4 v17, s[28:31], s58 offen offset:1024 nt lds
    buffer_load_dwordx4 v18, s[28:31], s58 offen offset:2048 nt lds
    buffer_load_dwordx4 v19, s[28:31], s58 offen offset:3072 nt lds
    s_waitcnt vmcnt(44)
    s_mov_b32 m0, 94208
    s_xor_b32 s58, s55, 77824
    buffer_load_dwordx4 v20, s[28:31], s58 offen offset:0 nt lds
    buffer_load_dwordx4 v21, s[28:31], s58 offen offset:1024 nt lds
    buffer_load_dwordx4 v22, s[28:31], s58 offen offset:2048 nt lds
    buffer_load_dwordx4 v23, s[28:31], s58 offen offset:3072 nt lds
    s_waitcnt vmcnt(44)
    s_mov_b32 m0, 98304
    s_xor_b32 s58, s55, 81920
    buffer_load_dwordx4 v16, s[28:31], s58 offen offset:0 nt lds
    buffer_load_dwordx4 v17, s[28:31], s58 offen offset:1024 nt lds
    buffer_load_dwordx4 v18, s[28:31], s58 offen offset:2048 nt lds
    buffer_load_dwordx4 v19, s[28:31], s58 offen offset:3072 nt lds
    s_waitcnt vmcnt(44)
    s_mov_b32 m0, 102400
    s_xor_b32 s58, s55, 86016
    buffer_load_dwordx4 v20, s[28:31], s58 offen offset:0 nt lds
    buffer_load_dwordx4 v21, s[28:31], s58 offen offset:1024 nt lds
    buffer_load_dwordx4 v22, s[28:31], s58 offen offset:2048 nt lds
    buffer_load_dwordx4 v23, s[28:31], s58 offen offset:3072 nt lds
    s_waitcnt vmcnt(44)
    s_barrier
    s_mov_b32 m0, 106496
    s_xor_b32 s58, s55, 90112
    buffer_load_dwordx4 v16, s[28:31], s58 offen offset:0 nt lds
    buffer_load_dwordx4 v17, s[28:31], s58 offen offset:1024 nt lds
    buffer_load_dwordx4 v18, s[28:31], s58 offen offset:2048 nt lds
    buffer_load_dwordx4 v19, s[28:31], s58 offen offset:3072 nt lds
    s_waitcnt vmcnt(44)
    s_mov_b32 m0, 110592
    s_xor_b32 s58, s55, 94208
    buffer_load_dwordx4 v20, s[28:31], s58 offen offset:0 nt lds
    buffer_load_dwordx4 v21, s[28:31], s58 offen offset:1024 nt lds
    buffer_load_dwordx4 v22, s[28:31], s58 offen offset:2048 nt lds
    buffer_load_dwordx4 v23, s[28:31], s58 offen offset:3072 nt lds
    s_waitcnt vmcnt(44)
    s_mov_b32 m0, 114688
    s_xor_b32 s58, s55, 98304
    buffer_load_dwordx4 v16, s[28:31], s58 offen offset:0 nt lds
    buffer_load_dwordx4 v17, s[28:31], s58 offen offset:1024 nt lds
    buffer_load_dwordx4 v18, s[28:31], s58 offen offset:2048 nt lds
    buffer_load_dwordx4 v19, s[28:31], s58 offen offset:3072 nt lds
    s_waitcnt vmcnt(44)
    s_mov_b32 m0, 118784
    s_xor_b32 s58, s55, 102400
    buffer_load_dwordx4 v20, s[28:31], s58 offen offset:0 nt lds
    buffer_load_dwordx4 v21, s[28:31], s58 offen offset:1024 nt lds
    buffer_load_dwordx4 v22, s[28:31], s58 offen offset:2048 nt lds
    buffer_load_dwordx4 v23, s[28:31], s58 offen offset:3072 nt lds
    s_waitcnt vmcnt(44)
    s_barrier
    s_mov_b32 m0, 122880
    s_xor_b32 s58, s55, 106496
    buffer_load_dwordx4 v16, s[28:31], s58 offen offset:0 nt lds
    buffer_load_dwordx4 v17, s[28:31], s58 offen offset:1024 nt lds
    buffer_load_dwordx4 v18, s[28:31], s58 offen offset:2048 nt lds
    buffer_load_dwordx4 v19, s[28:31], s58 offen offset:3072 nt lds
    s_waitcnt vmcnt(44)
    s_mov_b32 m0, 126976
    s_xor_b32 s58, s55, 110592
    buffer_load_dwordx4 v20, s[28:31], s58 offen offset:0 nt lds
    buffer_load_dwordx4 v21, s[28:31], s58 offen offset:1024 nt lds
    buffer_load_dwordx4 v22, s[28:31], s58 offen offset:2048 nt lds
    buffer_load_dwordx4 v23, s[28:31], s58 offen offset:3072 nt lds
    buffer_load_dword v54, v48, s[80:83], s85 offen sc1
    s_waitcnt vmcnt(44)
    s_mov_b32 m0, 131072
    s_xor_b32 s58, s55, 114688
    buffer_load_dwordx4 v16, s[28:31], s58 offen offset:0 nt lds
    buffer_load_dwordx4 v17, s[28:31], s58 offen offset:1024 nt lds
    buffer_load_dwordx4 v18, s[28:31], s58 offen offset:2048 nt lds
    buffer_load_dwordx4 v19, s[28:31], s58 offen offset:3072 nt lds
    s_waitcnt vmcnt(44)
    s_barrier
    s_mov_b32 m0, 135168
    s_xor_b32 s58, s55, 118784
    buffer_load_dwordx4 v20, s[28:31], s58 offen offset:0 nt lds
    buffer_load_dwordx4 v21, s[28:31], s58 offen offset:1024 nt lds
    buffer_load_dwordx4 v22, s[28:31], s58 offen offset:2048 nt lds
    buffer_load_dwordx4 v23, s[28:31], s58 offen offset:3072 nt lds
    s_waitcnt vmcnt(44)
    s_mov_b32 m0, 139264
    s_xor_b32 s58, s55, 122880
    buffer_load_dwordx4 v16, s[28:31], s58 offen offset:0 nt lds
    buffer_load_dwordx4 v17, s[28:31], s58 offen offset:1024 nt lds
    buffer_load_dwordx4 v18, s[28:31], s58 offen offset:2048 nt lds
    buffer_load_dwordx4 v19, s[28:31], s58 offen offset:3072 nt lds
    s_waitcnt vmcnt(44)
    s_mov_b32 m0, 143360
    s_xor_b32 s58, s55, 126976
    buffer_load_dwordx4 v20, s[28:31], s58 offen offset:0 nt lds
    buffer_load_dwordx4 v21, s[28:31], s58 offen offset:1024 nt lds
    buffer_load_dwordx4 v22, s[28:31], s58 offen offset:2048 nt lds
    buffer_load_dwordx4 v23, s[28:31], s58 offen offset:3072 nt lds
    s_waitcnt vmcnt(44)
    s_mov_b32 m0, 147456
    s_xor_b32 s58, s55, 131072
    buffer_load_dwordx4 v16, s[28:31], s58 offen offset:0 nt lds
    buffer_load_dwordx4 v17, s[28:31], s58 offen offset:1024 nt lds
    buffer_load_dwordx4 v18, s[28:31], s58 offen offset:2048 nt lds
    buffer_load_dwordx4 v19, s[28:31], s58 offen offset:3072 nt lds
    s_waitcnt vmcnt(44)
    s_mov_b32 m0, 151552
    s_xor_b32 s58, s55, 135168
    buffer_load_dwordx4 v20, s[28:31], s58 offen offset:0 nt lds
    buffer_load_dwordx4 v21, s[28:31], s58 offen offset:1024 nt lds
    buffer_load_dwordx4 v22, s[28:31], s58 offen offset:2048 nt lds
    buffer_load_dwordx4 v23, s[28:31], s58 offen offset:3072 nt lds
    s_waitcnt vmcnt(44)
    s_barrier
    s_mov_b32 m0, 155648
    s_xor_b32 s58, s55, 139264
    buffer_load_dwordx4 v16, s[28:31], s58 offen offset:0 nt lds
    buffer_load_dwordx4 v17, s[28:31], s58 offen offset:1024 nt lds
    buffer_load_dwordx4 v18, s[28:31], s58 offen offset:2048 nt lds
    buffer_load_dwordx4 v19, s[28:31], s58 offen offset:3072 nt lds
    s_waitcnt vmcnt(44)
    s_mov_b32 m0, 159744
    s_xor_b32 s58, s55, 143360
    buffer_load_dwordx4 v20, s[28:31], s58 offen offset:0 nt lds
    buffer_load_dwordx4 v21, s[28:31], s58 offen offset:1024 nt lds
    buffer_load_dwordx4 v22, s[28:31], s58 offen offset:2048 nt lds
    buffer_load_dwordx4 v23, s[28:31], s58 offen offset:3072 nt lds
    s_waitcnt vmcnt(44)
    s_mov_b32 m0, 0
    s_xor_b32 s58, s55, 147456
    buffer_load_dwordx4 v16, s[28:31], s58 offen offset:0 nt lds
    buffer_load_dwordx4 v17, s[28:31], s58 offen offset:1024 nt lds
    buffer_load_dwordx4 v18, s[28:31], s58 offen offset:2048 nt lds
    buffer_load_dwordx4 v19, s[28:31], s58 offen offset:3072 nt lds
    s_waitcnt vmcnt(44)
    s_mov_b32 m0, 4096
    s_xor_b32 s58, s55, 151552
    buffer_load_dwordx4 v20, s[28:31], s58 offen offset:0 nt lds
    buffer_load_dwordx4 v21, s[28:31], s58 offen offset:1024 nt lds
    buffer_load_dwordx4 v22, s[28:31], s58 offen offset:2048 nt lds
    buffer_load_dwordx4 v23, s[28:31], s58 offen offset:3072 nt lds
    s_waitcnt vmcnt(44)
    s_mov_b32 m0, 8192
    s_xor_b32 s58, s55, 155648
    buffer_load_dwordx4 v16, s[28:31], s58 offen offset:0 nt lds
    buffer_load_dwordx4 v17, s[28:31], s58 offen offset:1024 nt lds
    buffer_load_dwordx4 v18, s[28:31], s58 offen offset:2048 nt lds
    buffer_load_dwordx4 v19, s[28:31], s58 offen offset:3072 nt lds
    s_waitcnt vmcnt(44)
    s_barrier
    s_mov_b32 m0, 12288
    s_xor_b32 s58, s55, 159744
    buffer_load_dwordx4 v20, s[28:31], s58 offen offset:0 nt lds
    buffer_load_dwordx4 v21, s[28:31], s58 offen offset:1024 nt lds
    buffer_load_dwordx4 v22, s[28:31], s58 offen offset:2048 nt lds
    buffer_load_dwordx4 v23, s[28:31], s58 offen offset:3072 nt lds
    v_cmp_gt_u32 vcc, 1, v54
    s_nop 1
    s_cbranch_vccnz L_san
L_ban:
    s_mov_b64 exec, 1
    buffer_store_dword v53, v48, s[64:67], s90 offen offset:1024 sc1
    s_mov_b64 exec, -1
    s_waitcnt vmcnt(44)
    s_mov_b32 m0, 16384
    s_xor_b32 s58, s55, 163840
    buffer_load_dwordx4 v16, s[28:31], s58 offen offset:0 nt lds
    buffer_load_dwordx4 v17, s[28:31], s58 offen offset:1024 nt lds
    buffer_load_dwordx4 v18, s[28:31], s58 offen offset:2048 nt lds
    buffer_load_dwordx4 v19, s[28:31], s58 offen offset:3072 nt lds
    s_waitcnt vmcnt(44)
    s_mov_b32 m0, 20480
    s_xor_b32 s58, s55, 167936
    buffer_load_dwordx4 v20, s[28:31], s58 offen offset:0 nt lds
    buffer_load_dwordx4 v21, s[28:31], s58 offen offset:1024 nt lds
    buffer_load_dwordx4 v22, s[28:31], s58 offen offset:2048 nt lds
    buffer_load_dwordx4 v23, s[28:31], s58 offen offset:3072 nt lds
    s_waitcnt vmcnt(44)
    s_mov_b32 m0, 24576
    s_xor_b32 s58, s55, 172032
    buffer_load_dwordx4 v16, s[28:31], s58 offen offset:0 nt lds
    buffer_load_dwordx4 v17, s[28:31], s58 offen offset:1024 nt lds
    buffer_load_dwordx4 v18, s[28:31], s58 offen offset:2048 nt lds
    buffer_load_dwordx4 v19, s[28:31], s58 offen offset:3072 nt lds
    s_waitcnt vmcnt(44)
    s_barrier
    s_mov_b32 m0, 28672
    s_xor_b32 s58, s55, 176128
    buffer_load_dwordx4 v20, s[28:31], s58 offen offset:0 nt lds
    buffer_load_dwordx4 v21, s[28:31], s58 offen offset:1024 nt lds
    buffer_load_dwordx4 v22, s[28:31], s58 offen offset:2048 nt lds
    buffer_load_dwordx4 v23, s[28:31], s58 offen offset:3072 nt lds
    s_waitcnt vmcnt(44)
    s_mov_b32 m0, 32768
    s_xor_b32 s58, s55, 180224
    buffer_load_dwordx4 v16, s[28:31], s58 offen offset:0 nt lds
    buffer_load_dwordx4 v17, s[28:31], s58 offen offset:1024 nt lds
    buffer_load_dwordx4 v18, s[28:31], s58 offen offset:2048 nt lds
    buffer_load_dwordx4 v19, s[28:31], s58 offen offset:3072 nt lds
    s_waitcnt vmcnt(44)
    s_mov_b32 m0, 36864
    s_xor_b32 s58, s55, 184320
    buffer_load_dwordx4 v20, s[28:31], s58 offen offset:0 nt lds
    buffer_load_dwordx4 v21, s[28:31], s58 offen offset:1024 nt lds
    buffer_load_dwordx4 v22, s[28:31], s58 offen offset:2048 nt lds
    buffer_load_dwordx4 v23, s[28:31], s58 offen offset:3072 nt lds
    s_waitcnt vmcnt(44)
    s_mov_b32 m0, 40960
    s_xor_b32 s58, s55, 188416
    buffer_load_dwordx4 v16, s[28:31], s58 offen offset:0 nt lds
    buffer_load_dwordx4 v17, s[28:31], s58 offen offset:1024 nt lds
    buffer_load_dwordx4 v18, s[28:31], s58 offen offset:2048 nt lds
    buffer_load_dwordx4 v19, s[28:31], s58 offen offset:3072 nt lds
    s_waitcnt vmcnt(44)
    s_mov_b32 m0, 45056
    s_xor_b32 s58, s55, 192512
    buffer_load_dwordx4 v20, s[28:31], s58 offen offset:0 nt lds
    buffer_load_dwordx4 v21, s[28:31], s58 offen offset:1024 nt lds
    buffer_load_dwordx4 v22, s[28:31], s58 offen offset:2048 nt lds
    buffer_load_dwordx4 v23, s[28:31], s58 offen offset:3072 nt lds
    s_waitcnt vmcnt(44)
    s_barrier
    s_mov_b32 m0, 49152
    s_xor_b32 s58, s55, 196608
    buffer_load_dwordx4 v16, s[28:31], s58 offen offset:0 nt lds
    buffer_load_dwordx4 v17, s[28:31], s58 offen offset:1024 nt lds
    buffer_load_dwordx4 v18, s[28:31], s58 offen offset:2048 nt lds
    buffer_load_dwordx4 v19, s[28:31], s58 offen offset:3072 nt lds
    s_waitcnt vmcnt(44)
    s_mov_b32 m0, 53248
    s_xor_b32 s58, s55, 200704
    buffer_load_dwordx4 v20, s[28:31], s58 offen offset:0 nt lds
    buffer_load_dwordx4 v21, s[28:31], s58 offen offset:1024 nt lds
    buffer_load_dwordx4 v22, s[28:31], s58 offen offset:2048 nt lds
    buffer_load_dwordx4 v23, s[28:31], s58 offen offset:3072 nt lds
    s_waitcnt vmcnt(44)
    s_mov_b32 m0, 57344
    s_xor_b32 s58, s55, 204800
    buffer_load_dwordx4 v16, s[28:31], s58 offen offset:0 nt lds
    buffer_load_dwordx4 v17, s[28:31], s58 offen offset:1024 nt lds
    buffer_load_dwordx4 v18, s[28:31], s58 offen offset:2048 nt lds
    buffer_load_dwordx4 v19, s[28:31], s58 offen offset:3072 nt lds
    s_waitcnt vmcnt(44)
    s_mov_b32 m0, 61440
    s_xor_b32 s58, s55, 208896
    buffer_load_dwordx4 v20, s[28:31], s58 offen offset:0 nt lds
    buffer_load_dwordx4 v21, s[28:31], s58 offen offset:1024 nt lds
    buffer_load_dwordx4 v22, s[28:31], s58 offen offset:2048 nt lds
    buffer_load_dwordx4 v23, s[28:31], s58 offen offset:3072 nt lds
    buffer_load_dword v4, v3, s[36:39], s72 offen
    s_add_u32 s72, s72, 6144
    buffer_load_dword v4, v3, s[36:39], s72 offen
    s_waitcnt vmcnt(44)
    s_mov_b32 m0, 65536
    s_xor_b32 s58, s55, 212992
    buffer_load_dwordx4 v16, s[28:31], s58 offen offset:0 nt lds
    buffer_load_dwordx4 v17, s[28:31], s58 offen offset:1024 nt lds
    buffer_load_dwordx4 v18, s[28:31], s58 offen offset:2048 nt lds
    buffer_load_dwordx4 v19, s[28:31], s58 offen offset:3072 nt lds
    s_waitcnt vmcnt(44)
    s_barrier
    s_mov_b32 m0, 69632
    s_xor_b32 s58, s55, 217088
    buffer_load_dwordx4 v20, s[28:31], s58 offen offset:0 nt lds
    buffer_load_dwordx4 v21, s[28:31], s58 offen offset:1024 nt lds
    buffer_load_dwordx4 v22, s[28:31], s58 offen offset:2048 nt lds
    buffer_load_dwordx4 v23, s[28:31], s58 offen offset:3072 nt lds
    s_waitcnt vmcnt(44)
    s_mov_b32 m0, 73728
    s_xor_b32 s58, s55, 221184
    buffer_load_dwordx4 v16, s[28:31], s58 offen offset:0 nt lds
    buffer_load_dwordx4 v17, s[28:31], s58 offen offset:1024 nt lds
    buffer_load_dwordx4 v18, s[28:31], s58 offen offset:2048 nt lds
    buffer_load_dwordx4 v19, s[28:31], s58 offen offset:3072 nt lds
    s_waitcnt vmcnt(44)
    s_mov_b32 m0, 77824
    s_xor_b32 s58, s55, 225280
    buffer_load_dwordx4 v20, s[28:31], s58 offen offset:0 nt lds
    buffer_load_dwordx4 v21, s[28:31], s58 offen offset:1024 nt lds
    buffer_load_dwordx4 v22, s[28:31], s58 offen offset:2048 nt lds
    buffer_load_dwordx4 v23, s[28:31], s58 offen offset:3072 nt lds
    buffer_load_dword v55, v47, s[64:67], s84 offen offset:1024 sc1
    buffer_load_dword v56, v48, s[64:67], s89 offen sc1
    s_waitcnt vmcnt(44)
    s_mov_b32 m0, 81920
    s_xor_b32 s58, s55, 229376
    buffer_load_dwordx4 v16, s[28:31], s58 offen offset:0 nt lds
    buffer_load_dwordx4 v17, s[28:31], s58 offen offset:1024 nt lds
    buffer_load_dwordx4 v18, s[28:31], s58 offen offset:2048 nt lds
    buffer_load_dwordx4 v19, s[28:31], s58 offen offset:3072 nt lds
    s_waitcnt vmcnt(44)
    s_barrier
    s_mov_b32 m0, 86016
    s_xor_b32 s58, s55, 233472
    buffer_load_dwordx4 v20, s[28:31], s58 offen offset:0 nt lds
    buffer_load_dwordx4 v21, s[28:31], s58 offen offset:1024 nt lds
    buffer_load_dwordx4 v22, s[28:31], s58 offen offset:2048 nt lds
    buffer_load_dwordx4 v23, s[28:31], s58 offen offset:3072 nt lds
    s_waitcnt vmcnt(44)
    s_mov_b32 m0, 90112
    s_xor_b32 s58, s55, 237568
    buffer_load_dwordx4 v16, s[28:31], s58 offen offset:0 nt lds
    buffer_load_dwordx4 v17, s[28:31], s58 offen offset:1024 nt lds
    buffer_load_dwordx4 v18, s[28:31], s58 offen offset:2048 nt lds
    buffer_load_dwordx4 v19, s[28:31], s58 offen offset:3072 nt lds
    s_waitcnt vmcnt(44)
    s_mov_b32 m0, 94208
    s_xor_b32 s58, s55, 241664
    buffer_load_dwordx4 v20, s[28:31], s58 offen offset:0 nt lds
    buffer_load_dwordx4 v21, s[28:31], s58 offen offset:1024 nt lds
    buffer_load_dwordx4 v22, s[28:31], s58 offen offset:2048 nt lds
    buffer_load_dwordx4 v23, s[28:31], s58 offen offset:3072 nt lds
    s_waitcnt vmcnt(44)
    s_mov_b32 m0, 98304
    s_xor_b32 s58, s55, 245760
    buffer_load_dwordx4 v16, s[28:31], s58 offen offset:0 nt lds
    buffer_load_dwordx4 v17, s[28:31], s58 offen offset:1024 nt lds
    buffer_load_dwordx4 v18, s[28:31], s58 offen offset:2048 nt lds
    buffer_load_dwordx4 v19, s[28:31], s58 offen offset:3072 nt lds
    s_waitcnt vmcnt(44)
    s_barrier
    s_mov_b32 m0, 102400
    s_xor_b32 s58, s55, 249856
    buffer_load_dwordx4 v20, s[28:31], s58 offen offset:0 nt lds
    buffer_load_dwordx4 v21, s[28:31], s58 offen offset:1024 nt lds
    buffer_load_dwordx4 v22, s[28:31], s58 offen offset:2048 nt lds
    buffer_load_dwordx4 v23, s[28:31], s58 offen offset:3072 nt lds
    s_waitcnt vmcnt(44)
    s_mov_b32 m0, 106496
    s_xor_b32 s58, s55, 253952
    buffer_load_dwordx4 v16, s[28:31], s58 offen offset:0 nt lds
    buffer_load_dwordx4 v17, s[28:31], s58 offen offset:1024 nt lds
    buffer_load_dwordx4 v18, s[28:31], s58 offen offset:2048 nt lds
    buffer_load_dwordx4 v19, s[28:31], s58 offen offset:3072 nt lds
    s_waitcnt vmcnt(44)
    s_mov_b32 m0, 110592
    s_xor_b32 s58, s55, 258048
    buffer_load_dwordx4 v20, s[28:31], s58 offen offset:0 nt lds
    buffer_load_dwordx4 v21, s[28:31], s58 offen offset:1024 nt lds
    buffer_load_dwordx4 v22, s[28:31], s58 offen offset:2048 nt lds
    buffer_load_dwordx4 v23, s[28:31], s58 offen offset:3072 nt lds
    s_waitcnt vmcnt(44)
    s_mov_b32 m0, 114688
    s_xor_b32 s58, s56, 0
    buffer_load_dwordx4 v24, s[32:35], s58 offen offset:0 nt lds
    buffer_load_dwordx4 v25, s[32:35], s58 offen offset:1024 nt lds
    buffer_load_dwordx4 v26, s[32:35], s58 offen offset:2048 nt lds
    buffer_load_dwordx4 v27, s[32:35], s58 offen offset:3072 nt lds
    s_waitcnt vmcnt(44)
    s_mov_b32 m0, 118784
    s_xor_b32 s58, s56, 8192
    buffer_load_dwordx4 v24, s[32:35], s58 offen offset:0 nt lds
    buffer_load_dwordx4 v25, s[32:35], s58 offen offset:1024 nt lds
    buffer_load_dwordx4 v26, s[32:35], s58 offen offset:2048 nt lds
    buffer_load_dwordx4 v27, s[32:35], s58 offen offset:3072 nt lds
    s_waitcnt vmcnt(44)
    s_barrier
    s_mov_b32 m0, 122880
    s_xor_b32 s58, s56, 16384
    buffer_load_dwordx4 v24, s[32:35], s58 offen offset:0 nt lds
    buffer_load_dwordx4 v25, s[32:35], s58 offen offset:1024 nt lds
    buffer_load_dwordx4 v26, s[32:35], s58 offen offset:2048 nt lds
    buffer_load_dwordx4 v27, s[32:35], s58 offen offset:3072 nt lds
    s_waitcnt vmcnt(44)
    s_mov_b32 m0, 126976
    s_xor_b32 s58, s56, 24576
    buffer_load_dwordx4 v24, s[32:35], s58 offen offset:0 nt lds
    buffer_load_dwordx4 v25, s[32:35], s58 offen offset:1024 nt lds
    buffer_load_dwordx4 v26, s[32:35], s58 offen offset:2048 nt lds
    buffer_load_dwordx4 v27, s[32:35], s58 offen offset:3072 nt lds
    v_cmp_gt_u32 vcc, 16, v55
    s_nop 1
    s_cbranch_vccnz L_sid
L_bid:
    s_waitcnt vmcnt(44)
    s_mov_b32 m0, 131072
    s_xor_b32 s58, s56, 32768
    buffer_load_dwordx4 v24, s[32:35], s58 offen offset:0 nt lds
    buffer_load_dwordx4 v25, s[32:35], s58 offen offset:1024 nt lds
    buffer_load_dwordx4 v26, s[32:35], s58 offen offset:2048 nt lds
    buffer_load_dwordx4 v27, s[32:35], s58 offen offset:3072 nt lds
    s_waitcnt vmcnt(44)
    s_mov_b32 m0, 135168
    s_xor_b32 s58, s56, 40960
    buffer_load_dwordx4 v24, s[32:35], s58 offen offset:0 nt lds
    buffer_load_dwordx4 v25, s[32:35], s58 offen offset:1024 nt lds
    buffer_load_dwordx4 v26, s[32:35], s58 offen offset:2048 nt lds
    buffer_load_dwordx4 v27, s[32:35], s58 offen offset:3072 nt lds
    s_waitcnt vmcnt(44)
    s_barrier
    s_mov_b32 m0, 139264
    s_xor_b32 s58, s56, 49152
    buffer_load_dwordx4 v24, s[32:35], s58 offen offset:0 nt lds
    buffer_load_dwordx4 v25, s[32:35], s58 offen offset:1024 nt lds
    buffer_load_dwordx4 v26, s[32:35], s58 offen offset:2048 nt lds
    buffer_load_dwordx4 v27, s[32:35], s58 offen offset:3072 nt lds
    s_waitcnt vmcnt(44)
    s_mov_b32 m0, 143360
    s_xor_b32 s58, s56, 57344
    buffer_load_dwordx4 v24, s[32:35], s58 offen offset:0 nt lds
    buffer_load_dwordx4 v25, s[32:35], s58 offen offset:1024 nt lds
    buffer_load_dwordx4 v26, s[32:35], s58 offen offset:2048 nt lds
    buffer_load_dwordx4 v27, s[32:35], s58 offen offset:3072 nt lds
    s_waitcnt vmcnt(44)
    s_mov_b32 m0, 147456
    s_xor_b32 s58, s56, 65536
    buffer_load_dwordx4 v24, s[32:35], s58 offen offset:0 nt lds
    buffer_load_dwordx4 v25, s[32:35], s58 offen offset:1024 nt lds
    buffer_load_dwordx4 v26, s[32:35], s58 offen offset:2048 nt lds
    buffer_load_dwordx4 v27, s[32:35], s58 offen offset:3072 nt lds
    s_waitcnt vmcnt(44)
    s_mov_b32 m0, 151552
    s_xor_b32 s58, s56, 73728
    buffer_load_dwordx4 v24, s[32:35], s58 offen offset:0 nt lds
    buffer_load_dwordx4 v25, s[32:35], s58 offen offset:1024 nt lds
    buffer_load_dwordx4 v26, s[32:35], s58 offen offset:2048 nt lds
    buffer_load_dwordx4 v27, s[32:35], s58 offen offset:3072 nt lds
    s_waitcnt vmcnt(44)
    s_barrier
    s_mov_b32 m0, 155648
    s_xor_b32 s58, s56, 81920
    buffer_load_dwordx4 v24, s[32:35], s58 offen offset:0 nt lds
    buffer_load_dwordx4 v25, s[32:35], s58 offen offset:1024 nt lds
    buffer_load_dwordx4 v26, s[32:35], s58 offen offset:2048 nt lds
    buffer_load_dwordx4 v27, s[32:35], s58 offen offset:3072 nt lds
    s_waitcnt vmcnt(44)
    s_mov_b32 m0, 159744
    s_xor_b32 s58, s56, 90112
    buffer_load_dwordx4 v24, s[32:35], s58 offen offset:0 nt lds
    buffer_load_dwordx4 v25, s[32:35], s58 offen offset:1024 nt lds
    buffer_load_dwordx4 v26, s[32:35], s58 offen offset:2048 nt lds
    buffer_load_dwordx4 v27, s[32:35], s58 offen offset:3072 nt lds
    s_waitcnt vmcnt(44)
    s_mov_b32 m0, 0
    s_xor_b32 s58, s56, 98304
    buffer_load_dwordx4 v24, s[32:35], s58 offen offset:0 nt lds
    buffer_load_dwordx4 v25, s[32:35], s58 offen offset:1024 nt lds
    buffer_load_dwordx4 v26, s[32:35], s58 offen offset:2048 nt lds
    buffer_load_dwordx4 v27, s[32:35], s58 offen offset:3072 nt lds
    s_waitcnt vmcnt(44)
    s_mov_b32 m0, 4096
    s_xor_b32 s58, s56, 106496
    buffer_load_dwordx4 v24, s[32:35], s58 offen offset:0 nt lds
    buffer_load_dwordx4 v25, s[32:35], s58 offen offset:1024 nt lds
    buffer_load_dwordx4 v26, s[32:35], s58 offen offset:2048 nt lds
    buffer_load_dwordx4 v27, s[32:35], s58 offen offset:3072 nt lds
    s_waitcnt vmcnt(44)
    s_mov_b32 m0, 8192
    s_xor_b32 s58, s56, 114688
    buffer_load_dwordx4 v24, s[32:35], s58 offen offset:0 nt lds
    buffer_load_dwordx4 v25, s[32:35], s58 offen offset:1024 nt lds
    buffer_load_dwordx4 v26, s[32:35], s58 offen offset:2048 nt lds
    buffer_load_dwordx4 v27, s[32:35], s58 offen offset:3072 nt lds
    s_waitcnt vmcnt(44)
    s_barrier
    s_mov_b32 m0, 12288
    s_xor_b32 s58, s56, 122880
    buffer_load_dwordx4 v24, s[32:35], s58 offen offset:0 nt lds
    buffer_load_dwordx4 v25, s[32:35], s58 offen offset:1024 nt lds
    buffer_load_dwordx4 v26, s[32:35], s58 offen offset:2048 nt lds
    buffer_load_dwordx4 v27, s[32:35], s58 offen offset:3072 nt lds
    s_waitcnt vmcnt(44)
    s_mov_b32 m0, 16384
    s_xor_b32 s58, s56, 131072
    buffer_load_dwordx4 v24, s[32:35], s58 offen offset:0 nt lds
    buffer_load_dwordx4 v25, s[32:35], s58 offen offset:1024 nt lds
    buffer_load_dwordx4 v26, s[32:35], s58 offen offset:2048 nt lds
    buffer_load_dwordx4 v27, s[32:35], s58 offen offset:3072 nt lds
    s_waitcnt vmcnt(44)
    s_mov_b32 m0, 20480
    s_xor_b32 s58, s56, 139264
    buffer_load_dwordx4 v24, s[32:35], s58 offen offset:0 nt lds
    buffer_load_dwordx4 v25, s[32:35], s58 offen offset:1024 nt lds
    buffer_load_dwordx4 v26, s[32:35], s58 offen offset:2048 nt lds
    buffer_load_dwordx4 v27, s[32:35], s58 offen offset:3072 nt lds
    s_waitcnt vmcnt(44)
    s_mov_b32 m0, 24576
    s_xor_b32 s58, s56, 147456
    buffer_load_dwordx4 v24, s[32:35], s58 offen offset:0 nt lds
    buffer_load_dwordx4 v25, s[32:35], s58 offen offset:1024 nt lds
    buffer_load_dwordx4 v26, s[32:35], s58 offen offset:2048 nt lds
    buffer_load_dwordx4 v27, s[32:35], s58 offen offset:3072 nt lds
    s_waitcnt vmcnt(44)
    s_barrier
    s_mov_b32 m0, 28672
    s_xor_b32 s58, s56, 155648
    buffer_load_dwordx4 v24, s[32:35], s58 offen offset:0 nt lds
    buffer_load_dwordx4 v25, s[32:35], s58 offen offset:1024 nt lds
    buffer_load_dwordx4 v26, s[32:35], s58 offen offset:2048 nt lds
    buffer_load_dwordx4 v27, s[32:35], s58 offen offset:3072 nt lds
    s_waitcnt vmcnt(44)
    s_mov_b32 m0, 32768
    s_xor_b32 s58, s56, 163840
    buffer_load_dwordx4 v24, s[32:35], s58 offen offset:0 nt lds
    buffer_load_dwordx4 v25, s[32:35], s58 offen offset:1024 nt lds
    buffer_load_dwordx4 v26, s[32:35], s58 offen offset:2048 nt lds
    buffer_load_dwordx4 v27, s[32:35], s58 offen offset:3072 nt lds
    s_waitcnt vmcnt(44)
    s_mov_b32 m0, 36864
    s_xor_b32 s58, s56, 172032
    buffer_load_dwordx4 v24, s[32:35], s58 offen offset:0 nt lds
    buffer_load_dwordx4 v25, s[32:35], s58 offen offset:1024 nt lds
    buffer_load_dwordx4 v26, s[32:35], s58 offen offset:2048 nt lds
    buffer_load_dwordx4 v27, s[32:35], s58 offen offset:3072 nt lds
    s_waitcnt vmcnt(44)
    s_mov_b32 m0, 40960
    s_xor_b32 s58, s56, 180224
    buffer_load_dwordx4 v24, s[32:35], s58 offen offset:0 nt lds
    buffer_load_dwordx4 v25, s[32:35], s58 offen offset:1024 nt lds
    buffer_load_dwordx4 v26, s[32:35], s58 offen offset:2048 nt lds
    buffer_load_dwordx4 v27, s[32:35], s58 offen offset:3072 nt lds
    s_waitcnt vmcnt(44)
    s_barrier
    s_mov_b32 m0, 45056
    s_xor_b32 s58, s56, 188416
    buffer_load_dwordx4 v24, s[32:35], s58 offen offset:0 nt lds
    buffer_load_dwordx4 v25, s[32:35], s58 offen offset:1024 nt lds
    buffer_load_dwordx4 v26, s[32:35], s58 offen offset:2048 nt lds
    buffer_load_dwordx4 v27, s[32:35], s58 offen offset:3072 nt lds
    s_waitcnt vmcnt(44)
    s_mov_b32 m0, 49152
    s_xor_b32 s58, s56, 196608
    buffer_load_dwordx4 v24, s[32:35], s58 offen offset:0 nt lds
    buffer_load_dwordx4 v25, s[32:35], s58 offen offset:1024 nt lds
    buffer_load_dwordx4 v26, s[32:35], s58 offen offset:2048 nt lds
    buffer_load_dwordx4 v27, s[32:35], s58 offen offset:3072 nt lds
    s_waitcnt vmcnt(44)
    s_mov_b32 m0, 53248
    s_xor_b32 s58, s56, 204800
    buffer_load_dwordx4 v24, s[32:35], s58 offen offset:0 nt lds
    buffer_load_dwordx4 v25, s[32:35], s58 offen offset:1024 nt lds
    buffer_load_dwordx4 v26, s[32:35], s58 offen offset:2048 nt lds
    buffer_load_dwordx4 v27, s[32:35], s58 offen offset:3072 nt lds
    s_waitcnt vmcnt(44)
    s_mov_b32 m0, 57344
    s_xor_b32 s58, s56, 212992
    buffer_load_dwordx4 v24, s[32:35], s58 offen offset:0 nt lds
    buffer_load_dwordx4 v25, s[32:35], s58 offen offset:1024 nt lds
    buffer_load_dwordx4 v26, s[32:35], s58 offen offset:2048 nt lds
    buffer_load_dwordx4 v27, s[32:35], s58 offen offset:3072 nt lds
    s_waitcnt vmcnt(44)
    s_barrier
    s_mov_b32 m0, 61440
    s_xor_b32 s58, s56, 221184
    buffer_load_dwordx4 v24, s[32:35], s58 offen offset:0 nt lds
    buffer_load_dwordx4 v25, s[32:35], s58 offen offset:1024 nt lds
    buffer_load_dwordx4 v26, s[32:35], s58 offen offset:2048 nt lds
    buffer_load_dwordx4 v27, s[32:35], s58 offen offset:3072 nt lds
    s_waitcnt vmcnt(44)
    s_mov_b32 m0, 65536
    s_xor_b32 s58, s56, 229376
    buffer_load_dwordx4 v24, s[32:35], s58 offen offset:0 nt lds
    buffer_load_dwordx4 v25, s[32:35], s58 offen offset:1024 nt lds
    buffer_load_dwordx4 v26, s[32:35], s58 offen offset:2048 nt lds
    buffer_load_dwordx4 v27, s[32:35], s58 offen offset:3072 nt lds
    s_waitcnt vmcnt(44)
    s_mov_b32 m0, 69632
    s_xor_b32 s58, s56, 237568
    buffer_load_dwordx4 v24, s[32:35], s58 offen offset:0 nt lds
    buffer_load_dwordx4 v25, s[32:35], s58 offen offset:1024 nt lds
    buffer_load_dwordx4 v26, s[32:35], s58 offen offset:2048 nt lds
    buffer_load_dwordx4 v27, s[32:35], s58 offen offset:3072 nt lds
    s_waitcnt vmcnt(44)
    s_mov_b32 m0, 73728
    s_xor_b32 s58, s56, 245760
    buffer_load_dwordx4 v24, s[32:35], s58 offen offset:0 nt lds
    buffer_load_dwordx4 v25, s[32:35], s58 offen offset:1024 nt lds
    buffer_load_dwordx4 v26, s[32:35], s58 offen offset:2048 nt lds
    buffer_load_dwordx4 v27, s[32:35], s58 offen offset:3072 nt lds
    s_waitcnt vmcnt(44)
    s_barrier
    s_mov_b32 m0, 77824
    s_xor_b32 s58, s56, 253952
    buffer_load_dwordx4 v24, s[32:35], s58 offen offset:0 nt lds
    buffer_load_dwordx4 v25, s[32:35], s58 offen offset:1024 nt lds
    buffer_load_dwordx4 v26, s[32:35], s58 offen offset:2048 nt lds
    buffer_load_dwordx4 v27, s[32:35], s58 offen offset:3072 nt lds
    s_waitcnt vmcnt(44)
    s_mov_b32 m0, 81920
    s_xor_b32 s58, s57, 0
    buffer_load_dwordx4 v24, s[32:35], s58 offen offset:0 nt lds
    buffer_load_dwordx4 v25, s[32:35], s58 offen offset:1024 nt lds
    buffer_load_dwordx4 v26, s[32:35], s58 offen offset:2048 nt lds
    buffer_load_dwordx4 v27, s[32:35], s58 offen offset:3072 nt lds
    s_waitcnt vmcnt(44)
    s_mov_b32 m0, 86016
    s_xor_b32 s58, s57, 8192
    buffer_load_dwordx4 v24, s[32:35], s58 offen offset:0 nt lds
    buffer_load_dwordx4 v25, s[32:35], s58 offen offset:1024 nt lds
    buffer_load_dwordx4 v26, s[32:35], s58 offen offset:2048 nt lds
    buffer_load_dwordx4 v27, s[32:35], s58 offen offset:3072 nt lds
    s_waitcnt vmcnt(44)
    s_mov_b32 m0, 90112
    s_xor_b32 s58, s57, 16384
    buffer_load_dwordx4 v24, s[32:35], s58 offen offset:0 nt lds
    buffer_load_dwordx4 v25, s[32:35], s58 offen offset:1024 nt lds
    buffer_load_dwordx4 v26, s[32:35], s58 offen offset:2048 nt lds
    buffer_load_dwordx4 v27, s[32:35], s58 offen offset:3072 nt lds
    s_waitcnt vmcnt(44)
    s_barrier
    s_mov_b32 m0, 94208
    s_xor_b32 s58, s57, 24576
    buffer_load_dwordx4 v24, s[32:35], s58 offen offset:0 nt lds
    buffer_load_dwordx4 v25, s[32:35], s58 offen offset:1024 nt lds
    buffer_load_dwordx4 v26, s[32:35], s58 offen offset:2048 nt lds
    buffer_load_dwordx4 v27, s[32:35], s58 offen offset:3072 nt lds
    s_waitcnt vmcnt(44)
    s_mov_b32 m0, 98304
    s_xor_b32 s58, s57, 32768
    buffer_load_dwordx4 v24, s[32:35], s58 offen offset:0 nt lds
    buffer_load_dwordx4 v25, s[32:35], s58 offen offset:1024 nt lds
    buffer_load_dwordx4 v26, s[32:35], s58 offen offset:2048 nt lds
    buffer_load_dwordx4 v27, s[32:35], s58 offen offset:3072 nt lds
    s_waitcnt vmcnt(44)
    s_mov_b32 m0, 102400
    s_xor_b32 s58, s57, 40960
    buffer_load_dwordx4 v24, s[32:35], s58 offen offset:0 nt lds
    buffer_load_dwordx4 v25, s[32:35], s58 offen offset:1024 nt lds
    buffer_load_dwordx4 v26, s[32:35], s58 offen offset:2048 nt lds
    buffer_load_dwordx4 v27, s[32:35], s58 offen offset:3072 nt lds
    s_waitcnt vmcnt(44)
    s_barrier
    s_mov_b32 m0, 106496
    s_xor_b32 s58, s57, 49152
    buffer_load_dwordx4 v24, s[32:35], s58 offen offset:0 nt lds
    buffer_load_dwordx4 v25, s[32:35], s58 offen offset:1024 nt lds
    buffer_load_dwordx4 v26, s[32:35], s58 offen offset:2048 nt lds
    buffer_load_dwordx4 v27, s[32:35], s58 offen offset:3072 nt lds
    s_waitcnt vmcnt(44)
    s_mov_b32 m0, 110592
    s_xor_b32 s58, s57, 57344
    buffer_load_dwordx4 v24, s[32:35], s58 offen offset:0 nt lds
    buffer_load_dwordx4 v25, s[32:35], s58 offen offset:1024 nt lds
    buffer_load_dwordx4 v26, s[32:35], s58 offen offset:2048 nt lds
    buffer_load_dwordx4 v27, s[32:35], s58 offen offset:3072 nt lds
    s_waitcnt vmcnt(44)
    s_mov_b32 m0, 114688
    s_xor_b32 s58, s57, 65536
    buffer_load_dwordx4 v24, s[32:35], s58 offen offset:0 nt lds
    buffer_load_dwordx4 v25, s[32:35], s58 offen offset:1024 nt lds
    buffer_load_dwordx4 v26, s[32:35], s58 offen offset:2048 nt lds
    buffer_load_dwordx4 v27, s[32:35], s58 offen offset:3072 nt lds
    s_waitcnt vmcnt(44)
    s_mov_b32 m0, 118784
    s_xor_b32 s58, s57, 73728
    buffer_load_dwordx4 v24, s[32:35], s58 offen offset:0 nt lds
    buffer_load_dwordx4 v25, s[32:35], s58 offen offset:1024 nt lds
    buffer_load_dwordx4 v26, s[32:35], s58 offen offset:2048 nt lds
    buffer_load_dwordx4 v27, s[32:35], s58 offen offset:3072 nt lds
    s_waitcnt vmcnt(44)
    s_barrier
    s_mov_b32 m0, 122880
    s_xor_b32 s58, s57, 81920
    buffer_load_dwordx4 v24, s[32:35], s58 offen offset:0 nt lds
    buffer_load_dwordx4 v25, s[32:35], s58 offen offset:1024 nt lds
    buffer_load_dwordx4 v26, s[32:35], s58 offen offset:2048 nt lds
    buffer_load_dwordx4 v27, s[32:35], s58 offen offset:3072 nt lds
    s_waitcnt vmcnt(44)
    s_mov_b32 m0, 126976
    s_xor_b32 s58, s57, 90112
    buffer_load_dwordx4 v24, s[32:35], s58 offen offset:0 nt lds
    buffer_load_dwordx4 v25, s[32:35], s58 offen offset:1024 nt lds
    buffer_load_dwordx4 v26, s[32:35], s58 offen offset:2048 nt lds
    buffer_load_dwordx4 v27, s[32:35], s58 offen offset:3072 nt lds
    s_waitcnt vmcnt(44)
    s_mov_b32 m0, 131072
    s_xor_b32 s58, s57, 98304
    buffer_load_dwordx4 v24, s[32:35], s58 offen offset:0 nt lds
    buffer_load_dwordx4 v25, s[32:35], s58 offen offset:1024 nt lds
    buffer_load_dwordx4 v26, s[32:35], s58 offen offset:2048 nt lds
    buffer_load_dwordx4 v27, s[32:35], s58 offen offset:3072 nt lds
    s_waitcnt vmcnt(44)
    s_mov_b32 m0, 135168
    s_xor_b32 s58, s57, 106496
    buffer_load_dwordx4 v24, s[32:35], s58 offen offset:0 nt lds
    buffer_load_dwordx4 v25, s[32:35], s58 offen offset:1024 nt lds
    buffer_load_dwordx4 v26, s[32:35], s58 offen offset:2048 nt lds
    buffer_load_dwordx4 v27, s[32:35], s58 offen offset:3072 nt lds
    s_waitcnt vmcnt(44)
    s_barrier
    s_mov_b32 m0, 139264
    s_xor_b32 s58, s57, 114688
    buffer_load_dwordx4 v24, s[32:35], s58 offen offset:0 nt lds
    buffer_load_dwordx4 v25, s[32:35], s58 offen offset:1024 nt lds
    buffer_load_dwordx4 v26, s[32:35], s58 offen offset:2048 nt lds
    buffer_load_dwordx4 v27, s[32:35], s58 offen offset:3072 nt lds
    s_waitcnt vmcnt(44)
    s_mov_b32 m0, 143360
    s_xor_b32 s58, s57, 122880
    buffer_load_dwordx4 v24, s[32:35], s58 offen offset:0 nt lds
    buffer_load_dwordx4 v25, s[32:35], s58 offen offset:1024 nt lds
    buffer_load_dwordx4 v26, s[32:35], s58 offen offset:2048 nt lds
    buffer_load_dwordx4 v27, s[32:35], s58 offen offset:3072 nt lds
    s_waitcnt vmcnt(44)
    s_mov_b32 m0, 147456
    s_xor_b32 s58, s57, 131072
    buffer_load_dwordx4 v24, s[32:35], s58 offen offset:0 nt lds
    buffer_load_dwordx4 v25, s[32:35], s58 offen offset:1024 nt lds
    buffer_load_dwordx4 v26, s[32:35], s58 offen offset:2048 nt lds
    buffer_load_dwordx4 v27, s[32:35], s58 offen offset:3072 nt lds
    s_waitcnt vmcnt(44)
    s_mov_b32 m0, 151552
    s_xor_b32 s58, s57, 139264
    buffer_load_dwordx4 v24, s[32:35], s58 offen offset:0 nt lds
    buffer_load_dwordx4 v25, s[32:35], s58 offen offset:1024 nt lds
    buffer_load_dwordx4 v26, s[32:35], s58 offen offset:2048 nt lds
    buffer_load_dwordx4 v27, s[32:35], s58 offen offset:3072 nt lds
    s_waitcnt vmcnt(44)
    s_barrier
    s_mov_b32 m0, 155648
    s_xor_b32 s58, s57, 147456
    buffer_load_dwordx4 v24, s[32:35], s58 offen offset:0 nt lds
    buffer_load_dwordx4 v25, s[32:35], s58 offen offset:1024 nt lds
    buffer_load_dwordx4 v26, s[32:35], s58 offen offset:2048 nt lds
    buffer_load_dwordx4 v27, s[32:35], s58 offen offset:3072 nt lds
    s_waitcnt vmcnt(44)
    s_mov_b32 m0, 159744
    s_xor_b32 s58, s57, 155648
    buffer_load_dwordx4 v24, s[32:35], s58 offen offset:0 nt lds
    buffer_load_dwordx4 v25, s[32:35], s58 offen offset:1024 nt lds
    buffer_load_dwordx4 v26, s[32:35], s58 offen offset:2048 nt lds
    buffer_load_dwordx4 v27, s[32:35], s58 offen offset:3072 nt lds
    s_waitcnt vmcnt(44)
    s_mov_b32 m0, 0
    s_xor_b32 s58, s57, 163840
    buffer_load_dwordx4 v24, s[32:35], s58 offen offset:0 nt lds
    buffer_load_dwordx4 v25, s[32:35], s58 offen offset:1024 nt lds
    buffer_load_dwordx4 v26, s[32:35], s58 offen offset:2048 nt lds
    buffer_load_dwordx4 v27, s[32:35], s58 offen offset:3072 nt lds
    s_waitcnt vmcnt(44)
    s_mov_b32 m0, 4096
    s_xor_b32 s58, s57, 172032
    buffer_load_dwordx4 v24, s[32:35], s58 offen offset:0 nt lds
    buffer_load_dwordx4 v25, s[32:35], s58 offen offset:1024 nt lds
    buffer_load_dwordx4 v26, s[32:35], s58 offen offset:2048 nt lds
    buffer_load_dwordx4 v27, s[32:35], s58 offen offset:3072 nt lds
    s_waitcnt vmcnt(44)
    s_barrier
    s_mov_b32 m0, 8192
    s_xor_b32 s58, s57, 180224
    buffer_load_dwordx4 v24, s[32:35], s58 offen offset:0 nt lds
    buffer_load_dwordx4 v25, s[32:35], s58 offen offset:1024 nt lds
    buffer_load_dwordx4 v26, s[32:35], s58 offen offset:2048 nt lds
    buffer_load_dwordx4 v27, s[32:35], s58 offen offset:3072 nt lds
    s_waitcnt vmcnt(44)
    s_mov_b32 m0, 12288
    s_xor_b32 s58, s57, 188416
    buffer_load_dwordx4 v24, s[32:35], s58 offen offset:0 nt lds
    buffer_load_dwordx4 v25, s[32:35], s58 offen offset:1024 nt lds
    buffer_load_dwordx4 v26, s[32:35], s58 offen offset:2048 nt lds
    buffer_load_dwordx4 v27, s[32:35], s58 offen offset:3072 nt lds
    s_waitcnt vmcnt(44)
    s_mov_b32 m0, 16384
    s_xor_b32 s58, s57, 196608
    buffer_load_dwordx4 v24, s[32:35], s58 offen offset:0 nt lds
    buffer_load_dwordx4 v25, s[32:35], s58 offen offset:1024 nt lds
    buffer_load_dwordx4 v26, s[32:35], s58 offen offset:2048 nt lds
    buffer_load_dwordx4 v27, s[32:35], s58 offen offset:3072 nt lds
    s_waitcnt vmcnt(44)
    s_barrier
    s_mov_b32 m0, 20480
    s_xor_b32 s58, s57, 204800
    buffer_load_dwordx4 v24, s[32:35], s58 offen offset:0 nt lds
    buffer_load_dwordx4 v25, s[32:35], s58 offen offset:1024 nt lds
    buffer_load_dwordx4 v26, s[32:35], s58 offen offset:2048 nt lds
    buffer_load_dwordx4 v27, s[32:35], s58 offen offset:3072 nt lds
    s_waitcnt vmcnt(44)
    s_mov_b32 m0, 24576
    s_xor_b32 s58, s57, 212992
    buffer_load_dwordx4 v24, s[32:35], s58 offen offset:0 nt lds
    buffer_load_dwordx4 v25, s[32:35], s58 offen offset:1024 nt lds
    buffer_load_dwordx4 v26, s[32:35], s58 offen offset:2048 nt lds
    buffer_load_dwordx4 v27, s[32:35], s58 offen offset:3072 nt lds
    s_waitcnt vmcnt(44)
    s_mov_b32 m0, 28672
    s_xor_b32 s58, s57, 221184
    buffer_load_dwordx4 v24, s[32:35], s58 offen offset:0 nt lds
    buffer_load_dwordx4 v25, s[32:35], s58 offen offset:1024 nt lds
    buffer_load_dwordx4 v26, s[32:35], s58 offen offset:2048 nt lds
    buffer_load_dwordx4 v27, s[32:35], s58 offen offset:3072 nt lds
    s_waitcnt vmcnt(44)
    s_mov_b32 m0, 32768
    s_xor_b32 s58, s57, 229376
    buffer_load_dwordx4 v24, s[32:35], s58 offen offset:0 nt lds
    buffer_load_dwordx4 v25, s[32:35], s58 offen offset:1024 nt lds
    buffer_load_dwordx4 v26, s[32:35], s58 offen offset:2048 nt lds
    buffer_load_dwordx4 v27, s[32:35], s58 offen offset:3072 nt lds
    s_waitcnt vmcnt(44)
    s_barrier
    s_mov_b32 m0, 36864
    s_xor_b32 s58, s57, 237568
    buffer_load_dwordx4 v24, s[32:35], s58 offen offset:0 nt lds
    buffer_load_dwordx4 v25, s[32:35], s58 offen offset:1024 nt lds
    buffer_load_dwordx4 v26, s[32:35], s58 offen offset:2048 nt lds
    buffer_load_dwordx4 v27, s[32:35], s58 offen offset:3072 nt lds
    s_waitcnt vmcnt(44)
    s_mov_b32 m0, 40960
    s_xor_b32 s58, s57, 245760
    buffer_load_dwordx4 v24, s[32:35], s58 offen offset:0 nt lds
    buffer_load_dwordx4 v25, s[32:35], s58 offen offset:1024 nt lds
    buffer_load_dwordx4 v26, s[32:35], s58 offen offset:2048 nt lds
    buffer_load_dwordx4 v27, s[32:35], s58 offen offset:3072 nt lds
    s_waitcnt vmcnt(44)
    s_mov_b32 m0, 45056
    s_xor_b32 s58, s57, 253952
    buffer_load_dwordx4 v24, s[32:35], s58 offen offset:0 nt lds
    buffer_load_dwordx4 v25, s[32:35], s58 offen offset:1024 nt lds
    buffer_load_dwordx4 v26, s[32:35], s58 offen offset:2048 nt lds
    buffer_load_dwordx4 v27, s[32:35], s58 offen offset:3072 nt lds
    s_waitcnt vmcnt(44)
    s_mov_b32 m0, 49152
    s_add_u32 s58, s68, 0
    buffer_load_dwordx4 v28, s[36:39], s58 offen offset:0 lds
    buffer_load_dwordx4 v29, s[36:39], s58 offen offset:1024 lds
    buffer_load_dwordx4 v30, s[36:39], s58 offen offset:2048 lds
    buffer_load_dwordx4 v31, s[36:39], s58 offen offset:3072 lds
    s_waitcnt vmcnt(44)
    s_barrier
    s_mov_b32 m0, 53248
    s_add_u32 s58, s68, 28672
    buffer_load_dwordx4 v28, s[36:39], s58 offen offset:0 lds
    buffer_load_dwordx4 v29, s[36:39], s58 offen offset:1024 lds
    buffer_load_dwordx4 v30, s[36:39], s58 offen offset:2048 lds
    buffer_load_dwordx4 v31, s[36:39], s58 offen offset:3072 lds
    s_waitcnt vmcnt(44)
    s_mov_b32 m0, 57344
    s_add_u32 s58, s68, 57344
    buffer_load_dwordx4 v28, s[36:39], s58 offen offset:0 lds
    buffer_load_dwordx4 v29, s[36:39], s58 offen offset:1024 lds
    buffer_load_dwordx4 v30, s[36:39], s58 offen offset:2048 lds
    buffer_load_dwordx4 v31, s[36:39], s58 offen offset:3072 lds
    s_waitcnt vmcnt(44)
    s_mov_b32 m0, 61440
    s_add_u32 s58, s68, 86016
    buffer_load_dwordx4 v28, s[36:39], s58 offen offset:0 lds
    buffer_load_dwordx4 v29, s[36:39], s58 offen offset:1024 lds
    buffer_load_dwordx4 v30, s[36:39], s58 offen offset:2048 lds
    buffer_load_dwordx4 v31, s[36:39], s58 offen offset:3072 lds
    s_waitcnt vmcnt(44)
    s_mov_b32 m0, 65536
    s_add_u32 s58, s76, 128
    buffer_load_dwordx4 v28, s[36:39], s58 offen offset:0 lds
    buffer_load_dwordx4 v29, s[36:39], s58 offen offset:1024 lds
    buffer_load_dwordx4 v30, s[36:39], s58 offen offset:2048 lds
    buffer_load_dwordx4 v31, s[36:39], s58 offen offset:3072 lds
    s_waitcnt vmcnt(44)
    s_barrier
    s_mov_b32 m0, 69632
    s_add_u32 s58, s76, 28800
    buffer_load_dwordx4 v28, s[36:39], s58 offen offset:0 lds
    buffer_load_dwordx4 v29, s[36:39], s58 offen offset:1024 lds
    buffer_load_dwordx4 v30, s[36:39], s58 offen offset:2048 lds
    buffer_load_dwordx4 v31, s[36:39], s58 offen offset:3072 lds
    s_waitcnt vmcnt(44)
    s_mov_b32 m0, 73728
    s_add_u32 s58, s76, 57472
    buffer_load_dwordx4 v28, s[36:39], s58 offen offset:0 lds
    buffer_load_dwordx4 v29, s[36:39], s58 offen offset:1024 lds
    buffer_load_dwordx4 v30, s[36:39], s58 offen offset:2048 lds
    buffer_load_dwordx4 v31, s[36:39], s58 offen offset:3072 lds
    s_waitcnt vmcnt(44)
    s_mov_b32 m0, 77824
    s_add_u32 s58, s76, 86144
    buffer_load_dwordx4 v28, s[36:39], s58 offen offset:0 lds
    buffer_load_dwordx4 v29, s[36:39], s58 offen offset:1024 lds
    buffer_load_dwordx4 v30, s[36:39], s58 offen offset:2048 lds
    buffer_load_dwordx4 v31, s[36:39], s58 offen offset:3072 lds
    s_waitcnt vmcnt(44)
    s_mov_b32 m0, 81920
    s_add_u32 s58, s69, 0
    buffer_load_dwordx4 v28, s[36:39], s58 offen offset:0 lds
    buffer_load_dwordx4 v29, s[36:39], s58 offen offset:1024 lds
    buffer_load_dwordx4 v30, s[36:39], s58 offen offset:2048 lds
    buffer_load_dwordx4 v31, s[36:39], s58 offen offset:3072 lds
    s_waitcnt vmcnt(44)
    s_barrier
    s_mov_b32 m0, 86016
    s_add_u32 s58, s69, 28672
    buffer_load_dwordx4 v28, s[36:39], s58 offen offset:0 lds
    buffer_load_dwordx4 v29, s[36:39], s58 offen offset:1024 lds
    buffer_load_dwordx4 v30, s[36:39], s58 offen offset:2048 lds
    buffer_load_dwordx4 v31, s[36:39], s58 offen offset:3072 lds
    s_waitcnt vmcnt(44)
    s_mov_b32 m0, 90112
    s_add_u32 s58, s69, 57344
    buffer_load_dwordx4 v28, s[36:39], s58 offen offset:0 lds
    buffer_load_dwordx4 v29, s[36:39], s58 offen offset:1024 lds
    buffer_load_dwordx4 v30, s[36:39], s58 offen offset:2048 lds
    buffer_load_dwordx4 v31, s[36:39], s58 offen offset:3072 lds
    s_waitcnt vmcnt(44)
    s_mov_b32 m0, 94208
    s_add_u32 s58, s69, 86016
    buffer_load_dwordx4 v28, s[36:39], s58 offen offset:0 lds
    buffer_load_dwordx4 v29, s[36:39], s58 offen offset:1024 lds
    buffer_load_dwordx4 v30, s[36:39], s58 offen offset:2048 lds
    buffer_load_dwordx4 v31, s[36:39], s58 offen offset:3072 lds
    s_waitcnt vmcnt(44)
    s_mov_b32 m0, 98304
    s_add_u32 s58, s70, 0
    buffer_load_dwordx4 v28, s[36:39], s58 offen offset:0 lds
    buffer_load_dwordx4 v29, s[36:39], s58 offen offset:1024 lds
    buffer_load_dwordx4 v30, s[36:39], s58 offen offset:2048 lds
    buffer_load_dwordx4 v31, s[36:39], s58 offen offset:3072 lds
    s_waitcnt vmcnt(44)
    s_barrier
    s_mov_b32 m0, 102400
    s_add_u32 s58, s70, 28672
    buffer_load_dwordx4 v28, s[36:39], s58 offen offset:0 lds
    buffer_load_dwordx4 v29, s[36:39], s58 offen offset:1024 lds
    buffer_load_dwordx4 v30, s[36:39], s58 offen offset:2048 lds
    buffer_load_dwordx4 v31, s[36:39], s58 offen offset:3072 lds
    s_waitcnt vmcnt(44)
    s_mov_b32 m0, 106496
    s_add_u32 s58, s70, 57344
    buffer_load_dwordx4 v28, s[36:39], s58 offen offset:0 lds
    buffer_load_dwordx4 v29, s[36:39], s58 offen offset:1024 lds
    buffer_load_dwordx4 v30, s[36:39], s58 offen offset:2048 lds
    buffer_load_dwordx4 v31, s[36:39], s58 offen offset:3072 lds
    s_waitcnt vmcnt(44)
    s_mov_b32 m0, 110592
    s_add_u32 s58, s70, 86016
    buffer_load_dwordx4 v28, s[36:39], s58 offen offset:0 lds
    buffer_load_dwordx4 v29, s[36:39], s58 offen offset:1024 lds
    buffer_load_dwordx4 v30, s[36:39], s58 offen offset:2048 lds
    buffer_load_dwordx4 v31, s[36:39], s58 offen offset:3072 lds
    s_waitcnt vmcnt(44)
    s_mov_b32 m0, 114688
    s_add_u32 s58, s71, 0
    buffer_load_dwordx4 v28, s[36:39], s58 offen offset:0 lds
    buffer_load_dwordx4 v29, s[36:39], s58 offen offset:1024 lds
    buffer_load_dwordx4 v30, s[36:39], s58 offen offset:2048 lds
    buffer_load_dwordx4 v31, s[36:39], s58 offen offset:3072 lds
    s_waitcnt vmcnt(44)
    s_barrier
    s_mov_b32 m0, 118784
    s_add_u32 s58, s71, 28672
    buffer_load_dwordx4 v28, s[36:39], s58 offen offset:0 lds
    buffer_load_dwordx4 v29, s[36:39], s58 offen offset:1024 lds
    buffer_load_dwordx4 v30, s[36:39], s58 offen offset:2048 lds
    buffer_load_dwordx4 v31, s[36:39], s58 offen offset:3072 lds
    s_waitcnt vmcnt(44)
    s_mov_b32 m0, 122880
    s_add_u32 s58, s71, 57344
    buffer_load_dwordx4 v28, s[36:39], s58 offen offset:0 lds
    buffer_load_dwordx4 v29, s[36:39], s58 offen offset:1024 lds
    buffer_load_dwordx4 v30, s[36:39], s58 offen offset:2048 lds
    buffer_load_dwordx4 v31, s[36:39], s58 offen offset:3072 lds
    s_waitcnt vmcnt(44)
    s_mov_b32 m0, 126976
    s_add_u32 s58, s71, 86016
    buffer_load_dwordx4 v28, s[36:39], s58 offen offset:0 lds
    buffer_load_dwordx4 v29, s[36:39], s58 offen offset:1024 lds
    buffer_load_dwordx4 v30, s[36:39], s58 offen offset:2048 lds
    buffer_load_dwordx4 v31, s[36:39], s58 offen offset:3072 lds
    s_waitcnt vmcnt(44)
    s_mov_b32 m0, 131072
    s_add_u32 s58, s77, 128
    buffer_load_dwordx4 v28, s[36:39], s58 offen offset:0 lds
    buffer_load_dwordx4 v29, s[36:39], s58 offen offset:1024 lds
    buffer_load_dwordx4 v30, s[36:39], s58 offen offset:2048 lds
    buffer_load_dwordx4 v31, s[36:39], s58 offen offset:3072 lds
    s_waitcnt vmcnt(44)
    s_barrier
    s_mov_b32 m0, 135168
    s_add_u32 s58, s77, 28800
    buffer_load_dwordx4 v28, s[36:39], s58 offen offset:0 lds
    buffer_load_dwordx4 v29, s[36:39], s58 offen offset:1024 lds
    buffer_load_dwordx4 v30, s[36:39], s58 offen offset:2048 lds
    buffer_load_dwordx4 v31, s[36:39], s58 offen offset:3072 lds
    s_waitcnt vmcnt(44)
    s_mov_b32 m0, 139264
    s_add_u32 s58, s77, 57472
    buffer_load_dwordx4 v28, s[36:39], s58 offen offset:0 lds
    buffer_load_dwordx4 v29, s[36:39], s58 offen offset:1024 lds
    buffer_load_dwordx4 v30, s[36:39], s58 offen offset:2048 lds
    buffer_load_dwordx4 v31, s[36:39], s58 offen offset:3072 lds
    s_waitcnt vmcnt(44)
    s_mov_b32 m0, 143360
    s_add_u32 s58, s77, 86144
    buffer_load_dwordx4 v28, s[36:39], s58 offen offset:0 lds
    buffer_load_dwordx4 v29, s[36:39], s58 offen offset:1024 lds
    buffer_load_dwordx4 v30, s[36:39], s58 offen offset:2048 lds
    buffer_load_dwordx4 v31, s[36:39], s58 offen offset:3072 lds
    s_waitcnt vmcnt(44)
    s_mov_b32 m0, 147456
    s_add_u32 s58, s78, 128
    buffer_load_dwordx4 v28, s[36:39], s58 offen offset:0 lds
    buffer_load_dwordx4 v29, s[36:39], s58 offen offset:1024 lds
    buffer_load_dwordx4 v30, s[36:39], s58 offen offset:2048 lds
    buffer_load_dwordx4 v31, s[36:39], s58 offen offset:3072 lds
    s_waitcnt vmcnt(44)
    s_barrier
    s_mov_b32 m0, 151552
    s_add_u32 s58, s78, 28800
    buffer_load_dwordx4 v28, s[36:39], s58 offen offset:0 lds
    buffer_load_dwordx4 v29, s[36:39], s58 offen offset:1024 lds
    buffer_load_dwordx4 v30, s[36:39], s58 offen offset:2048 lds
    buffer_load_dwordx4 v31, s[36:39], s58 offen offset:3072 lds
    s_waitcnt vmcnt(44)
    s_mov_b32 m0, 155648
    s_add_u32 s58, s78, 57472
    buffer_load_dwordx4 v28, s[36:39], s58 offen offset:0 lds
    buffer_load_dwordx4 v29, s[36:39], s58 offen offset:1024 lds
    buffer_load_dwordx4 v30, s[36:39], s58 offen offset:2048 lds
    buffer_load_dwordx4 v31, s[36:39], s58 offen offset:3072 lds
    s_waitcnt vmcnt(44)
    s_mov_b32 m0, 159744
    s_add_u32 s58, s78, 86144
    buffer_load_dwordx4 v28, s[36:39], s58 offen offset:0 lds
    buffer_load_dwordx4 v29, s[36:39], s58 offen offset:1024 lds
    buffer_load_dwordx4 v30, s[36:39], s58 offen offset:2048 lds
    buffer_load_dwordx4 v31, s[36:39], s58 offen offset:3072 lds
    s_waitcnt vmcnt(44)
    s_mov_b32 m0, 0
    s_add_u32 s58, s79, 128
    buffer_load_dwordx4 v28, s[36:39], s58 offen offset:0 lds
    buffer_load_dwordx4 v29, s[36:39], s58 offen offset:1024 lds
    buffer_load_dwordx4 v30, s[36:39], s58 offen offset:2048 lds
    buffer_load_dwordx4 v31, s[36:39], s58 offen offset:3072 lds
    s_waitcnt vmcnt(44)
    s_barrier
    s_mov_b32 m0, 4096
    s_add_u32 s58, s79, 28800
    buffer_load_dwordx4 v28, s[36:39], s58 offen offset:0 lds
    buffer_load_dwordx4 v29, s[36:39], s58 offen offset:1024 lds
    buffer_load_dwordx4 v30, s[36:39], s58 offen offset:2048 lds
    buffer_load_dwordx4 v31, s[36:39], s58 offen offset:3072 lds
    s_waitcnt vmcnt(44)
    s_mov_b32 m0, 8192
    s_add_u32 s58, s79, 57472
    buffer_load_dwordx4 v28, s[36:39], s58 offen offset:0 lds
    buffer_load_dwordx4 v29, s[36:39], s58 offen offset:1024 lds
    buffer_load_dwordx4 v30, s[36:39], s58 offen offset:2048 lds
    buffer_load_dwordx4 v31, s[36:39], s58 offen offset:3072 lds
    s_waitcnt vmcnt(44)
    s_mov_b32 m0, 12288
    s_add_u32 s58, s79, 86144
    buffer_load_dwordx4 v28, s[36:39], s58 offen offset:0 lds
    buffer_load_dwordx4 v29, s[36:39], s58 offen offset:1024 lds
    buffer_load_dwordx4 v30, s[36:39], s58 offen offset:2048 lds
    buffer_load_dwordx4 v31, s[36:39], s58 offen offset:3072 lds
    s_waitcnt vmcnt(44)
    s_barrier
    s_barrier
    s_waitcnt vmcnt(0)
    s_barrier
    s_barrier
    buffer_store_dwordx4 v[58:61], v57, s[64:67], s93 offen sc1
    s_add_u32 s93, s93, 8192
    buffer_store_dwordx4 v[58:61], v57, s[64:67], s93 offen sc1
    s_add_u32 s93, s93, 8192
    buffer_store_dwordx4 v[58:61], v57, s[64:67], s93 offen sc1
    s_add_u32 s93, s93, 8192
    buffer_store_dwordx4 v[58:61], v57, s[64:67], s93 offen sc1
    s_add_u32 s93, s93, 8192
    buffer_store_dwordx4 v[58:61], v57, s[64:67], s93 offen sc1
    s_add_u32 s93, s93, 8192
    buffer_store_dwordx4 v[58:61], v57, s[64:67], s93 offen sc1
    s_add_u32 s93, s93, 8192
    buffer_store_dwordx4 v[58:61], v57, s[64:67], s93 offen sc1
    s_add_u32 s93, s93, 8192
    buffer_store_dwordx4 v[58:61], v57, s[64:67], s93 offen sc1
    s_add_u32 s93, s93, 8192
    buffer_store_dwordx4 v[58:61], v57, s[64:67], s93 offen sc1
    s_add_u32 s93, s93, 8192
    buffer_store_dwordx4 v[58:61], v57, s[64:67], s93 offen sc1
    s_add_u32 s93, s93, 8192
    buffer_store_dwordx4 v[58:61], v57, s[64:67], s93 offen sc1
    s_add_u32 s93, s93, 8192
    buffer_store_dwordx4 v[58:61], v57, s[64:67], s93 offen sc1
    s_add_u32 s93, s93, 8192
    s_barrier
    v_mov_b32 v52, 32
    s_waitcnt vmcnt(0)
    s_mov_b64 exec, 1
    buffer_store_dword v52, v48, s[64:67], s88 offen sc1
    s_mov_b64 exec, -1
    s_barrier
    s_endpgm
L_san:
    buffer_load_dword v54, v48, s[80:83], s85 offen sc1
    s_sub_u32 s92, s92, 1
    s_waitcnt vmcnt(0)
    v_cmp_gt_u32 vcc, 1, v54
    s_cselect_b32 s92, 0, s92
    s_cbranch_scc1 L_ban
    s_cbranch_vccnz L_san
    s_branch L_ban
L_sid:
    buffer_load_dword v55, v47, s[64:67], s84 offen offset:1024 sc1
    s_sub_u32 s92, s92, 1
    s_waitcnt vmcnt(0)
    v_cmp_gt_u32 vcc, 16, v55
    s_cselect_b32 s92, 0, s92
    s_cbranch_scc1 L_bid
    s_cbranch_vccnz L_sid
    s_branch L_bid
.p2align 12
M_compute:
    s_sub_u32 s45, s45, 1
    v_and_b32 v5, 31, v2
    v_lshrrev_b32 v6, 5, v2
    v_bfe_u32 v7, v2, 2, 2
    v_and_b32 v8, 3, v2
    v_bfe_u32 v9, v2, 4, 1
    s_lshl_b32 s47, s40, 5
    s_add_u32 s47, s47, s46
    s_waitcnt lgkmcnt(0)
    s_mov_b32 s36, s18
    s_mov_b32 s37, s19
    s_mov_b32 s38, 268435456
    s_mov_b32 s39, 0x20000
    s_mov_b32 s24, s14
    s_mov_b32 s25, s15
    s_mov_b32 s26, 688128
    s_mov_b32 s27, 0x20000
    s_lshl_b32 s53, s41, 11
    s_lshl_b32 s48, s40, 7
    s_add_u32 s53, s53, s48
    s_add_u32 s53, s53, 20971520
    s_and_b32 s49, s46, 3
    s_lshl_b32 s49, s49, 2
    s_add_u32 s49, s49, s45
    s_lshl_b32 s50, s49, 2
    s_add_u32 s50, s50, s53
    s_xor_b32 s70, s50, 32
    s_add_u32 s35, s53, 1024
    s_lshl_b32 s54, s47, 2
    s_add_u32 s54, s54, s45
    s_lshl_b32 s54, s54, 7
    s_add_u32 s54, s54, 21102592
    v_mov_b32 v0, 0
    v_lshlrev_b32 v3, 2, v8
    s_lshl_b32 s48, s45, 12
    s_lshl_b32 s49, s42, 6
    v_bfe_u32 v30, v2, 1, 3
    v_xor_b32 v30, v30, v6
    v_lshlrev_b32 v30, 4, v30
    v_lshl_add_u32 v30, v5, 7, v30
    v_add_u32 v30, s48, v30
    v_xor_b32 v10, s49, v30
    v_xor_b32 v11, 32, v10
    v_xor_b32 v12, 64, v10
    v_xor_b32 v13, 96, v10
    v_and_b32 v30, 1, v8
    v_lshlrev_b32 v30, 4, v30
    v_lshrrev_b32 v31, 1, v8
    v_lshl_add_u32 v31, v31, 3, v30
    v_lshl_add_u32 v31, v9, 5, v31
    v_lshl_add_u32 v30, v6, 3, v7
    v_lshlrev_b32 v30, 9, v30
    v_lshl_add_u32 v30, v7, 6, v30
    v_add_u32 v14, v30, v31
    v_xor_b32 v15, 64, v14
    v_xor_b32 v16, 128, v14
    v_xor_b32 v17, 192, v14
    v_bfe_u32 v30, v2, 1, 3
    v_xor_b32 v30, v30, v6
    v_lshlrev_b32 v30, 4, v30
    v_and_b32 v18, 7, v2
    v_lshl_add_u32 v30, v18, 7, v30
    v_bfe_u32 v18, v2, 3, 2
    v_lshl_add_u32 v18, v18, 12, v30
    v_xor_b32 v19, 32, v18
    v_xor_b32 v20, 64, v18
    v_xor_b32 v21, 96, v18
    v_add_u32 v22, 0x10000, v18
    v_add_u32 v23, 0x10000, v19
    v_add_u32 v24, 0x10000, v20
    v_add_u32 v25, 0x10000, v21
    v_lshlrev_b32 v29, 4, v2
    v_lshrrev_b32 v32, 4, v2
    v_bfe_u32 v30, v2, 1, 3
    v_xor_b32 v30, v30, v32
    v_lshlrev_b32 v30, 4, v30
    v_and_b32 v33, 15, v2
    v_lshl_add_u32 v30, v33, 7, v30
    v_add_u32 v30, s48, v30
    v_xor_b32 v10, s49, v30
    v_xor_b32 v11, 64, v10
    v_lshl_add_u32 v30, v32, 3, v7
    v_lshlrev_b32 v30, 9, v30
    v_lshl_add_u32 v30, v7, 6, v30
    v_lshl_add_u32 v30, v9, 5, v30
    v_lshl_add_u32 v64, v8, 3, v30
    v_xor_b32 v65, 32, v64
    v_xor_b32 v66, 64, v64
    v_xor_b32 v67, 96, v64
    v_xor_b32 v68, 128, v64
    v_xor_b32 v69, 160, v64
    v_xor_b32 v70, 192, v64
    v_xor_b32 v71, 224, v64
    v_add_u32 v72, 0x10000, v64
    v_add_u32 v73, 0x10000, v65
    v_add_u32 v74, 0x10000, v66
    v_add_u32 v75, 0x10000, v67
    v_add_u32 v76, 0x10000, v68
    v_add_u32 v77, 0x10000, v69
    v_add_u32 v78, 0x10000, v70
    v_add_u32 v79, 0x10000, v71
    v_add_u32 v80, 0x20000, v64
    v_add_u32 v81, 0x20000, v65
    v_add_u32 v82, 0x20000, v66
    v_add_u32 v83, 0x20000, v67
    v_add_u32 v84, 0x20000, v68
    v_add_u32 v85, 0x20000, v69
    v_add_u32 v86, 0x20000, v70
    v_add_u32 v87, 0x20000, v71
    v_lshl_add_u32 v30, v6, 2, v7
    v_lshlrev_b32 v8, 3, v8
    v_lshl_add_u32 v8, v9, 5, v8
    v_lshl_add_u32 v8, v7, 6, v8
    v_lshl_add_u32 v8, v30, 8, v8
    v_lshl_add_u32 v9, v30, 7, v31
    v_lshrrev_b32 v30, 1, v7
    v_lshl_add_u32 v9, v30, 6, v9
    s_mov_b32 s59, 0x3db8aa3b
    s_mov_b32 s58, 0x4f800000
    s_mov_b32 s57, 0xffff0000
    s_mov_b32 s73, 2000000
    s_xor_b32 s64, s47, 0
    s_mul_i32 s64, s64, 3
    s_add_u32 s64, s64, s45
    s_mul_i32 s64, s64, 9216
    s_add_u32 s64, s64, 6291456
    s_xor_b32 s65, s47, 2
    s_mul_i32 s65, s65, 3
    s_add_u32 s65, s65, s45
    s_mul_i32 s65, s65, 9216
    s_add_u32 s65, s65, 6291456
    s_xor_b32 s66, s47, 2
    s_mul_i32 s66, s66, 3
    s_add_u32 s66, s66, s45
    s_mul_i32 s66, s66, 9216
    s_add_u32 s66, s66, 6292480
    s_xor_b32 s67, s47, 3
    s_mul_i32 s67, s67, 3
    s_add_u32 s67, s67, s45
    s_mul_i32 s67, s67, 9216
    s_add_u32 s67, s67, 6292480
    s_xor_b32 s68, s47, 0
    s_mul_i32 s68, s68, 3
    s_add_u32 s68, s68, s45
    s_mul_i32 s68, s68, 9216
    s_add_u32 s68, s68, 6292480
    s_xor_b32 s69, s47, 1
    s_mul_i32 s69, s69, 3
    s_add_u32 s69, s69, s45
    s_mul_i32 s69, s69, 9216
    s_add_u32 s69, s69, 6292480
    s_getreg_b32 s28, hwreg(HW_REG_XCC_ID, 0, 4)
    s_or_b32 s28, s28, 16
    s_and_b32 s48, s46, 3
    s_mul_i32 s71, s41, 7
    s_lshl_b32 s49, s48, 1
    s_add_u32 s71, s71, s49
    s_mul_i32 s71, s71, 3
    s_add_u32 s71, s71, s45
    s_lshl_b32 s71, s71, 5
    s_add_u32 s71, s71, s40
    s_lshl_b32 s71, s71, 10
    s_add_u32 s72, s71, 98304
    s_cmp_eq_u32 s48, 3
    s_cselect_b32 s72, 0x20000000, s72
    v_and_b32 v4, 3, v2
    v_lshlrev_b32 v4, 4, v4
    v_xor_b32 v4, s50, v4
    s_waitcnt vmcnt(0)
    s_mov_b64 exec, 0
    s_cmp_eq_u32 s45, 1
    s_cbranch_scc1 C_pad1
    s_cmp_eq_u32 s45, 2
    s_cbranch_scc1 C_pad2
    s_branch C_pad3
L_ret1:
L_ret2:
L_ret3:
    s_mov_b64 exec, -1
    s_barrier
    ds_read_b64_tr_b16 a[216:217], v64 offset:16384
    ds_read_b64_tr_b16 a[218:219], v64 offset:18432
    ds_read_b128 a[0:3], v10 offset:0
    ds_read_b64_tr_b16 a[220:221], v65 offset:16384
    ds_read_b64_tr_b16 a[222:223], v65 offset:18432
    ds_read_b128 a[4:7], v10 offset:2048
    ds_read_b64_tr_b16 a[224:225], v66 offset:16384
    ds_read_b64_tr_b16 a[226:227], v66 offset:18432
    ds_read_b128 a[8:11], v11 offset:0
    ds_read_b64_tr_b16 a[228:229], v67 offset:16384
    ds_read_b64_tr_b16 a[230:231], v67 offset:18432
    ds_read_b128 a[12:15], v11 offset:2048
    ds_read_b64_tr_b16 a[232:233], v68 offset:16384
    ds_read_b64_tr_b16 a[234:235], v68 offset:18432
    s_waitcnt lgkmcnt(9)
    v_mfma_f32_16x16x32_bf16 v[128:131], a[216:219], a[0:3], 0
    ds_read_b64_tr_b16 a[236:237], v69 offset:16384
    s_waitcnt lgkmcnt(9)
    v_mfma_f32_16x16x32_bf16 v[132:135], a[216:219], a[4:7], 0
    ds_read_b64_tr_b16 a[238:239], v69 offset:18432
    v_mfma_f32_16x16x32_bf16 v[136:139], a[220:223], a[0:3], 0
    ds_read_b64_tr_b16 a[240:241], v70 offset:16384
    v_mfma_f32_16x16x32_bf16 v[140:143], a[220:223], a[4:7], 0
    ds_read_b64_tr_b16 a[242:243], v70 offset:18432
    s_waitcnt lgkmcnt(7)
    v_mfma_f32_16x16x32_bf16 v[144:147], a[224:227], a[0:3], 0
    ds_read_b64_tr_b16 a[244:245], v71 offset:16384
    v_mfma_f32_16x16x32_bf16 v[148:151], a[224:227], a[4:7], 0
    ds_read_b64_tr_b16 a[246:247], v71 offset:18432
    v_mfma_f32_16x16x32_bf16 v[152:155], a[228:231], a[0:3], 0
    ds_read_b64_tr_b16 a[248:249], v64 offset:16640
    v_mfma_f32_16x16x32_bf16 v[156:159], a[228:231], a[4:7], 0
    ds_read_b64_tr_b16 a[250:251], v64 offset:18688
    s_waitcnt lgkmcnt(6)
    v_mfma_f32_16x16x32_bf16 v[160:163], a[232:235], a[0:3], 0
    ds_read_b64_tr_b16 a[252:253], v65 offset:16640
    v_mfma_f32_16x16x32_bf16 v[164:167], a[232:235], a[4:7], 0
    ds_read_b64_tr_b16 a[254:255], v65 offset:18688
    v_mfma_f32_16x16x32_bf16 v[168:171], a[236:239], a[0:3], 0
    ds_read_b64_tr_b16 a[216:217], v66 offset:16640
    v_mfma_f32_16x16x32_bf16 v[172:175], a[236:239], a[4:7], 0
    ds_read_b64_tr_b16 a[218:219], v66 offset:18688
    s_waitcnt lgkmcnt(6)
    v_mfma_f32_16x16x32_bf16 v[176:179], a[240:243], a[0:3], 0
    ds_read_b64_tr_b16 a[220:221], v67 offset:16640
    v_mfma_f32_16x16x32_bf16 v[180:183], a[240:243], a[4:7], 0
    ds_read_b64_tr_b16 a[222:223], v67 offset:18688
    v_mfma_f32_16x16x32_bf16 v[184:187], a[244:247], a[0:3], 0
    ds_read_b64_tr_b16 a[224:225], v68 offset:16640
    v_mfma_f32_16x16x32_bf16 v[188:191], a[244:247], a[4:7], 0
    ds_read_b64_tr_b16 a[226:227], v68 offset:18688
    s_waitcnt lgkmcnt(6)
    v_mfma_f32_16x16x32_bf16 v[192:195], a[248:251], a[0:3], 0
    ds_read_b64_tr_b16 a[228:229], v69 offset:16640
    v_mfma_f32_16x16x32_bf16 v[196:199], a[248:251], a[4:7], 0
    ds_read_b64_tr_b16 a[230:231], v69 offset:18688
    v_mfma_f32_16x16x32_bf16 v[200:203], a[252:255], a[0:3], 0
    ds_read_b64_tr_b16 a[232:233], v70 offset:16640
    v_mfma_f32_16x16x32_bf16 v[204:207], a[252:255], a[4:7], 0
    ds_read_b64_tr_b16 a[234:235], v70 offset:18688
    s_waitcnt lgkmcnt(6)
    v_mfma_f32_16x16x32_bf16 v[208:211], a[216:219], a[0:3], 0
    ds_read_b64_tr_b16 a[236:237], v71 offset:16640
    v_mfma_f32_16x16x32_bf16 v[212:215], a[216:219], a[4:7], 0
    ds_read_b64_tr_b16 a[238:239], v71 offset:18688
    v_mfma_f32_16x16x32_bf16 v[216:219], a[220:223], a[0:3], 0
    s_barrier
    ds_read_b64_tr_b16 a[240:241], v64 offset:32768
    v_mfma_f32_16x16x32_bf16 v[220:223], a[220:223], a[4:7], 0
    ds_read_b64_tr_b16 a[242:243], v64 offset:34816
    s_waitcnt lgkmcnt(6)
    v_mfma_f32_16x16x32_bf16 v[224:227], a[224:227], a[0:3], 0
    ds_read_b64_tr_b16 a[244:245], v65 offset:32768
    v_mfma_f32_16x16x32_bf16 v[228:231], a[224:227], a[4:7], 0
    ds_read_b64_tr_b16 a[246:247], v65 offset:34816
    v_mfma_f32_16x16x32_bf16 v[232:235], a[228:231], a[0:3], 0
    ds_read_b64_tr_b16 a[248:249], v66 offset:32768
    v_mfma_f32_16x16x32_bf16 v[236:239], a[228:231], a[4:7], 0
    ds_read_b64_tr_b16 a[250:251], v66 offset:34816
    s_waitcnt lgkmcnt(6)
    v_mfma_f32_16x16x32_bf16 v[240:243], a[232:235], a[0:3], 0
    ds_read_b64_tr_b16 a[252:253], v67 offset:32768
    v_mfma_f32_16x16x32_bf16 v[244:247], a[232:235], a[4:7], 0
    ds_read_b64_tr_b16 a[254:255], v67 offset:34816
    v_mfma_f32_16x16x32_bf16 v[248:251], a[236:239], a[0:3], 0
    ds_read_b64_tr_b16 a[216:217], v68 offset:32768
    v_mfma_f32_16x16x32_bf16 v[252:255], a[236:239], a[4:7], 0
    ds_read_b64_tr_b16 a[218:219], v68 offset:34816
    s_waitcnt lgkmcnt(6)
    v_mfma_f32_16x16x32_bf16 v[128:131], a[240:243], a[8:11], v[128:131]
    ds_read_b64_tr_b16 a[220:221], v69 offset:32768
    v_mfma_f32_16x16x32_bf16 v[132:135], a[240:243], a[12:15], v[132:135]
    ds_read_b64_tr_b16 a[222:223], v69 offset:34816
    v_mfma_f32_16x16x32_bf16 v[136:139], a[244:247], a[8:11], v[136:139]
    ds_read_b64_tr_b16 a[224:225], v70 offset:32768
    v_mfma_f32_16x16x32_bf16 v[140:143], a[244:247], a[12:15], v[140:143]
    ds_read_b64_tr_b16 a[226:227], v70 offset:34816
    s_waitcnt lgkmcnt(6)
    v_mfma_f32_16x16x32_bf16 v[144:147], a[248:251], a[8:11], v[144:147]
    ds_read_b64_tr_b16 a[228:229], v71 offset:32768
    v_mfma_f32_16x16x32_bf16 v[148:151], a[248:251], a[12:15], v[148:151]
    ds_read_b64_tr_b16 a[230:231], v71 offset:34816
    v_mfma_f32_16x16x32_bf16 v[152:155], a[252:255], a[8:11], v[152:155]
    ds_read_b64_tr_b16 a[232:233], v64 offset:33024
    v_mfma_f32_16x16x32_bf16 v[156:159], a[252:255], a[12:15], v[156:159]
    ds_read_b64_tr_b16 a[234:235], v64 offset:35072
    s_waitcnt lgkmcnt(6)
    v_mfma_f32_16x16x32_bf16 v[160:163], a[216:219], a[8:11], v[160:163]
    ds_read_b64_tr_b16 a[236:237], v65 offset:33024
    v_mfma_f32_16x16x32_bf16 v[164:167], a[216:219], a[12:15], v[164:167]
    ds_read_b64_tr_b16 a[238:239], v65 offset:35072
    v_mfma_f32_16x16x32_bf16 v[168:171], a[220:223], a[8:11], v[168:171]
    ds_read_b64_tr_b16 a[240:241], v66 offset:33024
    v_mfma_f32_16x16x32_bf16 v[172:175], a[220:223], a[12:15], v[172:175]
    ds_read_b64_tr_b16 a[242:243], v66 offset:35072
    s_waitcnt lgkmcnt(6)
    v_mfma_f32_16x16x32_bf16 v[176:179], a[224:227], a[8:11], v[176:179]
    ds_read_b64_tr_b16 a[244:245], v67 offset:33024
    v_mfma_f32_16x16x32_bf16 v[180:183], a[224:227], a[12:15], v[180:183]
    ds_read_b64_tr_b16 a[246:247], v67 offset:35072
    v_mfma_f32_16x16x32_bf16 v[184:187], a[228:231], a[8:11], v[184:187]
    ds_read_b64_tr_b16 a[248:249], v68 offset:33024
    v_mfma_f32_16x16x32_bf16 v[188:191], a[228:231], a[12:15], v[188:191]
    ds_read_b64_tr_b16 a[250:251], v68 offset:35072
    s_waitcnt lgkmcnt(6)
    v_mfma_f32_16x16x32_bf16 v[192:195], a[232:235], a[8:11], v[192:195]
    ds_read_b64_tr_b16 a[252:253], v69 offset:33024
    v_mfma_f32_16x16x32_bf16 v[196:199], a[232:235], a[12:15], v[196:199]
    ds_read_b64_tr_b16 a[254:255], v69 offset:35072
    v_mfma_f32_16x16x32_bf16 v[200:203], a[236:239], a[8:11], v[200:203]
    ds_read_b64_tr_b16 a[216:217], v70 offset:33024
    v_mfma_f32_16x16x32_bf16 v[204:207], a[236:239], a[12:15], v[204:207]
    ds_read_b64_tr_b16 a[218:219], v70 offset:35072
    s_waitcnt lgkmcnt(6)
    v_mfma_f32_16x16x32_bf16 v[208:211], a[240:243], a[8:11], v[208:211]
    ds_read_b64_tr_b16 a[220:221], v71 offset:33024
    v_mfma_f32_16x16x32_bf16 v[212:215], a[240:243], a[12:15], v[212:215]
    ds_read_b64_tr_b16 a[222:223], v71 offset:35072
    v_mfma_f32_16x16x32_bf16 v[216:219], a[244:247], a[8:11], v[216:219]
    s_barrier
    ds_read_b128 a[16:19], v10 offset:49152
    v_mfma_f32_16x16x32_bf16 v[220:223], a[244:247], a[12:15], v[220:223]
    ds_read_b64_tr_b16 a[224:225], v72 offset:0
    ds_read_b64_tr_b16 a[226:227], v72 offset:2048
    s_waitcnt lgkmcnt(7)
    v_mfma_f32_16x16x32_bf16 v[224:227], a[248:251], a[8:11], v[224:227]
    ds_read_b64_tr_b16 a[228:229], v73 offset:0
    v_mfma_f32_16x16x32_bf16 v[228:231], a[248:251], a[12:15], v[228:231]
    ds_read_b64_tr_b16 a[230:231], v73 offset:2048
    ds_read_b128 a[20:23], v10 offset:51200
    v_mfma_f32_16x16x32_bf16 v[232:235], a[252:255], a[8:11], v[232:235]
    ds_read_b64_tr_b16 a[232:233], v74 offset:0
    v_mfma_f32_16x16x32_bf16 v[236:239], a[252:255], a[12:15], v[236:239]
    ds_read_b64_tr_b16 a[234:235], v74 offset:2048
    s_waitcnt lgkmcnt(8)
    v_mfma_f32_16x16x32_bf16 v[240:243], a[216:219], a[8:11], v[240:243]
    ds_read_b64_tr_b16 a[236:237], v75 offset:0
    v_mfma_f32_16x16x32_bf16 v[244:247], a[216:219], a[12:15], v[244:247]
    ds_read_b64_tr_b16 a[238:239], v75 offset:2048
    ds_read_b128 a[24:27], v11 offset:49152
    v_mfma_f32_16x16x32_bf16 v[248:251], a[220:223], a[8:11], v[248:251]
    ds_read_b64_tr_b16 a[240:241], v76 offset:0
    v_mfma_f32_16x16x32_bf16 v[252:255], a[220:223], a[12:15], v[252:255]
    ds_read_b64_tr_b16 a[242:243], v76 offset:2048
    s_waitcnt lgkmcnt(8)
    v_mfma_f32_16x16x32_bf16 v[128:131], a[224:227], a[16:19], v[128:131]
    ds_read_b64_tr_b16 a[244:245], v77 offset:0
    s_waitcnt lgkmcnt(8)
    v_mfma_f32_16x16x32_bf16 v[132:135], a[224:227], a[20:23], v[132:135]
    ds_read_b64_tr_b16 a[246:247], v77 offset:2048
    ds_read_b128 a[28:31], v11 offset:51200
    v_mfma_f32_16x16x32_bf16 v[136:139], a[228:231], a[16:19], v[136:139]
    ds_read_b64_tr_b16 a[248:249], v78 offset:0
    v_mfma_f32_16x16x32_bf16 v[140:143], a[228:231], a[20:23], v[140:143]
    ds_read_b64_tr_b16 a[250:251], v78 offset:2048
    s_waitcnt lgkmcnt(8)
    v_mfma_f32_16x16x32_bf16 v[144:147], a[232:235], a[16:19], v[144:147]
    ds_read_b64_tr_b16 a[252:253], v79 offset:0
    v_mfma_f32_16x16x32_bf16 v[148:151], a[232:235], a[20:23], v[148:151]
    ds_read_b64_tr_b16 a[254:255], v79 offset:2048
    v_mfma_f32_16x16x32_bf16 v[152:155], a[236:239], a[16:19], v[152:155]
    ds_read_b64_tr_b16 a[216:217], v72 offset:256
    v_mfma_f32_16x16x32_bf16 v[156:159], a[236:239], a[20:23], v[156:159]
    ds_read_b64_tr_b16 a[218:219], v72 offset:2304
    s_waitcnt lgkmcnt(7)
    v_mfma_f32_16x16x32_bf16 v[160:163], a[240:243], a[16:19], v[160:163]
    ds_read_b64_tr_b16 a[220:221], v73 offset:256
    v_mfma_f32_16x16x32_bf16 v[164:167], a[240:243], a[20:23], v[164:167]
    ds_read_b64_tr_b16 a[222:223], v73 offset:2304
    v_mfma_f32_16x16x32_bf16 v[168:171], a[244:247], a[16:19], v[168:171]
    ds_read_b64_tr_b16 a[224:225], v74 offset:256
    v_mfma_f32_16x16x32_bf16 v[172:175], a[244:247], a[20:23], v[172:175]
    ds_read_b64_tr_b16 a[226:227], v74 offset:2304
    s_waitcnt lgkmcnt(6)
    v_mfma_f32_16x16x32_bf16 v[176:179], a[248:251], a[16:19], v[176:179]
    ds_read_b64_tr_b16 a[228:229], v75 offset:256
    v_mfma_f32_16x16x32_bf16 v[180:183], a[248:251], a[20:23], v[180:183]
    ds_read_b64_tr_b16 a[230:231], v75 offset:2304
    v_mfma_f32_16x16x32_bf16 v[184:187], a[252:255], a[16:19], v[184:187]
    ds_read_b64_tr_b16 a[232:233], v76 offset:256
    v_mfma_f32_16x16x32_bf16 v[188:191], a[252:255], a[20:23], v[188:191]
    ds_read_b64_tr_b16 a[234:235], v76 offset:2304
    s_waitcnt lgkmcnt(6)
    v_mfma_f32_16x16x32_bf16 v[192:195], a[216:219], a[16:19], v[192:195]
    ds_read_b64_tr_b16 a[236:237], v77 offset:256
    v_mfma_f32_16x16x32_bf16 v[196:199], a[216:219], a[20:23], v[196:199]
    ds_read_b64_tr_b16 a[238:239], v77 offset:2304
    v_mfma_f32_16x16x32_bf16 v[200:203], a[220:223], a[16:19], v[200:203]
    ds_read_b64_tr_b16 a[240:241], v78 offset:256
    v_add_u32 v10, 0x10000, v10
    v_mfma_f32_16x16x32_bf16 v[204:207], a[220:223], a[20:23], v[204:207]
    ds_read_b64_tr_b16 a[242:243], v78 offset:2304
    s_waitcnt lgkmcnt(6)
    v_mfma_f32_16x16x32_bf16 v[208:211], a[224:227], a[16:19], v[208:211]
    ds_read_b64_tr_b16 a[244:245], v79 offset:256
    v_mfma_f32_16x16x32_bf16 v[212:215], a[224:227], a[20:23], v[212:215]
    ds_read_b64_tr_b16 a[246:247], v79 offset:2304
    v_mfma_f32_16x16x32_bf16 v[216:219], a[228:231], a[16:19], v[216:219]
    s_barrier
    ds_read_b64_tr_b16 a[248:249], v72 offset:32768
    v_mfma_f32_16x16x32_bf16 v[220:223], a[228:231], a[20:23], v[220:223]
    ds_read_b64_tr_b16 a[250:251], v72 offset:34816
    s_waitcnt lgkmcnt(6)
    v_mfma_f32_16x16x32_bf16 v[224:227], a[232:235], a[16:19], v[224:227]
    ds_read_b64_tr_b16 a[252:253], v73 offset:32768
    v_mfma_f32_16x16x32_bf16 v[228:231], a[232:235], a[20:23], v[228:231]
    ds_read_b64_tr_b16 a[254:255], v73 offset:34816
    ds_read_b128 a[0:3], v10 offset:16384
    v_mfma_f32_16x16x32_bf16 v[232:235], a[236:239], a[16:19], v[232:235]
    ds_read_b64_tr_b16 a[216:217], v74 offset:32768
    v_add_u32 v11, 0x10000, v11
    v_mfma_f32_16x16x32_bf16 v[236:239], a[236:239], a[20:23], v[236:239]
    ds_read_b64_tr_b16 a[218:219], v74 offset:34816
    s_waitcnt lgkmcnt(7)
    v_mfma_f32_16x16x32_bf16 v[240:243], a[240:243], a[16:19], v[240:243]
    ds_read_b64_tr_b16 a[220:221], v75 offset:32768
    v_mfma_f32_16x16x32_bf16 v[244:247], a[240:243], a[20:23], v[244:247]
    ds_read_b64_tr_b16 a[222:223], v75 offset:34816
    ds_read_b128 a[4:7], v10 offset:18432
    v_mfma_f32_16x16x32_bf16 v[248:251], a[244:247], a[16:19], v[248:251]
    ds_read_b64_tr_b16 a[224:225], v76 offset:32768
    v_mfma_f32_16x16x32_bf16 v[252:255], a[244:247], a[20:23], v[252:255]
    ds_read_b64_tr_b16 a[226:227], v76 offset:34816
    s_waitcnt lgkmcnt(8)
    v_mfma_f32_16x16x32_bf16 v[128:131], a[248:251], a[24:27], v[128:131]
    ds_read_b64_tr_b16 a[228:229], v77 offset:32768
    v_mfma_f32_16x16x32_bf16 v[132:135], a[248:251], a[28:31], v[132:135]
    ds_read_b64_tr_b16 a[230:231], v77 offset:34816
    ds_read_b128 a[8:11], v11 offset:16384
    v_mfma_f32_16x16x32_bf16 v[136:139], a[252:255], a[24:27], v[136:139]
    ds_read_b64_tr_b16 a[232:233], v78 offset:32768
    v_mfma_f32_16x16x32_bf16 v[140:143], a[252:255], a[28:31], v[140:143]
    ds_read_b64_tr_b16 a[234:235], v78 offset:34816
    s_waitcnt lgkmcnt(8)
    v_mfma_f32_16x16x32_bf16 v[144:147], a[216:219], a[24:27], v[144:147]
    ds_read_b64_tr_b16 a[236:237], v79 offset:32768
    v_mfma_f32_16x16x32_bf16 v[148:151], a[216:219], a[28:31], v[148:151]
    ds_read_b64_tr_b16 a[238:239], v79 offset:34816
    ds_read_b128 a[12:15], v11 offset:18432
    v_mfma_f32_16x16x32_bf16 v[152:155], a[220:223], a[24:27], v[152:155]
    ds_read_b64_tr_b16 a[240:241], v72 offset:33024
    v_mfma_f32_16x16x32_bf16 v[156:159], a[220:223], a[28:31], v[156:159]
    ds_read_b64_tr_b16 a[242:243], v72 offset:35072
    s_waitcnt lgkmcnt(8)
    v_mfma_f32_16x16x32_bf16 v[160:163], a[224:227], a[24:27], v[160:163]
    ds_read_b64_tr_b16 a[244:245], v73 offset:33024
    v_mfma_f32_16x16x32_bf16 v[164:167], a[224:227], a[28:31], v[164:167]
    ds_read_b64_tr_b16 a[246:247], v73 offset:35072
    v_mfma_f32_16x16x32_bf16 v[168:171], a[228:231], a[24:27], v[168:171]
    ds_read_b64_tr_b16 a[248:249], v74 offset:33024
    v_mfma_f32_16x16x32_bf16 v[172:175], a[228:231], a[28:31], v[172:175]
    ds_read_b64_tr_b16 a[250:251], v74 offset:35072
    s_waitcnt lgkmcnt(7)
    v_mfma_f32_16x16x32_bf16 v[176:179], a[232:235], a[24:27], v[176:179]
    ds_read_b64_tr_b16 a[252:253], v75 offset:33024
    v_mfma_f32_16x16x32_bf16 v[180:183], a[232:235], a[28:31], v[180:183]
    ds_read_b64_tr_b16 a[254:255], v75 offset:35072
    v_mfma_f32_16x16x32_bf16 v[184:187], a[236:239], a[24:27], v[184:187]
    ds_read_b64_tr_b16 a[216:217], v76 offset:33024
    v_mfma_f32_16x16x32_bf16 v[188:191], a[236:239], a[28:31], v[188:191]
    ds_read_b64_tr_b16 a[218:219], v76 offset:35072
    s_waitcnt lgkmcnt(6)
    v_mfma_f32_16x16x32_bf16 v[192:195], a[240:243], a[24:27], v[192:195]
    ds_read_b64_tr_b16 a[220:221], v77 offset:33024
    v_mfma_f32_16x16x32_bf16 v[196:199], a[240:243], a[28:31], v[196:199]
    ds_read_b64_tr_b16 a[222:223], v77 offset:35072
    v_mfma_f32_16x16x32_bf16 v[200:203], a[244:247], a[24:27], v[200:203]
    ds_read_b64_tr_b16 a[224:225], v78 offset:33024
    v_mfma_f32_16x16x32_bf16 v[204:207], a[244:247], a[28:31], v[204:207]
    ds_read_b64_tr_b16 a[226:227], v78 offset:35072
    s_waitcnt lgkmcnt(6)
    v_mfma_f32_16x16x32_bf16 v[208:211], a[248:251], a[24:27], v[208:211]
    ds_read_b64_tr_b16 a[228:229], v79 offset:33024
    v_mfma_f32_16x16x32_bf16 v[212:215], a[248:251], a[28:31], v[212:215]
    ds_read_b64_tr_b16 a[230:231], v79 offset:35072
    v_mfma_f32_16x16x32_bf16 v[216:219], a[252:255], a[24:27], v[216:219]
    s_barrier
    ds_read_b64_tr_b16 a[232:233], v72 offset:49152
    v_mfma_f32_16x16x32_bf16 v[220:223], a[252:255], a[28:31], v[220:223]
    ds_read_b64_tr_b16 a[234:235], v72 offset:51200
    s_waitcnt lgkmcnt(6)
    v_mfma_f32_16x16x32_bf16 v[224:227], a[216:219], a[24:27], v[224:227]
    ds_read_b64_tr_b16 a[236:237], v73 offset:49152
    v_mfma_f32_16x16x32_bf16 v[228:231], a[216:219], a[28:31], v[228:231]
    ds_read_b64_tr_b16 a[238:239], v73 offset:51200
    v_mfma_f32_16x16x32_bf16 v[232:235], a[220:223], a[24:27], v[232:235]
    ds_read_b64_tr_b16 a[240:241], v74 offset:49152
    v_mfma_f32_16x16x32_bf16 v[236:239], a[220:223], a[28:31], v[236:239]
    ds_read_b64_tr_b16 a[242:243], v74 offset:51200
    s_waitcnt lgkmcnt(6)
    v_mfma_f32_16x16x32_bf16 v[240:243], a[224:227], a[24:27], v[240:243]
    ds_read_b64_tr_b16 a[244:245], v75 offset:49152
    v_mfma_f32_16x16x32_bf16 v[244:247], a[224:227], a[28:31], v[244:247]
    ds_read_b64_tr_b16 a[246:247], v75 offset:51200
    v_mfma_f32_16x16x32_bf16 v[248:251], a[228:231], a[24:27], v[248:251]
    ds_read_b64_tr_b16 a[248:249], v76 offset:49152
    v_mfma_f32_16x16x32_bf16 v[252:255], a[228:231], a[28:31], v[252:255]
    ds_read_b64_tr_b16 a[250:251], v76 offset:51200
    s_waitcnt lgkmcnt(6)
    v_mfma_f32_16x16x32_bf16 v[128:131], a[232:235], a[0:3], v[128:131]
    ds_read_b64_tr_b16 a[252:253], v77 offset:49152
    v_mfma_f32_16x16x32_bf16 v[132:135], a[232:235], a[4:7], v[132:135]
    ds_read_b64_tr_b16 a[254:255], v77 offset:51200
    v_mfma_f32_16x16x32_bf16 v[136:139], a[236:239], a[0:3], v[136:139]
    ds_read_b64_tr_b16 a[216:217], v78 offset:49152
    v_mfma_f32_16x16x32_bf16 v[140:143], a[236:239], a[4:7], v[140:143]
    ds_read_b64_tr_b16 a[218:219], v78 offset:51200
    s_waitcnt lgkmcnt(6)
    v_mfma_f32_16x16x32_bf16 v[144:147], a[240:243], a[0:3], v[144:147]
    ds_read_b64_tr_b16 a[220:221], v79 offset:49152
    v_mfma_f32_16x16x32_bf16 v[148:151], a[240:243], a[4:7], v[148:151]
    ds_read_b64_tr_b16 a[222:223], v79 offset:51200
    v_mfma_f32_16x16x32_bf16 v[152:155], a[244:247], a[0:3], v[152:155]
    ds_read_b64_tr_b16 a[224:225], v72 offset:49408
    v_mfma_f32_16x16x32_bf16 v[156:159], a[244:247], a[4:7], v[156:159]
    ds_read_b64_tr_b16 a[226:227], v72 offset:51456
    s_waitcnt lgkmcnt(6)
    v_mfma_f32_16x16x32_bf16 v[160:163], a[248:251], a[0:3], v[160:163]
    ds_read_b64_tr_b16 a[228:229], v73 offset:49408
    v_mfma_f32_16x16x32_bf16 v[164:167], a[248:251], a[4:7], v[164:167]
    ds_read_b64_tr_b16 a[230:231], v73 offset:51456
    v_mfma_f32_16x16x32_bf16 v[168:171], a[252:255], a[0:3], v[168:171]
    ds_read_b64_tr_b16 a[232:233], v74 offset:49408
    v_mfma_f32_16x16x32_bf16 v[172:175], a[252:255], a[4:7], v[172:175]
    ds_read_b64_tr_b16 a[234:235], v74 offset:51456
    s_waitcnt lgkmcnt(6)
    v_mfma_f32_16x16x32_bf16 v[176:179], a[216:219], a[0:3], v[176:179]
    ds_read_b64_tr_b16 a[236:237], v75 offset:49408
    v_mfma_f32_16x16x32_bf16 v[180:183], a[216:219], a[4:7], v[180:183]
    ds_read_b64_tr_b16 a[238:239], v75 offset:51456
    v_mfma_f32_16x16x32_bf16 v[184:187], a[220:223], a[0:3], v[184:187]
    ds_read_b64_tr_b16 a[240:241], v76 offset:49408
    v_mfma_f32_16x16x32_bf16 v[188:191], a[220:223], a[4:7], v[188:191]
    ds_read_b64_tr_b16 a[242:243], v76 offset:51456
    s_waitcnt lgkmcnt(6)
    v_mfma_f32_16x16x32_bf16 v[192:195], a[224:227], a[0:3], v[192:195]
    ds_read_b64_tr_b16 a[244:245], v77 offset:49408
    v_mfma_f32_16x16x32_bf16 v[196:199], a[224:227], a[4:7], v[196:199]
    ds_read_b64_tr_b16 a[246:247], v77 offset:51456
    v_mfma_f32_16x16x32_bf16 v[200:203], a[228:231], a[0:3], v[200:203]
    ds_read_b64_tr_b16 a[248:249], v78 offset:49408
    v_add_u32 v10, 0x10000, v10
    v_mfma_f32_16x16x32_bf16 v[204:207], a[228:231], a[4:7], v[204:207]
    ds_read_b64_tr_b16 a[250:251], v78 offset:51456
    s_waitcnt lgkmcnt(6)
    v_mfma_f32_16x16x32_bf16 v[208:211], a[232:235], a[0:3], v[208:211]
    ds_read_b64_tr_b16 a[252:253], v79 offset:49408
    v_mfma_f32_16x16x32_bf16 v[212:215], a[232:235], a[4:7], v[212:215]
    ds_read_b64_tr_b16 a[254:255], v79 offset:51456
    v_mfma_f32_16x16x32_bf16 v[216:219], a[236:239], a[0:3], v[216:219]
    s_barrier
    ds_read_b64_tr_b16 a[216:217], v80 offset:16384
    v_mfma_f32_16x16x32_bf16 v[220:223], a[236:239], a[4:7], v[220:223]
    ds_read_b64_tr_b16 a[218:219], v80 offset:18432
    s_waitcnt lgkmcnt(6)
    v_mfma_f32_16x16x32_bf16 v[224:227], a[240:243], a[0:3], v[224:227]
    ds_read_b64_tr_b16 a[220:221], v81 offset:16384
    v_mfma_f32_16x16x32_bf16 v[228:231], a[240:243], a[4:7], v[228:231]
    ds_read_b64_tr_b16 a[222:223], v81 offset:18432
    ds_read_b128 a[16:19], v10 offset:0
    v_mfma_f32_16x16x32_bf16 v[232:235], a[244:247], a[0:3], v[232:235]
    ds_read_b64_tr_b16 a[224:225], v82 offset:16384
    v_add_u32 v11, 0x10000, v11
    v_mfma_f32_16x16x32_bf16 v[236:239], a[244:247], a[4:7], v[236:239]
    ds_read_b64_tr_b16 a[226:227], v82 offset:18432
    s_waitcnt lgkmcnt(7)
    v_mfma_f32_16x16x32_bf16 v[240:243], a[248:251], a[0:3], v[240:243]
    ds_read_b64_tr_b16 a[228:229], v83 offset:16384
    v_mfma_f32_16x16x32_bf16 v[244:247], a[248:251], a[4:7], v[244:247]
    ds_read_b64_tr_b16 a[230:231], v83 offset:18432
    ds_read_b128 a[20:23], v10 offset:2048
    v_mfma_f32_16x16x32_bf16 v[248:251], a[252:255], a[0:3], v[248:251]
    ds_read_b64_tr_b16 a[232:233], v84 offset:16384
    v_mfma_f32_16x16x32_bf16 v[252:255], a[252:255], a[4:7], v[252:255]
    ds_read_b64_tr_b16 a[234:235], v84 offset:18432
    s_waitcnt lgkmcnt(8)
    v_mfma_f32_16x16x32_bf16 v[128:131], a[216:219], a[8:11], v[128:131]
    ds_read_b64_tr_b16 a[236:237], v85 offset:16384
    v_mfma_f32_16x16x32_bf16 v[132:135], a[216:219], a[12:15], v[132:135]
    ds_read_b64_tr_b16 a[238:239], v85 offset:18432
    ds_read_b128 a[24:27], v11 offset:0
    v_mfma_f32_16x16x32_bf16 v[136:139], a[220:223], a[8:11], v[136:139]
    ds_read_b64_tr_b16 a[240:241], v86 offset:16384
    v_mfma_f32_16x16x32_bf16 v[140:143], a[220:223], a[12:15], v[140:143]
    ds_read_b64_tr_b16 a[242:243], v86 offset:18432
    s_waitcnt lgkmcnt(8)
    v_mfma_f32_16x16x32_bf16 v[144:147], a[224:227], a[8:11], v[144:147]
    ds_read_b64_tr_b16 a[244:245], v87 offset:16384
    v_mfma_f32_16x16x32_bf16 v[148:151], a[224:227], a[12:15], v[148:151]
C_pad1:
    s_cbranch_execz C_pad4
    ds_read_b64_tr_b16 a[246:247], v87 offset:18432
    ds_read_b128 a[28:31], v11 offset:2048
    v_mfma_f32_16x16x32_bf16 v[152:155], a[228:231], a[8:11], v[152:155]
    ds_read_b64_tr_b16 a[248:249], v80 offset:16640
    v_mfma_f32_16x16x32_bf16 v[156:159], a[228:231], a[12:15], v[156:159]
    ds_read_b64_tr_b16 a[250:251], v80 offset:18688
    s_waitcnt lgkmcnt(8)
    v_mfma_f32_16x16x32_bf16 v[160:163], a[232:235], a[8:11], v[160:163]
    ds_read_b64_tr_b16 a[252:253], v81 offset:16640
    v_mfma_f32_16x16x32_bf16 v[164:167], a[232:235], a[12:15], v[164:167]
    ds_read_b64_tr_b16 a[254:255], v81 offset:18688
    v_mfma_f32_16x16x32_bf16 v[168:171], a[236:239], a[8:11], v[168:171]
    ds_read_b64_tr_b16 a[216:217], v82 offset:16640
    v_mfma_f32_16x16x32_bf16 v[172:175], a[236:239], a[12:15], v[172:175]
    ds_read_b64_tr_b16 a[218:219], v82 offset:18688
    s_waitcnt lgkmcnt(7)
    v_mfma_f32_16x16x32_bf16 v[176:179], a[240:243], a[8:11], v[176:179]
    ds_read_b64_tr_b16 a[220:221], v83 offset:16640
    v_mfma_f32_16x16x32_bf16 v[180:183], a[240:243], a[12:15], v[180:183]
    ds_read_b64_tr_b16 a[222:223], v83 offset:18688
    v_mfma_f32_16x16x32_bf16 v[184:187], a[244:247], a[8:11], v[184:187]
    ds_read_b64_tr_b16 a[224:225], v84 offset:16640
    v_mfma_f32_16x16x32_bf16 v[188:191], a[244:247], a[12:15], v[188:191]
    ds_read_b64_tr_b16 a[226:227], v84 offset:18688
    s_waitcnt lgkmcnt(6)
    v_mfma_f32_16x16x32_bf16 v[192:195], a[248:251], a[8:11], v[192:195]
    ds_read_b64_tr_b16 a[228:229], v85 offset:16640
    v_mfma_f32_16x16x32_bf16 v[196:199], a[248:251], a[12:15], v[196:199]
    ds_read_b64_tr_b16 a[230:231], v85 offset:18688
    v_mfma_f32_16x16x32_bf16 v[200:203], a[252:255], a[8:11], v[200:203]
    ds_read_b64_tr_b16 a[232:233], v86 offset:16640
    v_mfma_f32_16x16x32_bf16 v[204:207], a[252:255], a[12:15], v[204:207]
    ds_read_b64_tr_b16 a[234:235], v86 offset:18688
    s_waitcnt lgkmcnt(6)
    v_mfma_f32_16x16x32_bf16 v[208:211], a[216:219], a[8:11], v[208:211]
    ds_read_b64_tr_b16 a[236:237], v87 offset:16640
    v_mfma_f32_16x16x32_bf16 v[212:215], a[216:219], a[12:15], v[212:215]
    ds_read_b64_tr_b16 a[238:239], v87 offset:18688
    v_mfma_f32_16x16x32_bf16 v[216:219], a[220:223], a[8:11], v[216:219]
    s_barrier
    ds_read_b64_tr_b16 a[240:241], v64 offset:0
    v_mfma_f32_16x16x32_bf16 v[220:223], a[220:223], a[12:15], v[220:223]
    ds_read_b64_tr_b16 a[242:243], v64 offset:2048
    s_waitcnt lgkmcnt(6)
    v_mfma_f32_16x16x32_bf16 v[224:227], a[224:227], a[8:11], v[224:227]
    ds_read_b64_tr_b16 a[244:245], v65 offset:0
    v_mfma_f32_16x16x32_bf16 v[228:231], a[224:227], a[12:15], v[228:231]
    ds_read_b64_tr_b16 a[246:247], v65 offset:2048
    v_mfma_f32_16x16x32_bf16 v[232:235], a[228:231], a[8:11], v[232:235]
    ds_read_b64_tr_b16 a[248:249], v66 offset:0
    v_mfma_f32_16x16x32_bf16 v[236:239], a[228:231], a[12:15], v[236:239]
    ds_read_b64_tr_b16 a[250:251], v66 offset:2048
    s_waitcnt lgkmcnt(6)
    v_mfma_f32_16x16x32_bf16 v[240:243], a[232:235], a[8:11], v[240:243]
    ds_read_b64_tr_b16 a[252:253], v67 offset:0
    v_mfma_f32_16x16x32_bf16 v[244:247], a[232:235], a[12:15], v[244:247]
    ds_read_b64_tr_b16 a[254:255], v67 offset:2048
    v_mfma_f32_16x16x32_bf16 v[248:251], a[236:239], a[8:11], v[248:251]
    ds_read_b64_tr_b16 a[216:217], v68 offset:0
    v_mfma_f32_16x16x32_bf16 v[252:255], a[236:239], a[12:15], v[252:255]
    ds_read_b64_tr_b16 a[218:219], v68 offset:2048
    s_waitcnt lgkmcnt(6)
    v_mfma_f32_16x16x32_bf16 v[128:131], a[240:243], a[16:19], v[128:131]
    ds_read_b64_tr_b16 a[220:221], v69 offset:0
    v_mfma_f32_16x16x32_bf16 v[132:135], a[240:243], a[20:23], v[132:135]
    ds_read_b64_tr_b16 a[222:223], v69 offset:2048
    v_mfma_f32_16x16x32_bf16 v[136:139], a[244:247], a[16:19], v[136:139]
    ds_read_b64_tr_b16 a[224:225], v70 offset:0
    v_mfma_f32_16x16x32_bf16 v[140:143], a[244:247], a[20:23], v[140:143]
    ds_read_b64_tr_b16 a[226:227], v70 offset:2048
    s_waitcnt lgkmcnt(6)
    v_mfma_f32_16x16x32_bf16 v[144:147], a[248:251], a[16:19], v[144:147]
    ds_read_b64_tr_b16 a[228:229], v71 offset:0
    v_mfma_f32_16x16x32_bf16 v[148:151], a[248:251], a[20:23], v[148:151]
    ds_read_b64_tr_b16 a[230:231], v71 offset:2048
    v_mfma_f32_16x16x32_bf16 v[152:155], a[252:255], a[16:19], v[152:155]
    ds_read_b64_tr_b16 a[232:233], v64 offset:256
    v_mfma_f32_16x16x32_bf16 v[156:159], a[252:255], a[20:23], v[156:159]
    ds_read_b64_tr_b16 a[234:235], v64 offset:2304
    s_waitcnt lgkmcnt(6)
    v_mfma_f32_16x16x32_bf16 v[160:163], a[216:219], a[16:19], v[160:163]
    ds_read_b64_tr_b16 a[236:237], v65 offset:256
    v_mfma_f32_16x16x32_bf16 v[164:167], a[216:219], a[20:23], v[164:167]
    ds_read_b64_tr_b16 a[238:239], v65 offset:2304
    v_mfma_f32_16x16x32_bf16 v[168:171], a[220:223], a[16:19], v[168:171]
    ds_read_b64_tr_b16 a[240:241], v66 offset:256
    v_mfma_f32_16x16x32_bf16 v[172:175], a[220:223], a[20:23], v[172:175]
    ds_read_b64_tr_b16 a[242:243], v66 offset:2304
    s_waitcnt lgkmcnt(6)
    v_mfma_f32_16x16x32_bf16 v[176:179], a[224:227], a[16:19], v[176:179]
    ds_read_b64_tr_b16 a[244:245], v67 offset:256
    v_mfma_f32_16x16x32_bf16 v[180:183], a[224:227], a[20:23], v[180:183]
    ds_read_b64_tr_b16 a[246:247], v67 offset:2304
    v_mfma_f32_16x16x32_bf16 v[184:187], a[228:231], a[16:19], v[184:187]
    ds_read_b64_tr_b16 a[248:249], v68 offset:256
    v_mfma_f32_16x16x32_bf16 v[188:191], a[228:231], a[20:23], v[188:191]
    ds_read_b64_tr_b16 a[250:251], v68 offset:2304
    s_waitcnt lgkmcnt(6)
    v_mfma_f32_16x16x32_bf16 v[192:195], a[232:235], a[16:19], v[192:195]
    ds_read_b64_tr_b16 a[252:253], v69 offset:256
    v_mfma_f32_16x16x32_bf16 v[196:199], a[232:235], a[20:23], v[196:199]
    ds_read_b64_tr_b16 a[254:255], v69 offset:2304
    v_mfma_f32_16x16x32_bf16 v[200:203], a[236:239], a[16:19], v[200:203]
    ds_read_b64_tr_b16 a[216:217], v70 offset:256
    v_add_u32 v10, 0xfffe0000, v10
    v_mfma_f32_16x16x32_bf16 v[204:207], a[236:239], a[20:23], v[204:207]
    ds_read_b64_tr_b16 a[218:219], v70 offset:2304
    s_waitcnt lgkmcnt(6)
    v_mfma_f32_16x16x32_bf16 v[208:211], a[240:243], a[16:19], v[208:211]
    ds_read_b64_tr_b16 a[220:221], v71 offset:256
    v_mfma_f32_16x16x32_bf16 v[212:215], a[240:243], a[20:23], v[212:215]
    ds_read_b64_tr_b16 a[222:223], v71 offset:2304
    v_mfma_f32_16x16x32_bf16 v[216:219], a[244:247], a[16:19], v[216:219]
    s_barrier
    ds_read_b64_tr_b16 a[224:225], v64 offset:32768
    v_mfma_f32_16x16x32_bf16 v[220:223], a[244:247], a[20:23], v[220:223]
    ds_read_b64_tr_b16 a[226:227], v64 offset:34816
    s_waitcnt lgkmcnt(6)
    v_mfma_f32_16x16x32_bf16 v[224:227], a[248:251], a[16:19], v[224:227]
    ds_read_b64_tr_b16 a[228:229], v65 offset:32768
    v_mfma_f32_16x16x32_bf16 v[228:231], a[248:251], a[20:23], v[228:231]
    ds_read_b64_tr_b16 a[230:231], v65 offset:34816
    ds_read_b128 a[0:3], v10 offset:16384
    v_mfma_f32_16x16x32_bf16 v[232:235], a[252:255], a[16:19], v[232:235]
    ds_read_b64_tr_b16 a[232:233], v66 offset:32768
    v_add_u32 v11, 0xfffe0000, v11
    v_mfma_f32_16x16x32_bf16 v[236:239], a[252:255], a[20:23], v[236:239]
    ds_read_b64_tr_b16 a[234:235], v66 offset:34816
    s_waitcnt lgkmcnt(7)
    v_mfma_f32_16x16x32_bf16 v[240:243], a[216:219], a[16:19], v[240:243]
    ds_read_b64_tr_b16 a[236:237], v67 offset:32768
    v_mfma_f32_16x16x32_bf16 v[244:247], a[216:219], a[20:23], v[244:247]
    ds_read_b64_tr_b16 a[238:239], v67 offset:34816
    ds_read_b128 a[4:7], v10 offset:18432
    v_mfma_f32_16x16x32_bf16 v[248:251], a[220:223], a[16:19], v[248:251]
    ds_read_b64_tr_b16 a[240:241], v68 offset:32768
    v_mfma_f32_16x16x32_bf16 v[252:255], a[220:223], a[20:23], v[252:255]
    ds_read_b64_tr_b16 a[242:243], v68 offset:34816
    s_waitcnt lgkmcnt(8)
    v_mfma_f32_16x16x32_bf16 v[128:131], a[224:227], a[24:27], v[128:131]
    ds_read_b64_tr_b16 a[244:245], v69 offset:32768
    v_mfma_f32_16x16x32_bf16 v[132:135], a[224:227], a[28:31], v[132:135]
    ds_read_b64_tr_b16 a[246:247], v69 offset:34816
    ds_read_b128 a[8:11], v11 offset:16384
    v_mfma_f32_16x16x32_bf16 v[136:139], a[228:231], a[24:27], v[136:139]
    ds_read_b64_tr_b16 a[248:249], v70 offset:32768
    v_mfma_f32_16x16x32_bf16 v[140:143], a[228:231], a[28:31], v[140:143]
    ds_read_b64_tr_b16 a[250:251], v70 offset:34816
    s_waitcnt lgkmcnt(8)
    v_mfma_f32_16x16x32_bf16 v[144:147], a[232:235], a[24:27], v[144:147]
    ds_read_b64_tr_b16 a[252:253], v71 offset:32768
    v_mfma_f32_16x16x32_bf16 v[148:151], a[232:235], a[28:31], v[148:151]
    ds_read_b64_tr_b16 a[254:255], v71 offset:34816
    ds_read_b128 a[12:15], v11 offset:18432
    v_mfma_f32_16x16x32_bf16 v[152:155], a[236:239], a[24:27], v[152:155]
    ds_read_b64_tr_b16 a[216:217], v64 offset:33024
    v_mfma_f32_16x16x32_bf16 v[156:159], a[236:239], a[28:31], v[156:159]
    ds_read_b64_tr_b16 a[218:219], v64 offset:35072
    s_waitcnt lgkmcnt(8)
    v_mfma_f32_16x16x32_bf16 v[160:163], a[240:243], a[24:27], v[160:163]
    ds_read_b64_tr_b16 a[220:221], v65 offset:33024
    v_mfma_f32_16x16x32_bf16 v[164:167], a[240:243], a[28:31], v[164:167]
    ds_read_b64_tr_b16 a[222:223], v65 offset:35072
    v_mfma_f32_16x16x32_bf16 v[168:171], a[244:247], a[24:27], v[168:171]
    ds_read_b64_tr_b16 a[224:225], v66 offset:33024
    v_mfma_f32_16x16x32_bf16 v[172:175], a[244:247], a[28:31], v[172:175]
    ds_read_b64_tr_b16 a[226:227], v66 offset:35072
    s_waitcnt lgkmcnt(7)
    v_mfma_f32_16x16x32_bf16 v[176:179], a[248:251], a[24:27], v[176:179]
    ds_read_b64_tr_b16 a[228:229], v67 offset:33024
    v_mfma_f32_16x16x32_bf16 v[180:183], a[248:251], a[28:31], v[180:183]
    ds_read_b64_tr_b16 a[230:231], v67 offset:35072
    v_mfma_f32_16x16x32_bf16 v[184:187], a[252:255], a[24:27], v[184:187]
    ds_read_b64_tr_b16 a[232:233], v68 offset:33024
    v_mfma_f32_16x16x32_bf16 v[188:191], a[252:255], a[28:31], v[188:191]
    ds_read_b64_tr_b16 a[234:235], v68 offset:35072
    s_waitcnt lgkmcnt(6)
    v_mfma_f32_16x16x32_bf16 v[192:195], a[216:219], a[24:27], v[192:195]
    ds_read_b64_tr_b16 a[236:237], v69 offset:33024
    v_mfma_f32_16x16x32_bf16 v[196:199], a[216:219], a[28:31], v[196:199]
    ds_read_b64_tr_b16 a[238:239], v69 offset:35072
    v_mfma_f32_16x16x32_bf16 v[200:203], a[220:223], a[24:27], v[200:203]
    ds_read_b64_tr_b16 a[240:241], v70 offset:33024
    v_mfma_f32_16x16x32_bf16 v[204:207], a[220:223], a[28:31], v[204:207]
    ds_read_b64_tr_b16 a[242:243], v70 offset:35072
    s_waitcnt lgkmcnt(6)
    v_mfma_f32_16x16x32_bf16 v[208:211], a[224:227], a[24:27], v[208:211]
    ds_read_b64_tr_b16 a[244:245], v71 offset:33024
    v_mfma_f32_16x16x32_bf16 v[212:215], a[224:227], a[28:31], v[212:215]
    ds_read_b64_tr_b16 a[246:247], v71 offset:35072
    v_mfma_f32_16x16x32_bf16 v[216:219], a[228:231], a[24:27], v[216:219]
    s_barrier
    ds_read_b64_tr_b16 a[248:249], v64 offset:49152
    v_mfma_f32_16x16x32_bf16 v[220:223], a[228:231], a[28:31], v[220:223]
    ds_read_b64_tr_b16 a[250:251], v64 offset:51200
    s_waitcnt lgkmcnt(6)
    v_mfma_f32_16x16x32_bf16 v[224:227], a[232:235], a[24:27], v[224:227]
    ds_read_b64_tr_b16 a[252:253], v65 offset:49152
    v_mfma_f32_16x16x32_bf16 v[228:231], a[232:235], a[28:31], v[228:231]
    ds_read_b64_tr_b16 a[254:255], v65 offset:51200
    v_mfma_f32_16x16x32_bf16 v[232:235], a[236:239], a[24:27], v[232:235]
    ds_read_b64_tr_b16 a[216:217], v66 offset:49152
    v_mfma_f32_16x16x32_bf16 v[236:239], a[236:239], a[28:31], v[236:239]
    ds_read_b64_tr_b16 a[218:219], v66 offset:51200
    s_waitcnt lgkmcnt(6)
    v_mfma_f32_16x16x32_bf16 v[240:243], a[240:243], a[24:27], v[240:243]
    ds_read_b64_tr_b16 a[220:221], v67 offset:49152
    v_mfma_f32_16x16x32_bf16 v[244:247], a[240:243], a[28:31], v[244:247]
    ds_read_b64_tr_b16 a[222:223], v67 offset:51200
    v_mfma_f32_16x16x32_bf16 v[248:251], a[244:247], a[24:27], v[248:251]
    ds_read_b64_tr_b16 a[224:225], v68 offset:49152
    v_mfma_f32_16x16x32_bf16 v[252:255], a[244:247], a[28:31], v[252:255]
    ds_read_b64_tr_b16 a[226:227], v68 offset:51200
    s_waitcnt lgkmcnt(6)
    v_mfma_f32_16x16x32_bf16 v[128:131], a[248:251], a[0:3], v[128:131]
    ds_read_b64_tr_b16 a[228:229], v69 offset:49152
    v_mfma_f32_16x16x32_bf16 v[132:135], a[248:251], a[4:7], v[132:135]
    ds_read_b64_tr_b16 a[230:231], v69 offset:51200
    v_mfma_f32_16x16x32_bf16 v[136:139], a[252:255], a[0:3], v[136:139]
    ds_read_b64_tr_b16 a[232:233], v70 offset:49152
    v_mfma_f32_16x16x32_bf16 v[140:143], a[252:255], a[4:7], v[140:143]
    ds_read_b64_tr_b16 a[234:235], v70 offset:51200
    s_waitcnt lgkmcnt(6)
    v_mfma_f32_16x16x32_bf16 v[144:147], a[216:219], a[0:3], v[144:147]
    ds_read_b64_tr_b16 a[236:237], v71 offset:49152
    v_mfma_f32_16x16x32_bf16 v[148:151], a[216:219], a[4:7], v[148:151]
    ds_read_b64_tr_b16 a[238:239], v71 offset:51200
    v_mfma_f32_16x16x32_bf16 v[152:155], a[220:223], a[0:3], v[152:155]
    ds_read_b64_tr_b16 a[240:241], v64 offset:49408
    v_mfma_f32_16x16x32_bf16 v[156:159], a[220:223], a[4:7], v[156:159]
    ds_read_b64_tr_b16 a[242:243], v64 offset:51456
    s_waitcnt lgkmcnt(6)
    v_mfma_f32_16x16x32_bf16 v[160:163], a[224:227], a[0:3], v[160:163]
    ds_read_b64_tr_b16 a[244:245], v65 offset:49408
    v_mfma_f32_16x16x32_bf16 v[164:167], a[224:227], a[4:7], v[164:167]
    ds_read_b64_tr_b16 a[246:247], v65 offset:51456
    v_mfma_f32_16x16x32_bf16 v[168:171], a[228:231], a[0:3], v[168:171]
    ds_read_b64_tr_b16 a[248:249], v66 offset:49408
    v_mfma_f32_16x16x32_bf16 v[172:175], a[228:231], a[4:7], v[172:175]
    ds_read_b64_tr_b16 a[250:251], v66 offset:51456
    s_waitcnt lgkmcnt(6)
    v_mfma_f32_16x16x32_bf16 v[176:179], a[232:235], a[0:3], v[176:179]
    ds_read_b64_tr_b16 a[252:253], v67 offset:49408
    v_mfma_f32_16x16x32_bf16 v[180:183], a[232:235], a[4:7], v[180:183]
    ds_read_b64_tr_b16 a[254:255], v67 offset:51456
    v_mfma_f32_16x16x32_bf16 v[184:187], a[236:239], a[0:3], v[184:187]
    ds_read_b64_tr_b16 a[216:217], v68 offset:49408
    v_mfma_f32_16x16x32_bf16 v[188:191], a[236:239], a[4:7], v[188:191]
    ds_read_b64_tr_b16 a[218:219], v68 offset:51456
    s_waitcnt lgkmcnt(6)
    v_mfma_f32_16x16x32_bf16 v[192:195], a[240:243], a[0:3], v[192:195]
    ds_read_b64_tr_b16 a[220:221], v69 offset:49408
    v_mfma_f32_16x16x32_bf16 v[196:199], a[240:243], a[4:7], v[196:199]
    ds_read_b64_tr_b16 a[222:223], v69 offset:51456
    v_mfma_f32_16x16x32_bf16 v[200:203], a[244:247], a[0:3], v[200:203]
    ds_read_b64_tr_b16 a[224:225], v70 offset:49408
    v_add_u32 v10, 0x10000, v10
    v_mfma_f32_16x16x32_bf16 v[204:207], a[244:247], a[4:7], v[204:207]
    ds_read_b64_tr_b16 a[226:227], v70 offset:51456
    s_waitcnt lgkmcnt(6)
    v_mfma_f32_16x16x32_bf16 v[208:211], a[248:251], a[0:3], v[208:211]
    ds_read_b64_tr_b16 a[228:229], v71 offset:49408
    v_mfma_f32_16x16x32_bf16 v[212:215], a[248:251], a[4:7], v[212:215]
    ds_read_b64_tr_b16 a[230:231], v71 offset:51456
    v_mfma_f32_16x16x32_bf16 v[216:219], a[252:255], a[0:3], v[216:219]
    s_barrier
    ds_read_b64_tr_b16 a[232:233], v72 offset:16384
    v_mfma_f32_16x16x32_bf16 v[220:223], a[252:255], a[4:7], v[220:223]
    ds_read_b64_tr_b16 a[234:235], v72 offset:18432
    s_waitcnt lgkmcnt(6)
    v_mfma_f32_16x16x32_bf16 v[224:227], a[216:219], a[0:3], v[224:227]
    ds_read_b64_tr_b16 a[236:237], v73 offset:16384
    v_mfma_f32_16x16x32_bf16 v[228:231], a[216:219], a[4:7], v[228:231]
    ds_read_b64_tr_b16 a[238:239], v73 offset:18432
    ds_read_b128 a[16:19], v10 offset:0
    v_mfma_f32_16x16x32_bf16 v[232:235], a[220:223], a[0:3], v[232:235]
    ds_read_b64_tr_b16 a[240:241], v74 offset:16384
    v_add_u32 v11, 0x10000, v11
    v_mfma_f32_16x16x32_bf16 v[236:239], a[220:223], a[4:7], v[236:239]
    ds_read_b64_tr_b16 a[242:243], v74 offset:18432
    s_waitcnt lgkmcnt(7)
    v_mfma_f32_16x16x32_bf16 v[240:243], a[224:227], a[0:3], v[240:243]
    ds_read_b64_tr_b16 a[244:245], v75 offset:16384
    v_mfma_f32_16x16x32_bf16 v[244:247], a[224:227], a[4:7], v[244:247]
    ds_read_b64_tr_b16 a[246:247], v75 offset:18432
    ds_read_b128 a[20:23], v10 offset:2048
    v_mfma_f32_16x16x32_bf16 v[248:251], a[228:231], a[0:3], v[248:251]
    ds_read_b64_tr_b16 a[248:249], v76 offset:16384
    v_mfma_f32_16x16x32_bf16 v[252:255], a[228:231], a[4:7], v[252:255]
    ds_read_b64_tr_b16 a[250:251], v76 offset:18432
    s_waitcnt lgkmcnt(8)
    v_mfma_f32_16x16x32_bf16 v[128:131], a[232:235], a[8:11], v[128:131]
    ds_read_b64_tr_b16 a[252:253], v77 offset:16384
    v_mfma_f32_16x16x32_bf16 v[132:135], a[232:235], a[12:15], v[132:135]
    ds_read_b64_tr_b16 a[254:255], v77 offset:18432
    ds_read_b128 a[24:27], v11 offset:0
    v_mfma_f32_16x16x32_bf16 v[136:139], a[236:239], a[8:11], v[136:139]
    ds_read_b64_tr_b16 a[216:217], v78 offset:16384
    v_mfma_f32_16x16x32_bf16 v[140:143], a[236:239], a[12:15], v[140:143]
    ds_read_b64_tr_b16 a[218:219], v78 offset:18432
    s_waitcnt lgkmcnt(8)
    v_mfma_f32_16x16x32_bf16 v[144:147], a[240:243], a[8:11], v[144:147]
    ds_read_b64_tr_b16 a[220:221], v79 offset:16384
    v_mfma_f32_16x16x32_bf16 v[148:151], a[240:243], a[12:15], v[148:151]
    ds_read_b64_tr_b16 a[222:223], v79 offset:18432
    ds_read_b128 a[28:31], v11 offset:2048
    v_mfma_f32_16x16x32_bf16 v[152:155], a[244:247], a[8:11], v[152:155]
    ds_read_b64_tr_b16 a[224:225], v72 offset:16640
    v_mfma_f32_16x16x32_bf16 v[156:159], a[244:247], a[12:15], v[156:159]
    ds_read_b64_tr_b16 a[226:227], v72 offset:18688
    s_waitcnt lgkmcnt(8)
    v_mfma_f32_16x16x32_bf16 v[160:163], a[248:251], a[8:11], v[160:163]
    ds_read_b64_tr_b16 a[228:229], v73 offset:16640
    v_mfma_f32_16x16x32_bf16 v[164:167], a[248:251], a[12:15], v[164:167]
    ds_read_b64_tr_b16 a[230:231], v73 offset:18688
    v_mfma_f32_16x16x32_bf16 v[168:171], a[252:255], a[8:11], v[168:171]
    ds_read_b64_tr_b16 a[232:233], v74 offset:16640
    v_mfma_f32_16x16x32_bf16 v[172:175], a[252:255], a[12:15], v[172:175]
    ds_read_b64_tr_b16 a[234:235], v74 offset:18688
    s_waitcnt lgkmcnt(7)
    v_mfma_f32_16x16x32_bf16 v[176:179], a[216:219], a[8:11], v[176:179]
    ds_read_b64_tr_b16 a[236:237], v75 offset:16640
    v_mfma_f32_16x16x32_bf16 v[180:183], a[216:219], a[12:15], v[180:183]
    ds_read_b64_tr_b16 a[238:239], v75 offset:18688
    v_mfma_f32_16x16x32_bf16 v[184:187], a[220:223], a[8:11], v[184:187]
    ds_read_b64_tr_b16 a[240:241], v76 offset:16640
    v_mfma_f32_16x16x32_bf16 v[188:191], a[220:223], a[12:15], v[188:191]
    ds_read_b64_tr_b16 a[242:243], v76 offset:18688
    s_waitcnt lgkmcnt(6)
    v_mfma_f32_16x16x32_bf16 v[192:195], a[224:227], a[8:11], v[192:195]
    ds_read_b64_tr_b16 a[244:245], v77 offset:16640
    v_mfma_f32_16x16x32_bf16 v[196:199], a[224:227], a[12:15], v[196:199]
    ds_read_b64_tr_b16 a[246:247], v77 offset:18688
    v_mfma_f32_16x16x32_bf16 v[200:203], a[228:231], a[8:11], v[200:203]
    ds_read_b64_tr_b16 a[248:249], v78 offset:16640
    v_mfma_f32_16x16x32_bf16 v[204:207], a[228:231], a[12:15], v[204:207]
    ds_read_b64_tr_b16 a[250:251], v78 offset:18688
    s_waitcnt lgkmcnt(6)
    v_mfma_f32_16x16x32_bf16 v[208:211], a[232:235], a[8:11], v[208:211]
    ds_read_b64_tr_b16 a[252:253], v79 offset:16640
    v_mfma_f32_16x16x32_bf16 v[212:215], a[232:235], a[12:15], v[212:215]
    ds_read_b64_tr_b16 a[254:255], v79 offset:18688
    v_mfma_f32_16x16x32_bf16 v[216:219], a[236:239], a[8:11], v[216:219]
    s_barrier
    ds_read_b64_tr_b16 a[216:217], v72 offset:32768
    v_mfma_f32_16x16x32_bf16 v[220:223], a[236:239], a[12:15], v[220:223]
    ds_read_b64_tr_b16 a[218:219], v72 offset:34816
    s_waitcnt lgkmcnt(6)
    v_mfma_f32_16x16x32_bf16 v[224:227], a[240:243], a[8:11], v[224:227]
    ds_read_b64_tr_b16 a[220:221], v73 offset:32768
    v_mfma_f32_16x16x32_bf16 v[228:231], a[240:243], a[12:15], v[228:231]
    ds_read_b64_tr_b16 a[222:223], v73 offset:34816
    v_mfma_f32_16x16x32_bf16 v[232:235], a[244:247], a[8:11], v[232:235]
    ds_read_b64_tr_b16 a[224:225], v74 offset:32768
    v_mfma_f32_16x16x32_bf16 v[236:239], a[244:247], a[12:15], v[236:239]
    ds_read_b64_tr_b16 a[226:227], v74 offset:34816
    s_waitcnt lgkmcnt(6)
    v_mfma_f32_16x16x32_bf16 v[240:243], a[248:251], a[8:11], v[240:243]
    ds_read_b64_tr_b16 a[228:229], v75 offset:32768
    v_mfma_f32_16x16x32_bf16 v[244:247], a[248:251], a[12:15], v[244:247]
    ds_read_b64_tr_b16 a[230:231], v75 offset:34816
    v_mfma_f32_16x16x32_bf16 v[248:251], a[252:255], a[8:11], v[248:251]
    ds_read_b64_tr_b16 a[232:233], v76 offset:32768
    v_mfma_f32_16x16x32_bf16 v[252:255], a[252:255], a[12:15], v[252:255]
    ds_read_b64_tr_b16 a[234:235], v76 offset:34816
    s_waitcnt lgkmcnt(6)
    v_mfma_f32_16x16x32_bf16 v[128:131], a[216:219], a[16:19], v[128:131]
    ds_read_b64_tr_b16 a[236:237], v77 offset:32768
    v_mfma_f32_16x16x32_bf16 v[132:135], a[216:219], a[20:23], v[132:135]
    ds_read_b64_tr_b16 a[238:239], v77 offset:34816
    v_mfma_f32_16x16x32_bf16 v[136:139], a[220:223], a[16:19], v[136:139]
    ds_read_b64_tr_b16 a[240:241], v78 offset:32768
    v_mfma_f32_16x16x32_bf16 v[140:143], a[220:223], a[20:23], v[140:143]
    ds_read_b64_tr_b16 a[242:243], v78 offset:34816
    s_waitcnt lgkmcnt(6)
    v_mfma_f32_16x16x32_bf16 v[144:147], a[224:227], a[16:19], v[144:147]
    ds_read_b64_tr_b16 a[244:245], v79 offset:32768
    v_mfma_f32_16x16x32_bf16 v[148:151], a[224:227], a[20:23], v[148:151]
    ds_read_b64_tr_b16 a[246:247], v79 offset:34816
    v_mfma_f32_16x16x32_bf16 v[152:155], a[228:231], a[16:19], v[152:155]
    ds_read_b64_tr_b16 a[248:249], v72 offset:33024
    v_mfma_f32_16x16x32_bf16 v[156:159], a[228:231], a[20:23], v[156:159]
    ds_read_b64_tr_b16 a[250:251], v72 offset:35072
    s_waitcnt lgkmcnt(6)
    v_mfma_f32_16x16x32_bf16 v[160:163], a[232:235], a[16:19], v[160:163]
    ds_read_b64_tr_b16 a[252:253], v73 offset:33024
    v_mfma_f32_16x16x32_bf16 v[164:167], a[232:235], a[20:23], v[164:167]
    ds_read_b64_tr_b16 a[254:255], v73 offset:35072
    v_mfma_f32_16x16x32_bf16 v[168:171], a[236:239], a[16:19], v[168:171]
    ds_read_b64_tr_b16 a[216:217], v74 offset:33024
    v_mfma_f32_16x16x32_bf16 v[172:175], a[236:239], a[20:23], v[172:175]
    ds_read_b64_tr_b16 a[218:219], v74 offset:35072
    s_waitcnt lgkmcnt(6)
    v_mfma_f32_16x16x32_bf16 v[176:179], a[240:243], a[16:19], v[176:179]
    ds_read_b64_tr_b16 a[220:221], v75 offset:33024
    v_mfma_f32_16x16x32_bf16 v[180:183], a[240:243], a[20:23], v[180:183]
    ds_read_b64_tr_b16 a[222:223], v75 offset:35072
    v_mfma_f32_16x16x32_bf16 v[184:187], a[244:247], a[16:19], v[184:187]
    ds_read_b64_tr_b16 a[224:225], v76 offset:33024
    v_mfma_f32_16x16x32_bf16 v[188:191], a[244:247], a[20:23], v[188:191]
    ds_read_b64_tr_b16 a[226:227], v76 offset:35072
    s_waitcnt lgkmcnt(6)
    v_mfma_f32_16x16x32_bf16 v[192:195], a[248:251], a[16:19], v[192:195]
    ds_read_b64_tr_b16 a[228:229], v77 offset:33024
    v_mfma_f32_16x16x32_bf16 v[196:199], a[248:251], a[20:23], v[196:199]
    ds_read_b64_tr_b16 a[230:231], v77 offset:35072
    v_mfma_f32_16x16x32_bf16 v[200:203], a[252:255], a[16:19], v[200:203]
    ds_read_b64_tr_b16 a[232:233], v78 offset:33024
    v_mfma_f32_16x16x32_bf16 v[204:207], a[252:255], a[20:23], v[204:207]
    ds_read_b64_tr_b16 a[234:235], v78 offset:35072
    s_waitcnt lgkmcnt(6)
    v_mfma_f32_16x16x32_bf16 v[208:211], a[216:219], a[16:19], v[208:211]
    ds_read_b64_tr_b16 a[236:237], v79 offset:33024
    v_mfma_f32_16x16x32_bf16 v[212:215], a[216:219], a[20:23], v[212:215]
    ds_read_b64_tr_b16 a[238:239], v79 offset:35072
    v_mfma_f32_16x16x32_bf16 v[216:219], a[220:223], a[16:19], v[216:219]
    s_barrier
    ds_read_b64_tr_b16 a[240:241], v80 offset:0
    v_mfma_f32_16x16x32_bf16 v[220:223], a[220:223], a[20:23], v[220:223]
    ds_read_b64_tr_b16 a[242:243], v80 offset:2048
    s_waitcnt lgkmcnt(6)
    v_mfma_f32_16x16x32_bf16 v[224:227], a[224:227], a[16:19], v[224:227]
    ds_read_b64_tr_b16 a[244:245], v81 offset:0
    v_mfma_f32_16x16x32_bf16 v[228:231], a[224:227], a[20:23], v[228:231]
    ds_read_b64_tr_b16 a[246:247], v81 offset:2048
    ds_read_b128 a[0:3], v10 offset:49152
    v_mfma_f32_16x16x32_bf16 v[232:235], a[228:231], a[16:19], v[232:235]
    ds_read_b64_tr_b16 a[248:249], v82 offset:0
    v_mfma_f32_16x16x32_bf16 v[236:239], a[228:231], a[20:23], v[236:239]
    ds_read_b64_tr_b16 a[250:251], v82 offset:2048
    s_waitcnt lgkmcnt(7)
    v_mfma_f32_16x16x32_bf16 v[240:243], a[232:235], a[16:19], v[240:243]
    ds_read_b64_tr_b16 a[252:253], v83 offset:0
    v_mfma_f32_16x16x32_bf16 v[244:247], a[232:235], a[20:23], v[244:247]
    ds_read_b64_tr_b16 a[254:255], v83 offset:2048
    ds_read_b128 a[4:7], v10 offset:51200
    v_mfma_f32_16x16x32_bf16 v[248:251], a[236:239], a[16:19], v[248:251]
    ds_read_b64_tr_b16 a[216:217], v84 offset:0
    v_mfma_f32_16x16x32_bf16 v[252:255], a[236:239], a[20:23], v[252:255]
    ds_read_b64_tr_b16 a[218:219], v84 offset:2048
    s_waitcnt lgkmcnt(8)
    v_mfma_f32_16x16x32_bf16 v[128:131], a[240:243], a[24:27], v[128:131]
    ds_read_b64_tr_b16 a[220:221], v85 offset:0
    v_mfma_f32_16x16x32_bf16 v[132:135], a[240:243], a[28:31], v[132:135]
    ds_read_b64_tr_b16 a[222:223], v85 offset:2048
    ds_read_b128 a[8:11], v11 offset:49152
    v_mfma_f32_16x16x32_bf16 v[136:139], a[244:247], a[24:27], v[136:139]
    ds_read_b64_tr_b16 a[224:225], v86 offset:0
    v_mfma_f32_16x16x32_bf16 v[140:143], a[244:247], a[28:31], v[140:143]
    ds_read_b64_tr_b16 a[226:227], v86 offset:2048
    s_waitcnt lgkmcnt(8)
    v_mfma_f32_16x16x32_bf16 v[144:147], a[248:251], a[24:27], v[144:147]
    ds_read_b64_tr_b16 a[228:229], v87 offset:0
    v_mfma_f32_16x16x32_bf16 v[148:151], a[248:251], a[28:31], v[148:151]
    ds_read_b64_tr_b16 a[230:231], v87 offset:2048
    ds_read_b128 a[12:15], v11 offset:51200
    v_mfma_f32_16x16x32_bf16 v[152:155], a[252:255], a[24:27], v[152:155]
    ds_read_b64_tr_b16 a[232:233], v80 offset:256
    v_mfma_f32_16x16x32_bf16 v[156:159], a[252:255], a[28:31], v[156:159]
    ds_read_b64_tr_b16 a[234:235], v80 offset:2304
    s_waitcnt lgkmcnt(8)
    v_mfma_f32_16x16x32_bf16 v[160:163], a[216:219], a[24:27], v[160:163]
    ds_read_b64_tr_b16 a[236:237], v81 offset:256
    v_mfma_f32_16x16x32_bf16 v[164:167], a[216:219], a[28:31], v[164:167]
    ds_read_b64_tr_b16 a[238:239], v81 offset:2304
    v_mfma_f32_16x16x32_bf16 v[168:171], a[220:223], a[24:27], v[168:171]
    ds_read_b64_tr_b16 a[240:241], v82 offset:256
    v_mfma_f32_16x16x32_bf16 v[172:175], a[220:223], a[28:31], v[172:175]
    ds_read_b64_tr_b16 a[242:243], v82 offset:2304
    s_waitcnt lgkmcnt(7)
    v_mfma_f32_16x16x32_bf16 v[176:179], a[224:227], a[24:27], v[176:179]
    ds_read_b64_tr_b16 a[244:245], v83 offset:256
    v_mfma_f32_16x16x32_bf16 v[180:183], a[224:227], a[28:31], v[180:183]
    ds_read_b64_tr_b16 a[246:247], v83 offset:2304
    v_mfma_f32_16x16x32_bf16 v[184:187], a[228:231], a[24:27], v[184:187]
    ds_read_b64_tr_b16 a[248:249], v84 offset:256
    v_mfma_f32_16x16x32_bf16 v[188:191], a[228:231], a[28:31], v[188:191]
    ds_read_b64_tr_b16 a[250:251], v84 offset:2304
    s_waitcnt lgkmcnt(6)
    v_mfma_f32_16x16x32_bf16 v[192:195], a[232:235], a[24:27], v[192:195]
    ds_read_b64_tr_b16 a[252:253], v85 offset:256
    v_mfma_f32_16x16x32_bf16 v[196:199], a[232:235], a[28:31], v[196:199]
    ds_read_b64_tr_b16 a[254:255], v85 offset:2304
    v_mfma_f32_16x16x32_bf16 v[200:203], a[236:239], a[24:27], v[200:203]
    ds_read_b64_tr_b16 a[216:217], v86 offset:256
    v_mfma_f32_16x16x32_bf16 v[204:207], a[236:239], a[28:31], v[204:207]
    ds_read_b64_tr_b16 a[218:219], v86 offset:2304
    s_waitcnt lgkmcnt(6)
    v_mfma_f32_16x16x32_bf16 v[208:211], a[240:243], a[24:27], v[208:211]
    ds_read_b64_tr_b16 a[220:221], v87 offset:256
    v_mfma_f32_16x16x32_bf16 v[212:215], a[240:243], a[28:31], v[212:215]
    ds_read_b64_tr_b16 a[222:223], v87 offset:2304
    v_mfma_f32_16x16x32_bf16 v[216:219], a[244:247], a[24:27], v[216:219]
    s_barrier
    ds_read_b64_tr_b16 a[224:225], v80 offset:16384
    v_mfma_f32_16x16x32_bf16 v[220:223], a[244:247], a[28:31], v[220:223]
    ds_read_b64_tr_b16 a[226:227], v80 offset:18432
    s_waitcnt lgkmcnt(6)
    v_mfma_f32_16x16x32_bf16 v[224:227], a[248:251], a[24:27], v[224:227]
    ds_read_b64_tr_b16 a[228:229], v81 offset:16384
    v_mfma_f32_16x16x32_bf16 v[228:231], a[248:251], a[28:31], v[228:231]
    ds_read_b64_tr_b16 a[230:231], v81 offset:18432
    v_mfma_f32_16x16x32_bf16 v[232:235], a[252:255], a[24:27], v[232:235]
    ds_read_b64_tr_b16 a[232:233], v82 offset:16384
    v_mfma_f32_16x16x32_bf16 v[236:239], a[252:255], a[28:31], v[236:239]
    ds_read_b64_tr_b16 a[234:235], v82 offset:18432
    s_waitcnt lgkmcnt(6)
    v_mfma_f32_16x16x32_bf16 v[240:243], a[216:219], a[24:27], v[240:243]
    ds_read_b64_tr_b16 a[236:237], v83 offset:16384
    v_mfma_f32_16x16x32_bf16 v[244:247], a[216:219], a[28:31], v[244:247]
    ds_read_b64_tr_b16 a[238:239], v83 offset:18432
    v_mfma_f32_16x16x32_bf16 v[248:251], a[220:223], a[24:27], v[248:251]
    ds_read_b64_tr_b16 a[240:241], v84 offset:16384
    v_mfma_f32_16x16x32_bf16 v[252:255], a[220:223], a[28:31], v[252:255]
    ds_read_b64_tr_b16 a[242:243], v84 offset:18432
    s_waitcnt lgkmcnt(6)
    v_mfma_f32_16x16x32_bf16 v[128:131], a[224:227], a[0:3], v[128:131]
    ds_read_b64_tr_b16 a[244:245], v85 offset:16384
    v_mfma_f32_16x16x32_bf16 v[132:135], a[224:227], a[4:7], v[132:135]
    ds_read_b64_tr_b16 a[246:247], v85 offset:18432
    v_mfma_f32_16x16x32_bf16 v[136:139], a[228:231], a[0:3], v[136:139]
    ds_read_b64_tr_b16 a[248:249], v86 offset:16384
    v_mfma_f32_16x16x32_bf16 v[140:143], a[228:231], a[4:7], v[140:143]
    ds_read_b64_tr_b16 a[250:251], v86 offset:18432
    s_waitcnt lgkmcnt(6)
    v_mfma_f32_16x16x32_bf16 v[144:147], a[232:235], a[0:3], v[144:147]
    ds_read_b64_tr_b16 a[252:253], v87 offset:16384
    v_mfma_f32_16x16x32_bf16 v[148:151], a[232:235], a[4:7], v[148:151]
    ds_read_b64_tr_b16 a[254:255], v87 offset:18432
    v_mfma_f32_16x16x32_bf16 v[152:155], a[236:239], a[0:3], v[152:155]
    ds_read_b64_tr_b16 a[216:217], v80 offset:16640
    v_mfma_f32_16x16x32_bf16 v[156:159], a[236:239], a[4:7], v[156:159]
    ds_read_b64_tr_b16 a[218:219], v80 offset:18688
    s_waitcnt lgkmcnt(6)
    v_mfma_f32_16x16x32_bf16 v[160:163], a[240:243], a[0:3], v[160:163]
    ds_read_b64_tr_b16 a[220:221], v81 offset:16640
    v_mfma_f32_16x16x32_bf16 v[164:167], a[240:243], a[4:7], v[164:167]
    ds_read_b64_tr_b16 a[222:223], v81 offset:18688
    v_mfma_f32_16x16x32_bf16 v[168:171], a[244:247], a[0:3], v[168:171]
    ds_read_b64_tr_b16 a[224:225], v82 offset:16640
    v_mfma_f32_16x16x32_bf16 v[172:175], a[244:247], a[4:7], v[172:175]
    ds_read_b64_tr_b16 a[226:227], v82 offset:18688
    s_waitcnt lgkmcnt(6)
    v_mfma_f32_16x16x32_bf16 v[176:179], a[248:251], a[0:3], v[176:179]
C_pad2:
    s_cbranch_execz C_pad5
    ds_read_b64_tr_b16 a[228:229], v83 offset:16640
    v_mfma_f32_16x16x32_bf16 v[180:183], a[248:251], a[4:7], v[180:183]
    ds_read_b64_tr_b16 a[230:231], v83 offset:18688
    v_mfma_f32_16x16x32_bf16 v[184:187], a[252:255], a[0:3], v[184:187]
    ds_read_b64_tr_b16 a[232:233], v84 offset:16640
    v_mfma_f32_16x16x32_bf16 v[188:191], a[252:255], a[4:7], v[188:191]
    ds_read_b64_tr_b16 a[234:235], v84 offset:18688
    s_waitcnt lgkmcnt(6)
    v_mfma_f32_16x16x32_bf16 v[192:195], a[216:219], a[0:3], v[192:195]
    ds_read_b64_tr_b16 a[236:237], v85 offset:16640
    v_mfma_f32_16x16x32_bf16 v[196:199], a[216:219], a[4:7], v[196:199]
    ds_read_b64_tr_b16 a[238:239], v85 offset:18688
    v_mfma_f32_16x16x32_bf16 v[200:203], a[220:223], a[0:3], v[200:203]
    ds_read_b64_tr_b16 a[240:241], v86 offset:16640
    v_mfma_f32_16x16x32_bf16 v[204:207], a[220:223], a[4:7], v[204:207]
    ds_read_b64_tr_b16 a[242:243], v86 offset:18688
    s_waitcnt lgkmcnt(6)
    v_mfma_f32_16x16x32_bf16 v[208:211], a[224:227], a[0:3], v[208:211]
    ds_read_b64_tr_b16 a[244:245], v87 offset:16640
    v_mfma_f32_16x16x32_bf16 v[212:215], a[224:227], a[4:7], v[212:215]
    ds_read_b64_tr_b16 a[246:247], v87 offset:18688
    v_mfma_f32_16x16x32_bf16 v[216:219], a[228:231], a[0:3], v[216:219]
    s_barrier
    ds_read_b64_tr_b16 a[248:249], v64 offset:0
    v_mfma_f32_16x16x32_bf16 v[220:223], a[228:231], a[4:7], v[220:223]
    ds_read_b64_tr_b16 a[250:251], v64 offset:2048
    s_waitcnt lgkmcnt(6)
    v_mfma_f32_16x16x32_bf16 v[224:227], a[232:235], a[0:3], v[224:227]
    ds_read_b64_tr_b16 a[252:253], v65 offset:0
    v_mfma_f32_16x16x32_bf16 v[228:231], a[232:235], a[4:7], v[228:231]
    ds_read_b64_tr_b16 a[254:255], v65 offset:2048
    v_mfma_f32_16x16x32_bf16 v[232:235], a[236:239], a[0:3], v[232:235]
    ds_read_b64_tr_b16 a[216:217], v66 offset:0
    v_mfma_f32_16x16x32_bf16 v[236:239], a[236:239], a[4:7], v[236:239]
    ds_read_b64_tr_b16 a[218:219], v66 offset:2048
    s_waitcnt lgkmcnt(6)
    v_mfma_f32_16x16x32_bf16 v[240:243], a[240:243], a[0:3], v[240:243]
    ds_read_b64_tr_b16 a[220:221], v67 offset:0
    v_mfma_f32_16x16x32_bf16 v[244:247], a[240:243], a[4:7], v[244:247]
    ds_read_b64_tr_b16 a[222:223], v67 offset:2048
    v_mfma_f32_16x16x32_bf16 v[248:251], a[244:247], a[0:3], v[248:251]
    ds_read_b64_tr_b16 a[224:225], v68 offset:0
    v_mfma_f32_16x16x32_bf16 v[252:255], a[244:247], a[4:7], v[252:255]
    ds_read_b64_tr_b16 a[226:227], v68 offset:2048
    s_waitcnt lgkmcnt(6)
    v_mfma_f32_16x16x32_bf16 v[128:131], a[248:251], a[8:11], v[128:131]
    ds_read_b64_tr_b16 a[228:229], v69 offset:0
    v_mfma_f32_16x16x32_bf16 v[132:135], a[248:251], a[12:15], v[132:135]
    ds_read_b64_tr_b16 a[230:231], v69 offset:2048
    v_mfma_f32_16x16x32_bf16 v[136:139], a[252:255], a[8:11], v[136:139]
    ds_read_b64_tr_b16 a[232:233], v70 offset:0
    v_mfma_f32_16x16x32_bf16 v[140:143], a[252:255], a[12:15], v[140:143]
    ds_read_b64_tr_b16 a[234:235], v70 offset:2048
    s_waitcnt lgkmcnt(6)
    v_mfma_f32_16x16x32_bf16 v[144:147], a[216:219], a[8:11], v[144:147]
    ds_read_b64_tr_b16 a[236:237], v71 offset:0
    v_cvt_pk_bf16_f32 v96, v128, v129
    v_cvt_pk_bf16_f32 v97, v130, v131
    v_mfma_f32_16x16x32_bf16 v[148:151], a[216:219], a[12:15], v[148:151]
    ds_read_b64_tr_b16 a[238:239], v71 offset:2048
    v_cvt_pk_bf16_f32 v98, v132, v133
    v_mfma_f32_16x16x32_bf16 v[152:155], a[220:223], a[8:11], v[152:155]
    ds_read_b64_tr_b16 a[240:241], v64 offset:256
    v_cvt_pk_bf16_f32 v99, v134, v135
    v_cvt_pk_bf16_f32 v100, v136, v137
    v_mfma_f32_16x16x32_bf16 v[156:159], a[220:223], a[12:15], v[156:159]
    ds_read_b64_tr_b16 a[242:243], v64 offset:2304
    v_cvt_pk_bf16_f32 v101, v138, v139
    s_waitcnt lgkmcnt(6)
    v_mfma_f32_16x16x32_bf16 v[160:163], a[224:227], a[8:11], v[160:163]
    ds_read_b64_tr_b16 a[244:245], v65 offset:256
    v_cvt_pk_bf16_f32 v102, v140, v141
    v_cvt_pk_bf16_f32 v103, v142, v143
    v_mfma_f32_16x16x32_bf16 v[164:167], a[224:227], a[12:15], v[164:167]
    ds_read_b64_tr_b16 a[246:247], v65 offset:2304
    v_permlane16_swap_b32 v96, v98
    v_mfma_f32_16x16x32_bf16 v[168:171], a[228:231], a[8:11], v[168:171]
    ds_read_b64_tr_b16 a[248:249], v66 offset:256
    v_permlane16_swap_b32 v97, v99
    v_cvt_pk_bf16_f32 v104, v144, v145
    v_mfma_f32_16x16x32_bf16 v[172:175], a[228:231], a[12:15], v[172:175]
    ds_read_b64_tr_b16 a[250:251], v66 offset:2304
    s_waitcnt lgkmcnt(6)
    v_mfma_f32_16x16x32_bf16 v[176:179], a[232:235], a[8:11], v[176:179]
    ds_read_b64_tr_b16 a[252:253], v67 offset:256
    v_cvt_pk_bf16_f32 v105, v146, v147
    v_cvt_pk_bf16_f32 v106, v148, v149
    v_mfma_f32_16x16x32_bf16 v[180:183], a[232:235], a[12:15], v[180:183]
    ds_read_b64_tr_b16 a[254:255], v67 offset:2304
    v_cvt_pk_bf16_f32 v107, v150, v151
    v_mfma_f32_16x16x32_bf16 v[184:187], a[236:239], a[8:11], v[184:187]
    ds_read_b64_tr_b16 a[216:217], v68 offset:256
    v_permlane16_swap_b32 v100, v102
    v_permlane16_swap_b32 v101, v103
    v_mfma_f32_16x16x32_bf16 v[188:191], a[236:239], a[12:15], v[188:191]
    ds_read_b64_tr_b16 a[218:219], v68 offset:2304
    v_cvt_pk_bf16_f32 v108, v152, v153
    s_waitcnt lgkmcnt(6)
    v_mfma_f32_16x16x32_bf16 v[192:195], a[240:243], a[8:11], v[192:195]
    ds_read_b64_tr_b16 a[220:221], v69 offset:256
    v_cvt_pk_bf16_f32 v109, v154, v155
    v_cvt_pk_bf16_f32 v110, v156, v157
    v_mfma_f32_16x16x32_bf16 v[196:199], a[240:243], a[12:15], v[196:199]
    ds_read_b64_tr_b16 a[222:223], v69 offset:2304
    v_cvt_pk_bf16_f32 v111, v158, v159
    v_mfma_f32_16x16x32_bf16 v[200:203], a[244:247], a[8:11], v[200:203]
    ds_read_b64_tr_b16 a[224:225], v70 offset:256
    v_permlane16_swap_b32 v104, v106
    v_permlane16_swap_b32 v105, v107
    v_mfma_f32_16x16x32_bf16 v[204:207], a[244:247], a[12:15], v[204:207]
    ds_read_b64_tr_b16 a[226:227], v70 offset:2304
    s_waitcnt lgkmcnt(6)
    v_mfma_f32_16x16x32_bf16 v[208:211], a[248:251], a[8:11], v[208:211]
    ds_read_b64_tr_b16 a[228:229], v71 offset:256
    ds_read_b64_tr_b16 a[230:231], v71 offset:2304
    v_mfma_f32_16x16x32_bf16 v[212:215], a[248:251], a[12:15], v[212:215]
    s_barrier
    ds_read_b128 a[232:235], v18 offset:16384
    ds_read_b128 a[236:239], v19 offset:16384
    ds_read_b128 a[240:243], v20 offset:16384
    v_mfma_f32_16x16x32_bf16 v[216:219], a[252:255], a[8:11], v[216:219]
    ds_read_b128 a[244:247], v21 offset:16384
    v_cvt_pk_bf16_f32 v112, v160, v161
    v_cvt_pk_bf16_f32 v113, v162, v163
    v_mfma_f32_16x16x32_bf16 v[220:223], a[252:255], a[12:15], v[220:223]
    v_cvt_pk_bf16_f32 v114, v164, v165
    v_cvt_pk_bf16_f32 v115, v166, v167
    s_waitcnt lgkmcnt(8)
    v_mfma_f32_16x16x32_bf16 v[224:227], a[216:219], a[8:11], v[224:227]
    ds_read_b128 a[248:251], v18 offset:17408
    v_permlane16_swap_b32 v108, v110
    v_permlane16_swap_b32 v109, v111
    v_mfma_f32_16x16x32_bf16 v[228:231], a[216:219], a[12:15], v[228:231]
    v_cvt_pk_bf16_f32 v116, v168, v169
    v_cvt_pk_bf16_f32 v117, v170, v171
    v_mfma_f32_16x16x32_bf16 v[232:235], a[220:223], a[8:11], v[232:235]
    ds_read_b128 a[252:255], v19 offset:17408
    v_cvt_pk_bf16_f32 v118, v172, v173
    v_cvt_pk_bf16_f32 v119, v174, v175
    v_mfma_f32_16x16x32_bf16 v[236:239], a[220:223], a[12:15], v[236:239]
    v_permlane16_swap_b32 v112, v114
    s_waitcnt lgkmcnt(6)
    v_mfma_f32_16x16x32_bf16 v[240:243], a[224:227], a[8:11], v[240:243]
    ds_read_b128 a[216:219], v20 offset:17408
    v_permlane16_swap_b32 v113, v115
    v_cvt_pk_bf16_f32 v120, v176, v177
    v_mfma_f32_16x16x32_bf16 v[244:247], a[224:227], a[12:15], v[244:247]
    v_cvt_pk_bf16_f32 v121, v178, v179
    v_cvt_pk_bf16_f32 v122, v180, v181
    v_mfma_f32_16x16x32_bf16 v[248:251], a[228:231], a[8:11], v[248:251]
    ds_read_b128 a[220:223], v21 offset:17408
    v_cvt_pk_bf16_f32 v123, v182, v183
    v_permlane16_swap_b32 v116, v118
    v_mfma_f32_16x16x32_bf16 v[252:255], a[228:231], a[12:15], v[252:255]
    v_permlane16_swap_b32 v117, v119
    v_cvt_pk_bf16_f32 v124, v184, v185
    s_waitcnt lgkmcnt(6)
    v_mfma_f32_32x32x16_bf16 v[48:63], a[232:235], v[96:99], 0
    ds_read_b128 a[224:227], v18 offset:18432
    v_cvt_pk_bf16_f32 v125, v186, v187
    v_cvt_pk_bf16_f32 v126, v188, v189
    v_cvt_pk_bf16_f32 v127, v190, v191
    v_permlane16_swap_b32 v120, v122
    v_permlane16_swap_b32 v121, v123
    v_cvt_pk_bf16_f32 v32, v192, v193
    v_mfma_f32_32x32x16_bf16 v[48:63], a[236:239], v[100:103], v[48:63]
    ds_read_b128 a[228:231], v19 offset:18432
    v_cvt_pk_bf16_f32 v33, v194, v195
    v_cvt_pk_bf16_f32 v34, v196, v197
    v_cvt_pk_bf16_f32 v35, v198, v199
    v_permlane16_swap_b32 v124, v126
    v_permlane16_swap_b32 v125, v127
    s_waitcnt lgkmcnt(4)
    v_mfma_f32_32x32x16_bf16 v[48:63], a[240:243], v[104:107], v[48:63]
    ds_read_b128 a[232:235], v20 offset:18432
    v_cvt_pk_bf16_f32 v36, v200, v201
    v_cvt_pk_bf16_f32 v37, v202, v203
    v_cvt_pk_bf16_f32 v38, v204, v205
    v_cvt_pk_bf16_f32 v39, v206, v207
    v_permlane16_swap_b32 v32, v34
    v_permlane16_swap_b32 v33, v35
    v_mfma_f32_32x32x16_bf16 v[48:63], a[244:247], v[108:111], v[48:63]
    ds_read_b128 a[236:239], v21 offset:18432
    v_accvgpr_write_b32 a160, v32
    v_accvgpr_write_b32 a161, v33
    v_accvgpr_write_b32 a162, v34
    v_accvgpr_write_b32 a163, v35
    v_cvt_pk_bf16_f32 v40, v208, v209
    v_cvt_pk_bf16_f32 v41, v210, v211
    v_cvt_pk_bf16_f32 v42, v212, v213
    v_mfma_f32_32x32x16_bf16 v[48:63], a[248:251], v[112:115], v[48:63]
    ds_read_b128 a[240:243], v18 offset:19456
    v_cvt_pk_bf16_f32 v43, v214, v215
    v_permlane16_swap_b32 v36, v38
    v_permlane16_swap_b32 v37, v39
    v_accvgpr_write_b32 a164, v36
    v_accvgpr_write_b32 a165, v37
    v_accvgpr_write_b32 a166, v38
    v_mfma_f32_32x32x16_bf16 v[48:63], a[252:255], v[116:119], v[48:63]
    ds_read_b128 a[244:247], v19 offset:19456
    v_accvgpr_write_b32 a167, v39
    v_cvt_pk_bf16_f32 v44, v216, v217
    v_cvt_pk_bf16_f32 v45, v218, v219
    v_cvt_pk_bf16_f32 v46, v220, v221
    v_cvt_pk_bf16_f32 v47, v222, v223
    s_waitcnt lgkmcnt(4)
    v_mfma_f32_32x32x16_bf16 v[48:63], a[216:219], v[120:123], v[48:63]
    ds_read_b128 a[248:251], v20 offset:19456
    v_permlane16_swap_b32 v40, v42
    v_permlane16_swap_b32 v41, v43
    v_accvgpr_write_b32 a168, v40
    v_accvgpr_write_b32 a169, v41
    v_accvgpr_write_b32 a170, v42
    v_accvgpr_write_b32 a171, v43
    v_mfma_f32_32x32x16_bf16 v[48:63], a[220:223], v[124:127], v[48:63]
    ds_read_b128 a[252:255], v21 offset:19456
    v_cvt_pk_bf16_f32 v32, v224, v225
    v_cvt_pk_bf16_f32 v33, v226, v227
    v_cvt_pk_bf16_f32 v34, v228, v229
    v_cvt_pk_bf16_f32 v35, v230, v231
    v_permlane16_swap_b32 v44, v46
    v_permlane16_swap_b32 v45, v47
    v_accvgpr_write_b32 a172, v44
    v_mfma_f32_32x32x16_bf16 v[48:63], a[224:227], a[160:163], v[48:63]
    s_barrier
    ds_read_b128 a[216:219], v18 offset:32768
    v_accvgpr_write_b32 a173, v45
    v_accvgpr_write_b32 a174, v46
    v_accvgpr_write_b32 a175, v47
    v_cvt_pk_bf16_f32 v36, v232, v233
    v_cvt_pk_bf16_f32 v37, v234, v235
    v_mfma_f32_32x32x16_bf16 v[48:63], a[228:231], a[164:167], v[48:63]
    ds_read_b128 a[220:223], v19 offset:32768
    v_cvt_pk_bf16_f32 v38, v236, v237
    v_cvt_pk_bf16_f32 v39, v238, v239
    v_permlane16_swap_b32 v32, v34
    v_permlane16_swap_b32 v33, v35
    v_accvgpr_write_b32 a176, v32
    s_waitcnt lgkmcnt(4)
    v_mfma_f32_32x32x16_bf16 v[48:63], a[232:235], a[168:171], v[48:63]
    ds_read_b128 a[224:227], v20 offset:32768
    v_accvgpr_write_b32 a177, v33
    v_accvgpr_write_b32 a178, v34
    v_accvgpr_write_b32 a179, v35
    v_cvt_pk_bf16_f32 v40, v240, v241
    v_cvt_pk_bf16_f32 v41, v242, v243
    v_cvt_pk_bf16_f32 v42, v244, v245
    v_mfma_f32_32x32x16_bf16 v[48:63], a[236:239], a[172:175], v[48:63]
    ds_read_b128 a[228:231], v21 offset:32768
    v_cvt_pk_bf16_f32 v43, v246, v247
    v_permlane16_swap_b32 v36, v38
    v_permlane16_swap_b32 v37, v39
    v_accvgpr_write_b32 a180, v36
    v_accvgpr_write_b32 a181, v37
    v_accvgpr_write_b32 a182, v38
    v_accvgpr_write_b32 a183, v39
    v_mfma_f32_32x32x16_bf16 v[48:63], a[240:243], a[176:179], v[48:63]
    ds_read_b128 a[232:235], v18 offset:33792
    v_cvt_pk_bf16_f32 v44, v248, v249
    v_cvt_pk_bf16_f32 v45, v250, v251
    v_cvt_pk_bf16_f32 v46, v252, v253
    v_cvt_pk_bf16_f32 v47, v254, v255
    v_permlane16_swap_b32 v40, v42
    v_permlane16_swap_b32 v41, v43
    v_mfma_f32_32x32x16_bf16 v[48:63], a[244:247], a[180:183], v[48:63]
    ds_read_b128 a[236:239], v19 offset:33792
    v_accvgpr_write_b32 a184, v40
    v_accvgpr_write_b32 a185, v41
    v_accvgpr_write_b32 a186, v42
    v_accvgpr_write_b32 a187, v43
    v_permlane16_swap_b32 v44, v46
    s_waitcnt lgkmcnt(4)
    v_mfma_f32_32x32x16_bf16 v[48:63], a[248:251], a[184:187], v[48:63]
    ds_read_b128 a[240:243], v20 offset:33792
    v_permlane16_swap_b32 v45, v47
    v_accvgpr_write_b32 a188, v44
    v_accvgpr_write_b32 a189, v45
    v_accvgpr_write_b32 a190, v46
    v_accvgpr_write_b32 a191, v47
    s_nop 1
    v_mfma_f32_32x32x16_bf16 v[48:63], a[252:255], a[188:191], v[48:63]
    ds_read_b128 a[244:247], v21 offset:33792
    v_mov_b32 v14, v8
    v_xor_b32 v15, 64, v8
    v_xor_b32 v16, 128, v8
    v_xor_b32 v17, 192, v8
    v_add_u32 v10, 0x20000, v18
    v_mfma_f32_32x32x16_bf16 v[64:79], a[216:219], v[96:99], 0
    ds_read_b128 a[248:251], v18 offset:34816
    v_add_u32 v11, 0x20000, v19
    v_add_u32 v12, 0x20000, v20
    v_add_u32 v13, 0x20000, v21
    v_lshlrev_b32 v7, 3, v5
    v_mfma_f32_32x32x16_bf16 v[64:79], a[220:223], v[100:103], v[64:79]
    ds_read_b128 a[252:255], v19 offset:34816
    s_waitcnt lgkmcnt(4)
    v_mfma_f32_32x32x16_bf16 v[64:79], a[224:227], v[104:107], v[64:79]
    ds_read_b128 a[216:219], v20 offset:34816
    v_max3_f32 v30, v48, v49, v50
    v_max3_f32 v30, v51, v52, v30
    v_max3_f32 v30, v53, v54, v30
    v_max3_f32 v30, v55, v56, v30
    v_max3_f32 v30, v57, v58, v30
    v_max3_f32 v30, v59, v60, v30
    v_mfma_f32_32x32x16_bf16 v[64:79], a[228:231], v[108:111], v[64:79]
    ds_read_b128 a[220:223], v21 offset:34816
    v_max3_f32 v30, v61, v62, v30
    v_max_f32 v30, v63, v30
    v_mov_b32 v31, v30
    s_nop 1
    v_permlane32_swap_b32 v30, v31
    v_mfma_f32_32x32x16_bf16 v[64:79], a[232:235], v[112:115], v[64:79]
    ds_read_b128 a[224:227], v18 offset:35840
    v_max_f32 v30, v30, v31
    v_mul_f32 v26, s59, v30
    v_fma_f32 v32, v48, s59, -v26
    v_exp_f32 v32, v32
    v_fma_f32 v33, v49, s59, -v26
    v_mfma_f32_32x32x16_bf16 v[64:79], a[236:239], v[116:119], v[64:79]
    ds_read_b128 a[228:231], v19 offset:35840
    v_fma_f32 v34, v50, s59, -v26
    v_exp_f32 v33, v33
    v_exp_f32 v34, v34
    s_waitcnt lgkmcnt(4)
    v_mfma_f32_32x32x16_bf16 v[64:79], a[240:243], v[120:123], v[64:79]
    ds_read_b128 a[232:235], v20 offset:35840
    v_add_f32 v27, v32, v33
    v_fma_f32 v35, v51, s59, -v26
    v_exp_f32 v35, v35
    v_add_f32 v27, v27, v34
    v_cvt_pk_bf16_f32 v128, v32, v33
    v_mfma_f32_32x32x16_bf16 v[64:79], a[244:247], v[124:127], v[64:79]
    ds_read_b128 a[236:239], v21 offset:35840
    v_fma_f32 v36, v52, s59, -v26
    v_exp_f32 v36, v36
    v_add_f32 v27, v27, v35
    v_fma_f32 v37, v53, s59, -v26
    v_mfma_f32_32x32x16_bf16 v[64:79], a[248:251], a[160:163], v[64:79]
    s_barrier
    ds_read_b128 a[240:243], v18 offset:49152
    v_exp_f32 v37, v37
    v_add_f32 v27, v27, v36
    v_cvt_pk_bf16_f32 v129, v34, v35
    v_fma_f32 v38, v54, s59, -v26
    v_mfma_f32_32x32x16_bf16 v[64:79], a[252:255], a[164:167], v[64:79]
    ds_read_b128 a[244:247], v19 offset:49152
    v_exp_f32 v38, v38
    v_add_f32 v27, v27, v37
    v_fma_f32 v39, v55, s59, -v26
    s_waitcnt lgkmcnt(4)
    v_mfma_f32_32x32x16_bf16 v[64:79], a[216:219], a[168:171], v[64:79]
    ds_read_b128 a[248:251], v20 offset:49152
    v_exp_f32 v39, v39
    v_add_f32 v27, v27, v38
    v_cvt_pk_bf16_f32 v130, v36, v37
    v_fma_f32 v40, v56, s59, -v26
    v_mfma_f32_32x32x16_bf16 v[64:79], a[220:223], a[172:175], v[64:79]
    ds_read_b128 a[252:255], v21 offset:49152
    v_exp_f32 v40, v40
    v_add_f32 v27, v27, v39
    v_fma_f32 v41, v57, s59, -v26
    v_exp_f32 v41, v41
    v_mfma_f32_32x32x16_bf16 v[64:79], a[224:227], a[176:179], v[64:79]
    ds_read_b128 a[216:219], v18 offset:50176
    v_add_f32 v27, v27, v40
    v_cvt_pk_bf16_f32 v131, v38, v39
    v_fma_f32 v42, v58, s59, -v26
    v_exp_f32 v42, v42
    v_add_f32 v27, v27, v41
    v_mfma_f32_32x32x16_bf16 v[64:79], a[228:231], a[180:183], v[64:79]
    ds_read_b128 a[220:223], v19 offset:50176
    v_fma_f32 v43, v59, s59, -v26
    v_exp_f32 v43, v43
    v_add_f32 v27, v27, v42
    v_cvt_pk_bf16_f32 v132, v40, v41
    s_waitcnt lgkmcnt(4)
    v_mfma_f32_32x32x16_bf16 v[64:79], a[232:235], a[184:187], v[64:79]
    ds_read_b128 a[224:227], v20 offset:50176
    v_fma_f32 v44, v60, s59, -v26
    v_exp_f32 v44, v44
    v_add_f32 v27, v27, v43
    v_fma_f32 v45, v61, s59, -v26
    v_mfma_f32_32x32x16_bf16 v[64:79], a[236:239], a[188:191], v[64:79]
    ds_read_b128 a[228:231], v21 offset:50176
    v_exp_f32 v45, v45
    v_add_f32 v27, v27, v44
    v_cvt_pk_bf16_f32 v133, v42, v43
    v_fma_f32 v46, v62, s59, -v26
    v_mfma_f32_32x32x16_bf16 v[80:95], a[240:243], v[96:99], 0
    ds_read_b128 a[232:235], v18 offset:51200
    v_exp_f32 v46, v46
    v_add_f32 v27, v27, v45
    v_fma_f32 v47, v63, s59, -v26
    v_exp_f32 v47, v47
    v_mfma_f32_32x32x16_bf16 v[80:95], a[244:247], v[100:103], v[80:95]
    ds_read_b128 a[236:239], v19 offset:51200
    v_add_f32 v27, v27, v46
    v_cvt_pk_bf16_f32 v134, v44, v45
    v_add_f32 v27, v27, v47
    v_cvt_pk_bf16_f32 v135, v46, v47
    s_waitcnt lgkmcnt(4)
    v_mfma_f32_32x32x16_bf16 v[80:95], a[248:251], v[104:107], v[80:95]
    ds_read_b128 a[240:243], v20 offset:51200
    v_mfma_f32_32x32x16_bf16 v[80:95], a[252:255], v[108:111], v[80:95]
    ds_read_b128 a[244:247], v21 offset:51200
    v_fma_f32 v32, v64, s59, -v26
    v_exp_f32 v32, v32
    v_fma_f32 v33, v65, s59, -v26
    v_fma_f32 v34, v66, s59, -v26
    v_mfma_f32_32x32x16_bf16 v[80:95], a[216:219], v[112:115], v[80:95]
    ds_read_b128 a[248:251], v18 offset:52224
    v_exp_f32 v33, v33
    v_exp_f32 v34, v34
    v_add_f32 v28, v32, v33
    v_mfma_f32_32x32x16_bf16 v[80:95], a[220:223], v[116:119], v[80:95]
    ds_read_b128 a[252:255], v19 offset:52224
    v_fma_f32 v35, v67, s59, -v26
    v_exp_f32 v35, v35
    v_add_f32 v28, v28, v34
    s_waitcnt lgkmcnt(4)
    v_mfma_f32_32x32x16_bf16 v[80:95], a[224:227], v[120:123], v[80:95]
    ds_read_b128 a[216:219], v20 offset:52224
    v_fma_f32 v36, v68, s59, -v26
    v_exp_f32 v36, v36
    v_add_f32 v28, v28, v35
    v_cvt_pk_bf16_f32 v136, v32, v33
    v_mfma_f32_32x32x16_bf16 v[80:95], a[228:231], v[124:127], v[80:95]
    ds_read_b128 a[220:223], v21 offset:52224
    v_fma_f32 v37, v69, s59, -v26
    v_exp_f32 v37, v37
    v_add_f32 v28, v28, v36
    v_cvt_pk_bf16_f32 v137, v34, v35
    v_mfma_f32_32x32x16_bf16 v[80:95], a[232:235], a[160:163], v[80:95]
    s_barrier
    ds_read_b128 a[224:227], v22 offset:0
    v_fma_f32 v38, v70, s59, -v26
    v_exp_f32 v38, v38
    v_add_f32 v28, v28, v37
    v_mfma_f32_32x32x16_bf16 v[80:95], a[236:239], a[164:167], v[80:95]
    ds_read_b128 a[228:231], v23 offset:0
    v_fma_f32 v39, v71, s59, -v26
    v_exp_f32 v39, v39
    v_add_f32 v28, v28, v38
    s_waitcnt lgkmcnt(4)
    v_mfma_f32_32x32x16_bf16 v[80:95], a[240:243], a[168:171], v[80:95]
    ds_read_b128 a[232:235], v24 offset:0
    v_fma_f32 v40, v72, s59, -v26
    v_exp_f32 v40, v40
    v_add_f32 v28, v28, v39
    v_cvt_pk_bf16_f32 v138, v36, v37
    v_mfma_f32_32x32x16_bf16 v[80:95], a[244:247], a[172:175], v[80:95]
    ds_read_b128 a[236:239], v25 offset:0
    v_fma_f32 v41, v73, s59, -v26
    v_exp_f32 v41, v41
    v_add_f32 v28, v28, v40
    v_cvt_pk_bf16_f32 v139, v38, v39
    v_mfma_f32_32x32x16_bf16 v[80:95], a[248:251], a[176:179], v[80:95]
    ds_read_b128 a[240:243], v22 offset:1024
    v_fma_f32 v42, v74, s59, -v26
    v_exp_f32 v42, v42
    v_add_f32 v28, v28, v41
    v_cvt_pk_bf16_f32 v140, v40, v41
    v_mfma_f32_32x32x16_bf16 v[80:95], a[252:255], a[180:183], v[80:95]
    ds_read_b128 a[244:247], v23 offset:1024
    v_fma_f32 v43, v75, s59, -v26
    v_exp_f32 v43, v43
    v_add_f32 v28, v28, v42
    s_waitcnt lgkmcnt(4)
    v_mfma_f32_32x32x16_bf16 v[80:95], a[216:219], a[184:187], v[80:95]
    ds_read_b128 a[248:251], v24 offset:1024
    v_fma_f32 v44, v76, s59, -v26
    v_exp_f32 v44, v44
    v_add_f32 v28, v28, v43
    v_cvt_pk_bf16_f32 v141, v42, v43
    v_mfma_f32_32x32x16_bf16 v[80:95], a[220:223], a[188:191], v[80:95]
    ds_read_b128 a[252:255], v25 offset:1024
    v_fma_f32 v45, v77, s59, -v26
    v_exp_f32 v45, v45
    v_add_f32 v28, v28, v44
    v_mfma_f32_32x32x16_bf16 v[48:63], a[224:227], v[96:99], 0
    ds_read_b128 a[216:219], v22 offset:2048
    v_fma_f32 v46, v78, s59, -v26
    v_exp_f32 v46, v46
    v_add_f32 v28, v28, v45
    v_cvt_pk_bf16_f32 v142, v44, v45
    v_mfma_f32_32x32x16_bf16 v[48:63], a[228:231], v[100:103], v[48:63]
    ds_read_b128 a[220:223], v23 offset:2048
    v_fma_f32 v47, v79, s59, -v26
    v_exp_f32 v47, v47
    v_add_f32 v28, v28, v46
    s_waitcnt lgkmcnt(4)
    v_mfma_f32_32x32x16_bf16 v[48:63], a[232:235], v[104:107], v[48:63]
    ds_read_b128 a[224:227], v24 offset:2048
    v_add_f32 v28, v28, v47
    v_cmp_lt_f32 vcc, s58, v28
    v_cvt_pk_bf16_f32 v143, v46, v47
    s_cbranch_vccnz C_rare1
C_back1:
    v_add_f32 v27, v27, v28
    v_mfma_f32_32x32x16_bf16 v[48:63], a[236:239], v[108:111], v[48:63]
    ds_read_b128 a[228:231], v25 offset:2048
    v_fma_f32 v32, v80, s59, -v26
    v_exp_f32 v32, v32
    v_fma_f32 v33, v81, s59, -v26
    v_fma_f32 v34, v82, s59, -v26
    v_mfma_f32_32x32x16_bf16 v[48:63], a[240:243], v[112:115], v[48:63]
    ds_read_b128 a[232:235], v22 offset:3072
    v_exp_f32 v33, v33
    v_exp_f32 v34, v34
    v_add_f32 v28, v32, v33
    v_mfma_f32_32x32x16_bf16 v[48:63], a[244:247], v[116:119], v[48:63]
    ds_read_b128 a[236:239], v23 offset:3072
    v_fma_f32 v35, v83, s59, -v26
    v_exp_f32 v35, v35
    v_add_f32 v28, v28, v34
    s_waitcnt lgkmcnt(4)
    v_mfma_f32_32x32x16_bf16 v[48:63], a[248:251], v[120:123], v[48:63]
    ds_read_b128 a[240:243], v24 offset:3072
    v_fma_f32 v36, v84, s59, -v26
    v_exp_f32 v36, v36
    v_add_f32 v28, v28, v35
    v_cvt_pk_bf16_f32 v144, v32, v33
    v_mfma_f32_32x32x16_bf16 v[48:63], a[252:255], v[124:127], v[48:63]
    ds_read_b128 a[244:247], v25 offset:3072
    v_fma_f32 v37, v85, s59, -v26
    v_exp_f32 v37, v37
    v_add_f32 v28, v28, v36
    v_cvt_pk_bf16_f32 v145, v34, v35
    v_mfma_f32_32x32x16_bf16 v[48:63], a[216:219], a[160:163], v[48:63]
    s_barrier
    ds_read_b128 a[248:251], v22 offset:16384
    v_fma_f32 v38, v86, s59, -v26
    v_exp_f32 v38, v38
    v_add_f32 v28, v28, v37
    v_mfma_f32_32x32x16_bf16 v[48:63], a[220:223], a[164:167], v[48:63]
    ds_read_b128 a[252:255], v23 offset:16384
    v_fma_f32 v39, v87, s59, -v26
    v_exp_f32 v39, v39
    v_add_f32 v28, v28, v38
    s_waitcnt lgkmcnt(4)
    v_mfma_f32_32x32x16_bf16 v[48:63], a[224:227], a[168:171], v[48:63]
    ds_read_b128 a[216:219], v24 offset:16384
    v_fma_f32 v40, v88, s59, -v26
    v_exp_f32 v40, v40
    v_add_f32 v28, v28, v39
    v_cvt_pk_bf16_f32 v146, v36, v37
    v_mfma_f32_32x32x16_bf16 v[48:63], a[228:231], a[172:175], v[48:63]
    ds_read_b128 a[220:223], v25 offset:16384
    v_fma_f32 v41, v89, s59, -v26
    v_exp_f32 v41, v41
    v_add_f32 v28, v28, v40
    v_cvt_pk_bf16_f32 v147, v38, v39
    v_mfma_f32_32x32x16_bf16 v[48:63], a[232:235], a[176:179], v[48:63]
    ds_read_b128 a[224:227], v22 offset:17408
    v_fma_f32 v42, v90, s59, -v26
    v_exp_f32 v42, v42
    v_add_f32 v28, v28, v41
    v_cvt_pk_bf16_f32 v148, v40, v41
    v_mfma_f32_32x32x16_bf16 v[48:63], a[236:239], a[180:183], v[48:63]
    ds_read_b128 a[228:231], v23 offset:17408
    v_fma_f32 v43, v91, s59, -v26
    v_exp_f32 v43, v43
    v_add_f32 v28, v28, v42
    s_waitcnt lgkmcnt(4)
    v_mfma_f32_32x32x16_bf16 v[48:63], a[240:243], a[184:187], v[48:63]
    ds_read_b128 a[232:235], v24 offset:17408
    v_fma_f32 v44, v92, s59, -v26
    v_exp_f32 v44, v44
    v_add_f32 v28, v28, v43
    v_cvt_pk_bf16_f32 v149, v42, v43
    v_mfma_f32_32x32x16_bf16 v[48:63], a[244:247], a[188:191], v[48:63]
    ds_read_b128 a[236:239], v25 offset:17408
    v_fma_f32 v45, v93, s59, -v26
    v_exp_f32 v45, v45
    v_add_f32 v28, v28, v44
    v_mfma_f32_32x32x16_bf16 v[64:79], a[248:251], v[96:99], 0
    ds_read_b128 a[240:243], v22 offset:18432
    v_fma_f32 v46, v94, s59, -v26
    v_exp_f32 v46, v46
    v_add_f32 v28, v28, v45
    v_cvt_pk_bf16_f32 v150, v44, v45
    v_mfma_f32_32x32x16_bf16 v[64:79], a[252:255], v[100:103], v[64:79]
    ds_read_b128 a[244:247], v23 offset:18432
    v_fma_f32 v47, v95, s59, -v26
    v_exp_f32 v47, v47
    v_add_f32 v28, v28, v46
    s_waitcnt lgkmcnt(4)
    v_mfma_f32_32x32x16_bf16 v[64:79], a[216:219], v[104:107], v[64:79]
    ds_read_b128 a[248:251], v24 offset:18432
    v_add_f32 v28, v28, v47
    v_cmp_lt_f32 vcc, s58, v28
    v_cvt_pk_bf16_f32 v151, v46, v47
    s_cbranch_vccnz C_rare2
C_back2:
    v_add_f32 v27, v27, v28
    v_mfma_f32_32x32x16_bf16 v[64:79], a[220:223], v[108:111], v[64:79]
    ds_read_b128 a[252:255], v25 offset:18432
    v_fma_f32 v32, v48, s59, -v26
    v_exp_f32 v32, v32
    v_fma_f32 v33, v49, s59, -v26
    v_fma_f32 v34, v50, s59, -v26
    v_mfma_f32_32x32x16_bf16 v[64:79], a[224:227], v[112:115], v[64:79]
    ds_read_b128 a[216:219], v22 offset:19456
C_pad3:
    s_cbranch_execz C_pad6
    v_exp_f32 v33, v33
    v_exp_f32 v34, v34
    v_add_f32 v28, v32, v33
    v_mfma_f32_32x32x16_bf16 v[64:79], a[228:231], v[116:119], v[64:79]
    ds_read_b128 a[220:223], v23 offset:19456
    v_fma_f32 v35, v51, s59, -v26
    v_exp_f32 v35, v35
    v_add_f32 v28, v28, v34
    s_waitcnt lgkmcnt(4)
    v_mfma_f32_32x32x16_bf16 v[64:79], a[232:235], v[120:123], v[64:79]
    ds_read_b128 a[224:227], v24 offset:19456
    v_fma_f32 v36, v52, s59, -v26
    v_exp_f32 v36, v36
    v_add_f32 v28, v28, v35
    v_cvt_pk_bf16_f32 v152, v32, v33
    v_mfma_f32_32x32x16_bf16 v[64:79], a[236:239], v[124:127], v[64:79]
    ds_read_b128 a[228:231], v25 offset:19456
    v_fma_f32 v37, v53, s59, -v26
    v_exp_f32 v37, v37
    v_add_f32 v28, v28, v36
    v_cvt_pk_bf16_f32 v153, v34, v35
    v_mfma_f32_32x32x16_bf16 v[64:79], a[240:243], a[160:163], v[64:79]
    s_barrier
    ds_read_b128 a[232:235], v22 offset:32768
    v_fma_f32 v38, v54, s59, -v26
    v_exp_f32 v38, v38
    v_add_f32 v28, v28, v37
    v_mfma_f32_32x32x16_bf16 v[64:79], a[244:247], a[164:167], v[64:79]
    ds_read_b128 a[236:239], v23 offset:32768
    v_fma_f32 v39, v55, s59, -v26
    v_exp_f32 v39, v39
    v_add_f32 v28, v28, v38
    s_waitcnt lgkmcnt(4)
    v_mfma_f32_32x32x16_bf16 v[64:79], a[248:251], a[168:171], v[64:79]
    ds_read_b128 a[240:243], v24 offset:32768
    v_fma_f32 v40, v56, s59, -v26
    v_exp_f32 v40, v40
    v_add_f32 v28, v28, v39
    v_cvt_pk_bf16_f32 v154, v36, v37
    v_mfma_f32_32x32x16_bf16 v[64:79], a[252:255], a[172:175], v[64:79]
    ds_read_b128 a[244:247], v25 offset:32768
    v_fma_f32 v41, v57, s59, -v26
    v_exp_f32 v41, v41
    v_add_f32 v28, v28, v40
    v_cvt_pk_bf16_f32 v155, v38, v39
    v_mfma_f32_32x32x16_bf16 v[64:79], a[216:219], a[176:179], v[64:79]
    ds_read_b128 a[248:251], v22 offset:33792
    v_fma_f32 v42, v58, s59, -v26
    v_exp_f32 v42, v42
    v_add_f32 v28, v28, v41
    v_cvt_pk_bf16_f32 v156, v40, v41
    v_mfma_f32_32x32x16_bf16 v[64:79], a[220:223], a[180:183], v[64:79]
    ds_read_b128 a[252:255], v23 offset:33792
    v_fma_f32 v43, v59, s59, -v26
    v_exp_f32 v43, v43
    v_add_f32 v28, v28, v42
    s_waitcnt lgkmcnt(4)
    v_mfma_f32_32x32x16_bf16 v[64:79], a[224:227], a[184:187], v[64:79]
    ds_read_b128 a[216:219], v24 offset:33792
    v_fma_f32 v44, v60, s59, -v26
    v_exp_f32 v44, v44
    v_add_f32 v28, v28, v43
    v_cvt_pk_bf16_f32 v157, v42, v43
    v_mfma_f32_32x32x16_bf16 v[64:79], a[228:231], a[188:191], v[64:79]
    ds_read_b128 a[220:223], v25 offset:33792
    v_fma_f32 v45, v61, s59, -v26
    v_exp_f32 v45, v45
    v_add_f32 v28, v28, v44
    v_mfma_f32_32x32x16_bf16 v[80:95], a[232:235], v[96:99], 0
    ds_read_b128 a[224:227], v22 offset:34816
    v_fma_f32 v46, v62, s59, -v26
    v_exp_f32 v46, v46
    v_add_f32 v28, v28, v45
    v_cvt_pk_bf16_f32 v158, v44, v45
    v_mfma_f32_32x32x16_bf16 v[80:95], a[236:239], v[100:103], v[80:95]
    ds_read_b128 a[228:231], v23 offset:34816
    v_fma_f32 v47, v63, s59, -v26
    v_exp_f32 v47, v47
    v_add_f32 v28, v28, v46
    s_waitcnt lgkmcnt(4)
    v_mfma_f32_32x32x16_bf16 v[80:95], a[240:243], v[104:107], v[80:95]
    ds_read_b128 a[232:235], v24 offset:34816
    v_add_f32 v28, v28, v47
    v_cmp_lt_f32 vcc, s58, v28
    v_cvt_pk_bf16_f32 v159, v46, v47
    s_cbranch_vccnz C_rare3
C_back3:
    v_add_f32 v27, v27, v28
    v_mfma_f32_32x32x16_bf16 v[80:95], a[244:247], v[108:111], v[80:95]
    ds_read_b128 a[236:239], v25 offset:34816
    v_fma_f32 v32, v64, s59, -v26
    v_exp_f32 v32, v32
    v_fma_f32 v33, v65, s59, -v26
    v_fma_f32 v34, v66, s59, -v26
    v_mfma_f32_32x32x16_bf16 v[80:95], a[248:251], v[112:115], v[80:95]
    ds_read_b128 a[240:243], v22 offset:35840
    v_exp_f32 v33, v33
    v_exp_f32 v34, v34
    v_add_f32 v28, v32, v33
    v_mfma_f32_32x32x16_bf16 v[80:95], a[252:255], v[116:119], v[80:95]
    ds_read_b128 a[244:247], v23 offset:35840
    v_fma_f32 v35, v67, s59, -v26
    v_exp_f32 v35, v35
    v_add_f32 v28, v28, v34
    s_waitcnt lgkmcnt(4)
    v_mfma_f32_32x32x16_bf16 v[80:95], a[216:219], v[120:123], v[80:95]
    ds_read_b128 a[248:251], v24 offset:35840
    v_fma_f32 v36, v68, s59, -v26
    v_exp_f32 v36, v36
    v_add_f32 v28, v28, v35
    v_cvt_pk_bf16_f32 v160, v32, v33
    v_mfma_f32_32x32x16_bf16 v[80:95], a[220:223], v[124:127], v[80:95]
    ds_read_b128 a[252:255], v25 offset:35840
    v_fma_f32 v37, v69, s59, -v26
    v_exp_f32 v37, v37
    v_add_f32 v28, v28, v36
    v_cvt_pk_bf16_f32 v161, v34, v35
    v_mfma_f32_32x32x16_bf16 v[80:95], a[224:227], a[160:163], v[80:95]
    s_barrier
    ds_read_b128 a[216:219], v22 offset:49152
    v_fma_f32 v38, v70, s59, -v26
    v_exp_f32 v38, v38
    v_add_f32 v28, v28, v37
    v_mfma_f32_32x32x16_bf16 v[80:95], a[228:231], a[164:167], v[80:95]
    ds_read_b128 a[220:223], v23 offset:49152
    v_fma_f32 v39, v71, s59, -v26
    v_exp_f32 v39, v39
    v_add_f32 v28, v28, v38
    s_waitcnt lgkmcnt(4)
    v_mfma_f32_32x32x16_bf16 v[80:95], a[232:235], a[168:171], v[80:95]
    ds_read_b128 a[224:227], v24 offset:49152
    v_fma_f32 v40, v72, s59, -v26
    v_exp_f32 v40, v40
    v_add_f32 v28, v28, v39
    v_cvt_pk_bf16_f32 v162, v36, v37
    v_mfma_f32_32x32x16_bf16 v[80:95], a[236:239], a[172:175], v[80:95]
    ds_read_b128 a[228:231], v25 offset:49152
    v_fma_f32 v41, v73, s59, -v26
    v_exp_f32 v41, v41
    v_add_f32 v28, v28, v40
    v_cvt_pk_bf16_f32 v163, v38, v39
    v_mfma_f32_32x32x16_bf16 v[80:95], a[240:243], a[176:179], v[80:95]
    ds_read_b128 a[232:235], v22 offset:50176
    v_fma_f32 v42, v74, s59, -v26
    v_exp_f32 v42, v42
    v_add_f32 v28, v28, v41
    v_cvt_pk_bf16_f32 v164, v40, v41
    v_mfma_f32_32x32x16_bf16 v[80:95], a[244:247], a[180:183], v[80:95]
    ds_read_b128 a[236:239], v23 offset:50176
    v_fma_f32 v43, v75, s59, -v26
    v_exp_f32 v43, v43
    v_add_f32 v28, v28, v42
    s_waitcnt lgkmcnt(4)
    v_mfma_f32_32x32x16_bf16 v[80:95], a[248:251], a[184:187], v[80:95]
    ds_read_b128 a[240:243], v24 offset:50176
    v_fma_f32 v44, v76, s59, -v26
    v_exp_f32 v44, v44
    v_add_f32 v28, v28, v43
    v_cvt_pk_bf16_f32 v165, v42, v43
    v_mfma_f32_32x32x16_bf16 v[80:95], a[252:255], a[188:191], v[80:95]
    ds_read_b128 a[244:247], v25 offset:50176
    v_fma_f32 v45, v77, s59, -v26
    v_exp_f32 v45, v45
    v_add_f32 v28, v28, v44
    v_mfma_f32_32x32x16_bf16 v[48:63], a[216:219], v[96:99], 0
    ds_read_b128 a[248:251], v22 offset:51200
    v_fma_f32 v46, v78, s59, -v26
    v_exp_f32 v46, v46
    v_add_f32 v28, v28, v45
    v_cvt_pk_bf16_f32 v166, v44, v45
    v_mfma_f32_32x32x16_bf16 v[48:63], a[220:223], v[100:103], v[48:63]
    ds_read_b128 a[252:255], v23 offset:51200
    v_fma_f32 v47, v79, s59, -v26
    v_exp_f32 v47, v47
    v_add_f32 v28, v28, v46
    s_waitcnt lgkmcnt(4)
    v_mfma_f32_32x32x16_bf16 v[48:63], a[224:227], v[104:107], v[48:63]
    ds_read_b128 a[216:219], v24 offset:51200
    v_add_f32 v28, v28, v47
    v_cmp_lt_f32 vcc, s58, v28
    v_cvt_pk_bf16_f32 v167, v46, v47
    s_cbranch_vccnz C_rare4
C_back4:
    v_add_f32 v27, v27, v28
    v_mfma_f32_32x32x16_bf16 v[48:63], a[228:231], v[108:111], v[48:63]
    ds_read_b128 a[220:223], v25 offset:51200
    v_fma_f32 v32, v80, s59, -v26
    v_exp_f32 v32, v32
    v_fma_f32 v33, v81, s59, -v26
    v_fma_f32 v34, v82, s59, -v26
    v_mfma_f32_32x32x16_bf16 v[48:63], a[232:235], v[112:115], v[48:63]
    ds_read_b128 a[224:227], v22 offset:52224
    v_exp_f32 v33, v33
    v_exp_f32 v34, v34
    v_add_f32 v28, v32, v33
    v_mfma_f32_32x32x16_bf16 v[48:63], a[236:239], v[116:119], v[48:63]
    ds_read_b128 a[228:231], v23 offset:52224
    v_fma_f32 v35, v83, s59, -v26
    v_exp_f32 v35, v35
    v_add_f32 v28, v28, v34
    s_waitcnt lgkmcnt(4)
    v_mfma_f32_32x32x16_bf16 v[48:63], a[240:243], v[120:123], v[48:63]
    ds_read_b128 a[232:235], v24 offset:52224
    v_fma_f32 v36, v84, s59, -v26
    v_exp_f32 v36, v36
    v_add_f32 v28, v28, v35
    v_cvt_pk_bf16_f32 v168, v32, v33
    v_mfma_f32_32x32x16_bf16 v[48:63], a[244:247], v[124:127], v[48:63]
    ds_read_b128 a[236:239], v25 offset:52224
    v_fma_f32 v37, v85, s59, -v26
    v_exp_f32 v37, v37
    v_add_f32 v28, v28, v36
    v_cvt_pk_bf16_f32 v169, v34, v35
    v_mfma_f32_32x32x16_bf16 v[48:63], a[248:251], a[160:163], v[48:63]
    s_barrier
    ds_read_b128 a[240:243], v10 offset:0
    v_fma_f32 v38, v86, s59, -v26
    v_exp_f32 v38, v38
    v_add_f32 v28, v28, v37
    v_mfma_f32_32x32x16_bf16 v[48:63], a[252:255], a[164:167], v[48:63]
    ds_read_b128 a[244:247], v11 offset:0
    v_fma_f32 v39, v87, s59, -v26
    v_exp_f32 v39, v39
    v_add_f32 v28, v28, v38
    s_waitcnt lgkmcnt(4)
    v_mfma_f32_32x32x16_bf16 v[48:63], a[216:219], a[168:171], v[48:63]
    ds_read_b128 a[248:251], v12 offset:0
    v_fma_f32 v40, v88, s59, -v26
    v_exp_f32 v40, v40
    v_add_f32 v28, v28, v39
    v_cvt_pk_bf16_f32 v170, v36, v37
    v_mfma_f32_32x32x16_bf16 v[48:63], a[220:223], a[172:175], v[48:63]
    ds_read_b128 a[252:255], v13 offset:0
    v_fma_f32 v41, v89, s59, -v26
    v_exp_f32 v41, v41
    v_add_f32 v28, v28, v40
    v_cvt_pk_bf16_f32 v171, v38, v39
    v_mfma_f32_32x32x16_bf16 v[48:63], a[224:227], a[176:179], v[48:63]
    ds_read_b128 a[216:219], v10 offset:1024
    v_fma_f32 v42, v90, s59, -v26
    v_exp_f32 v42, v42
    v_add_f32 v28, v28, v41
    v_cvt_pk_bf16_f32 v172, v40, v41
    v_mfma_f32_32x32x16_bf16 v[48:63], a[228:231], a[180:183], v[48:63]
    ds_read_b128 a[220:223], v11 offset:1024
    v_fma_f32 v43, v91, s59, -v26
    v_exp_f32 v43, v43
    v_add_f32 v28, v28, v42
    s_waitcnt lgkmcnt(4)
    v_mfma_f32_32x32x16_bf16 v[48:63], a[232:235], a[184:187], v[48:63]
    ds_read_b128 a[224:227], v12 offset:1024
    v_fma_f32 v44, v92, s59, -v26
    v_exp_f32 v44, v44
    v_add_f32 v28, v28, v43
    v_cvt_pk_bf16_f32 v173, v42, v43
    v_mfma_f32_32x32x16_bf16 v[48:63], a[236:239], a[188:191], v[48:63]
    ds_read_b128 a[228:231], v13 offset:1024
    v_fma_f32 v45, v93, s59, -v26
    v_exp_f32 v45, v45
    v_add_f32 v28, v28, v44
    v_mfma_f32_32x32x16_bf16 v[64:79], a[240:243], v[96:99], 0
    ds_read_b128 a[232:235], v10 offset:2048
    v_fma_f32 v46, v94, s59, -v26
    v_exp_f32 v46, v46
    v_add_f32 v28, v28, v45
    v_cvt_pk_bf16_f32 v174, v44, v45
    v_mfma_f32_32x32x16_bf16 v[64:79], a[244:247], v[100:103], v[64:79]
    ds_read_b128 a[236:239], v11 offset:2048
    v_fma_f32 v47, v95, s59, -v26
    v_exp_f32 v47, v47
    v_add_f32 v28, v28, v46
    s_waitcnt lgkmcnt(4)
    v_mfma_f32_32x32x16_bf16 v[64:79], a[248:251], v[104:107], v[64:79]
    ds_read_b128 a[240:243], v12 offset:2048
    v_add_f32 v28, v28, v47
    v_cmp_lt_f32 vcc, s58, v28
    v_cvt_pk_bf16_f32 v175, v46, v47
    s_cbranch_vccnz C_rare5
C_back5:
    v_add_f32 v27, v27, v28
    v_mfma_f32_32x32x16_bf16 v[64:79], a[252:255], v[108:111], v[64:79]
    ds_read_b128 a[244:247], v13 offset:2048
    v_fma_f32 v32, v48, s59, -v26
    v_exp_f32 v32, v32
    v_fma_f32 v33, v49, s59, -v26
    v_fma_f32 v34, v50, s59, -v26
    v_mfma_f32_32x32x16_bf16 v[64:79], a[216:219], v[112:115], v[64:79]
    ds_read_b128 a[248:251], v10 offset:3072
    v_exp_f32 v33, v33
    v_exp_f32 v34, v34
    v_add_f32 v28, v32, v33
    v_mfma_f32_32x32x16_bf16 v[64:79], a[220:223], v[116:119], v[64:79]
    ds_read_b128 a[252:255], v11 offset:3072
    v_fma_f32 v35, v51, s59, -v26
    v_exp_f32 v35, v35
    v_add_f32 v28, v28, v34
    s_waitcnt lgkmcnt(4)
    v_mfma_f32_32x32x16_bf16 v[64:79], a[224:227], v[120:123], v[64:79]
    ds_read_b128 a[216:219], v12 offset:3072
    v_fma_f32 v36, v52, s59, -v26
    v_exp_f32 v36, v36
    v_add_f32 v28, v28, v35
    v_cvt_pk_bf16_f32 v176, v32, v33
    v_mfma_f32_32x32x16_bf16 v[64:79], a[228:231], v[124:127], v[64:79]
    ds_read_b128 a[220:223], v13 offset:3072
    v_fma_f32 v37, v53, s59, -v26
    v_exp_f32 v37, v37
    v_add_f32 v28, v28, v36
    v_cvt_pk_bf16_f32 v177, v34, v35
    v_mfma_f32_32x32x16_bf16 v[64:79], a[232:235], a[160:163], v[64:79]
    s_barrier
    ds_read_b128 a[224:227], v10 offset:16384
    v_fma_f32 v38, v54, s59, -v26
    v_exp_f32 v38, v38
    v_add_f32 v28, v28, v37
    v_mfma_f32_32x32x16_bf16 v[64:79], a[236:239], a[164:167], v[64:79]
    ds_read_b128 a[228:231], v11 offset:16384
    v_fma_f32 v39, v55, s59, -v26
    v_exp_f32 v39, v39
    v_add_f32 v28, v28, v38
    s_waitcnt lgkmcnt(4)
    v_mfma_f32_32x32x16_bf16 v[64:79], a[240:243], a[168:171], v[64:79]
    ds_read_b128 a[232:235], v12 offset:16384
    v_fma_f32 v40, v56, s59, -v26
    v_exp_f32 v40, v40
    v_add_f32 v28, v28, v39
    v_cvt_pk_bf16_f32 v178, v36, v37
    v_mfma_f32_32x32x16_bf16 v[64:79], a[244:247], a[172:175], v[64:79]
    ds_read_b128 a[236:239], v13 offset:16384
    v_fma_f32 v41, v57, s59, -v26
    v_exp_f32 v41, v41
    v_add_f32 v28, v28, v40
    v_cvt_pk_bf16_f32 v179, v38, v39
    v_mfma_f32_32x32x16_bf16 v[64:79], a[248:251], a[176:179], v[64:79]
    ds_read_b128 a[240:243], v10 offset:17408
    v_fma_f32 v42, v58, s59, -v26
    v_exp_f32 v42, v42
    v_add_f32 v28, v28, v41
    v_cvt_pk_bf16_f32 v180, v40, v41
    v_mfma_f32_32x32x16_bf16 v[64:79], a[252:255], a[180:183], v[64:79]
    ds_read_b128 a[244:247], v11 offset:17408
    v_fma_f32 v43, v59, s59, -v26
    v_exp_f32 v43, v43
    v_add_f32 v28, v28, v42
    s_waitcnt lgkmcnt(4)
    v_mfma_f32_32x32x16_bf16 v[64:79], a[216:219], a[184:187], v[64:79]
    ds_read_b128 a[248:251], v12 offset:17408
    v_fma_f32 v44, v60, s59, -v26
    v_exp_f32 v44, v44
    v_add_f32 v28, v28, v43
    v_cvt_pk_bf16_f32 v181, v42, v43
    v_mfma_f32_32x32x16_bf16 v[64:79], a[220:223], a[188:191], v[64:79]
    ds_read_b128 a[252:255], v13 offset:17408
    v_fma_f32 v45, v61, s59, -v26
    v_exp_f32 v45, v45
    v_add_f32 v28, v28, v44
    v_mfma_f32_32x32x16_bf16 v[80:95], a[224:227], v[96:99], 0
    ds_read_b128 a[216:219], v10 offset:18432
    v_fma_f32 v46, v62, s59, -v26
    v_exp_f32 v46, v46
    v_add_f32 v28, v28, v45
    v_cvt_pk_bf16_f32 v182, v44, v45
    v_mfma_f32_32x32x16_bf16 v[80:95], a[228:231], v[100:103], v[80:95]
    ds_read_b128 a[220:223], v11 offset:18432
    v_fma_f32 v47, v63, s59, -v26
    v_exp_f32 v47, v47
    v_add_f32 v28, v28, v46
    s_waitcnt lgkmcnt(4)
    v_mfma_f32_32x32x16_bf16 v[80:95], a[232:235], v[104:107], v[80:95]
    ds_read_b128 a[224:227], v12 offset:18432
    v_add_f32 v28, v28, v47
    v_cmp_lt_f32 vcc, s58, v28
    v_cvt_pk_bf16_f32 v183, v46, v47
    s_cbranch_vccnz C_rare6
C_back6:
    v_add_f32 v27, v27, v28
    v_mfma_f32_32x32x16_bf16 v[80:95], a[236:239], v[108:111], v[80:95]
    ds_read_b128 a[228:231], v13 offset:18432
    v_fma_f32 v32, v64, s59, -v26
    v_exp_f32 v32, v32
    v_fma_f32 v33, v65, s59, -v26
    v_fma_f32 v34, v66, s59, -v26
    v_mfma_f32_32x32x16_bf16 v[80:95], a[240:243], v[112:115], v[80:95]
    ds_read_b128 a[232:235], v10 offset:19456
    v_exp_f32 v33, v33
    v_exp_f32 v34, v34
    v_add_f32 v28, v32, v33
    v_mfma_f32_32x32x16_bf16 v[80:95], a[244:247], v[116:119], v[80:95]
    ds_read_b128 a[236:239], v11 offset:19456
    v_fma_f32 v35, v67, s59, -v26
    v_exp_f32 v35, v35
    v_add_f32 v28, v28, v34
    s_waitcnt lgkmcnt(4)
    v_mfma_f32_32x32x16_bf16 v[80:95], a[248:251], v[120:123], v[80:95]
    ds_read_b128 a[240:243], v12 offset:19456
    v_fma_f32 v36, v68, s59, -v26
    v_exp_f32 v36, v36
    v_add_f32 v28, v28, v35
    v_cvt_pk_bf16_f32 v184, v32, v33
    v_mfma_f32_32x32x16_bf16 v[80:95], a[252:255], v[124:127], v[80:95]
    ds_read_b128 a[244:247], v13 offset:19456
    v_fma_f32 v37, v69, s59, -v26
    v_exp_f32 v37, v37
    v_add_f32 v28, v28, v36
    v_cvt_pk_bf16_f32 v185, v34, v35
    v_mfma_f32_32x32x16_bf16 v[80:95], a[216:219], a[160:163], v[80:95]
    s_barrier
    ds_read_b128 a[248:251], v18 offset:0
    v_fma_f32 v38, v70, s59, -v26
    v_exp_f32 v38, v38
    v_add_f32 v28, v28, v37
    v_mfma_f32_32x32x16_bf16 v[80:95], a[220:223], a[164:167], v[80:95]
    ds_read_b128 a[252:255], v19 offset:0
    v_fma_f32 v39, v71, s59, -v26
    v_exp_f32 v39, v39
    v_add_f32 v28, v28, v38
    s_waitcnt lgkmcnt(4)
    v_mfma_f32_32x32x16_bf16 v[80:95], a[224:227], a[168:171], v[80:95]
    ds_read_b128 a[216:219], v20 offset:0
    v_fma_f32 v40, v72, s59, -v26
    v_exp_f32 v40, v40
    v_add_f32 v28, v28, v39
    v_cvt_pk_bf16_f32 v186, v36, v37
    v_mfma_f32_32x32x16_bf16 v[80:95], a[228:231], a[172:175], v[80:95]
    ds_read_b128 a[220:223], v21 offset:0
    v_fma_f32 v41, v73, s59, -v26
    v_exp_f32 v41, v41
    v_add_f32 v28, v28, v40
    v_cvt_pk_bf16_f32 v187, v38, v39
    v_mfma_f32_32x32x16_bf16 v[80:95], a[232:235], a[176:179], v[80:95]
    ds_read_b128 a[224:227], v18 offset:1024
    v_fma_f32 v42, v74, s59, -v26
    v_exp_f32 v42, v42
    v_add_f32 v28, v28, v41
    v_cvt_pk_bf16_f32 v188, v40, v41
    v_mfma_f32_32x32x16_bf16 v[80:95], a[236:239], a[180:183], v[80:95]
    ds_read_b128 a[228:231], v19 offset:1024
    v_fma_f32 v43, v75, s59, -v26
    v_exp_f32 v43, v43
    v_add_f32 v28, v28, v42
    s_waitcnt lgkmcnt(4)
    v_mfma_f32_32x32x16_bf16 v[80:95], a[240:243], a[184:187], v[80:95]
    ds_read_b128 a[232:235], v20 offset:1024
    v_fma_f32 v44, v76, s59, -v26
    v_exp_f32 v44, v44
    v_add_f32 v28, v28, v43
    v_cvt_pk_bf16_f32 v189, v42, v43
    v_mfma_f32_32x32x16_bf16 v[80:95], a[244:247], a[188:191], v[80:95]
    ds_read_b128 a[236:239], v21 offset:1024
    v_fma_f32 v45, v77, s59, -v26
    v_exp_f32 v45, v45
    v_add_f32 v28, v28, v44
    v_mfma_f32_32x32x16_bf16 v[48:63], a[248:251], v[96:99], 0
    ds_read_b128 a[240:243], v18 offset:2048
    v_fma_f32 v46, v78, s59, -v26
    v_exp_f32 v46, v46
    v_add_f32 v28, v28, v45
    v_cvt_pk_bf16_f32 v190, v44, v45
    v_mfma_f32_32x32x16_bf16 v[48:63], a[252:255], v[100:103], v[48:63]
    ds_read_b128 a[244:247], v19 offset:2048
    v_fma_f32 v47, v79, s59, -v26
    v_exp_f32 v47, v47
    v_add_f32 v28, v28, v46
    s_waitcnt lgkmcnt(4)
    v_mfma_f32_32x32x16_bf16 v[48:63], a[216:219], v[104:107], v[48:63]
    ds_read_b128 a[248:251], v20 offset:2048
    v_add_f32 v28, v28, v47
    v_cmp_lt_f32 vcc, s58, v28
    v_cvt_pk_bf16_f32 v191, v46, v47
    s_cbranch_vccnz C_rare7
C_back7:
    v_add_f32 v27, v27, v28
    v_mfma_f32_32x32x16_bf16 v[48:63], a[220:223], v[108:111], v[48:63]
    ds_read_b128 a[252:255], v21 offset:2048
    v_fma_f32 v32, v80, s59, -v26
    v_exp_f32 v32, v32
    v_fma_f32 v33, v81, s59, -v26
    v_fma_f32 v34, v82, s59, -v26
    v_mfma_f32_32x32x16_bf16 v[48:63], a[224:227], v[112:115], v[48:63]
    ds_read_b128 a[216:219], v18 offset:3072
    v_exp_f32 v33, v33
    v_exp_f32 v34, v34
    v_add_f32 v28, v32, v33
    v_mfma_f32_32x32x16_bf16 v[48:63], a[228:231], v[116:119], v[48:63]
    ds_read_b128 a[220:223], v19 offset:3072
    v_fma_f32 v35, v83, s59, -v26
    v_exp_f32 v35, v35
    v_add_f32 v28, v28, v34
    s_waitcnt lgkmcnt(4)
    v_mfma_f32_32x32x16_bf16 v[48:63], a[232:235], v[120:123], v[48:63]
    ds_read_b128 a[224:227], v20 offset:3072
    v_fma_f32 v36, v84, s59, -v26
    v_exp_f32 v36, v36
    v_add_f32 v28, v28, v35
    v_cvt_pk_bf16_f32 v192, v32, v33
    v_mfma_f32_32x32x16_bf16 v[48:63], a[236:239], v[124:127], v[48:63]
    ds_read_b128 a[228:231], v21 offset:3072
    v_fma_f32 v37, v85, s59, -v26
    v_exp_f32 v37, v37
    v_add_f32 v28, v28, v36
    v_cvt_pk_bf16_f32 v193, v34, v35
    v_mfma_f32_32x32x16_bf16 v[48:63], a[240:243], a[160:163], v[48:63]
    s_barrier
    ds_read_b128 a[232:235], v18 offset:16384
    v_fma_f32 v38, v86, s59, -v26
    v_exp_f32 v38, v38
    v_add_f32 v28, v28, v37
    v_mfma_f32_32x32x16_bf16 v[48:63], a[244:247], a[164:167], v[48:63]
    ds_read_b128 a[236:239], v19 offset:16384
    v_fma_f32 v39, v87, s59, -v26
    v_exp_f32 v39, v39
    v_add_f32 v28, v28, v38
    s_waitcnt lgkmcnt(4)
    v_mfma_f32_32x32x16_bf16 v[48:63], a[248:251], a[168:171], v[48:63]
    ds_read_b128 a[240:243], v20 offset:16384
    v_fma_f32 v40, v88, s59, -v26
    v_exp_f32 v40, v40
    v_add_f32 v28, v28, v39
    v_cvt_pk_bf16_f32 v194, v36, v37
    v_mfma_f32_32x32x16_bf16 v[48:63], a[252:255], a[172:175], v[48:63]
    ds_read_b128 a[244:247], v21 offset:16384
    v_fma_f32 v41, v89, s59, -v26
    v_exp_f32 v41, v41
    v_add_f32 v28, v28, v40
    v_cvt_pk_bf16_f32 v195, v38, v39
    v_mfma_f32_32x32x16_bf16 v[48:63], a[216:219], a[176:179], v[48:63]
    ds_read_b128 a[248:251], v18 offset:17408
    v_fma_f32 v42, v90, s59, -v26
    v_exp_f32 v42, v42
    v_add_f32 v28, v28, v41
    v_cvt_pk_bf16_f32 v196, v40, v41
    v_mfma_f32_32x32x16_bf16 v[48:63], a[220:223], a[180:183], v[48:63]
    ds_read_b128 a[252:255], v19 offset:17408
    v_fma_f32 v43, v91, s59, -v26
    v_exp_f32 v43, v43
    v_add_f32 v28, v28, v42
    s_waitcnt lgkmcnt(4)
    v_mfma_f32_32x32x16_bf16 v[48:63], a[224:227], a[184:187], v[48:63]
    ds_read_b128 a[216:219], v20 offset:17408
    v_fma_f32 v44, v92, s59, -v26
    v_exp_f32 v44, v44
    v_add_f32 v28, v28, v43
    v_cvt_pk_bf16_f32 v197, v42, v43
    v_mfma_f32_32x32x16_bf16 v[48:63], a[228:231], a[188:191], v[48:63]
    ds_read_b128 a[220:223], v21 offset:17408
    v_fma_f32 v45, v93, s59, -v26
    v_exp_f32 v45, v45
    v_add_f32 v28, v28, v44
    v_mfma_f32_32x32x16_bf16 v[64:79], a[232:235], v[96:99], 0
    ds_read_b128 a[224:227], v18 offset:18432
    v_fma_f32 v46, v94, s59, -v26
    v_exp_f32 v46, v46
    v_add_f32 v28, v28, v45
    v_cvt_pk_bf16_f32 v198, v44, v45
    v_mfma_f32_32x32x16_bf16 v[64:79], a[236:239], v[100:103], v[64:79]
    ds_read_b128 a[228:231], v19 offset:18432
    v_fma_f32 v47, v95, s59, -v26
    v_exp_f32 v47, v47
    v_add_f32 v28, v28, v46
    s_waitcnt lgkmcnt(4)
    v_mfma_f32_32x32x16_bf16 v[64:79], a[240:243], v[104:107], v[64:79]
    ds_read_b128 a[232:235], v20 offset:18432
    v_add_f32 v28, v28, v47
    v_cmp_lt_f32 vcc, s58, v28
    v_cvt_pk_bf16_f32 v199, v46, v47
    s_cbranch_vccnz C_rare8
C_back8:
    v_add_f32 v27, v27, v28
    v_mfma_f32_32x32x16_bf16 v[64:79], a[244:247], v[108:111], v[64:79]
    ds_read_b128 a[236:239], v21 offset:18432
    v_fma_f32 v32, v48, s59, -v26
    v_exp_f32 v32, v32
    v_fma_f32 v33, v49, s59, -v26
    v_fma_f32 v34, v50, s59, -v26
    v_mfma_f32_32x32x16_bf16 v[64:79], a[248:251], v[112:115], v[64:79]
    ds_read_b128 a[240:243], v18 offset:19456
    v_exp_f32 v33, v33
    v_exp_f32 v34, v34
    v_add_f32 v28, v32, v33
    v_mfma_f32_32x32x16_bf16 v[64:79], a[252:255], v[116:119], v[64:79]
    ds_read_b128 a[244:247], v19 offset:19456
    v_fma_f32 v35, v51, s59, -v26
    v_exp_f32 v35, v35
    v_add_f32 v28, v28, v34
    s_waitcnt lgkmcnt(4)
    v_mfma_f32_32x32x16_bf16 v[64:79], a[216:219], v[120:123], v[64:79]
    ds_read_b128 a[248:251], v20 offset:19456
    v_fma_f32 v36, v52, s59, -v26
    v_exp_f32 v36, v36
    v_add_f32 v28, v28, v35
    v_cvt_pk_bf16_f32 v200, v32, v33
    v_mfma_f32_32x32x16_bf16 v[64:79], a[220:223], v[124:127], v[64:79]
    ds_read_b128 a[252:255], v21 offset:19456
    v_fma_f32 v37, v53, s59, -v26
    v_exp_f32 v37, v37
    v_add_f32 v28, v28, v36
    v_cvt_pk_bf16_f32 v201, v34, v35
    v_mfma_f32_32x32x16_bf16 v[64:79], a[224:227], a[160:163], v[64:79]
    s_barrier
    ds_read_b128 a[216:219], v18 offset:32768
    v_fma_f32 v38, v54, s59, -v26
    v_exp_f32 v38, v38
    v_add_f32 v28, v28, v37
    v_mfma_f32_32x32x16_bf16 v[64:79], a[228:231], a[164:167], v[64:79]
    ds_read_b128 a[220:223], v19 offset:32768
    v_fma_f32 v39, v55, s59, -v26
    v_exp_f32 v39, v39
    v_add_f32 v28, v28, v38
    s_waitcnt lgkmcnt(4)
    v_mfma_f32_32x32x16_bf16 v[64:79], a[232:235], a[168:171], v[64:79]
    ds_read_b128 a[224:227], v20 offset:32768
    v_fma_f32 v40, v56, s59, -v26
    v_exp_f32 v40, v40
    v_add_f32 v28, v28, v39
    v_cvt_pk_bf16_f32 v202, v36, v37
    v_mfma_f32_32x32x16_bf16 v[64:79], a[236:239], a[172:175], v[64:79]
    ds_read_b128 a[228:231], v21 offset:32768
    v_fma_f32 v41, v57, s59, -v26
    v_exp_f32 v41, v41
    v_add_f32 v28, v28, v40
    v_cvt_pk_bf16_f32 v203, v38, v39
    v_mfma_f32_32x32x16_bf16 v[64:79], a[240:243], a[176:179], v[64:79]
    ds_read_b128 a[232:235], v18 offset:33792
    v_fma_f32 v42, v58, s59, -v26
    v_exp_f32 v42, v42
    v_add_f32 v28, v28, v41
    v_cvt_pk_bf16_f32 v204, v40, v41
    v_mfma_f32_32x32x16_bf16 v[64:79], a[244:247], a[180:183], v[64:79]
    ds_read_b128 a[236:239], v19 offset:33792
    v_fma_f32 v43, v59, s59, -v26
    v_exp_f32 v43, v43
    v_add_f32 v28, v28, v42
    s_waitcnt lgkmcnt(4)
    v_mfma_f32_32x32x16_bf16 v[64:79], a[248:251], a[184:187], v[64:79]
    ds_read_b128 a[240:243], v20 offset:33792
    v_fma_f32 v44, v60, s59, -v26
    v_exp_f32 v44, v44
    v_add_f32 v28, v28, v43
    v_cvt_pk_bf16_f32 v205, v42, v43
    v_mfma_f32_32x32x16_bf16 v[64:79], a[252:255], a[188:191], v[64:79]
    ds_read_b128 a[244:247], v21 offset:33792
    v_fma_f32 v45, v61, s59, -v26
    v_exp_f32 v45, v45
    v_add_f32 v28, v28, v44
    v_mfma_f32_32x32x16_bf16 v[80:95], a[216:219], v[96:99], 0
    ds_read_b128 a[248:251], v18 offset:34816
    v_fma_f32 v46, v62, s59, -v26
    v_exp_f32 v46, v46
    v_add_f32 v28, v28, v45
    v_cvt_pk_bf16_f32 v206, v44, v45
C_pad4:
    s_cbranch_execz C_pad7
    v_mfma_f32_32x32x16_bf16 v[80:95], a[220:223], v[100:103], v[80:95]
    ds_read_b128 a[252:255], v19 offset:34816
    v_fma_f32 v47, v63, s59, -v26
    v_exp_f32 v47, v47
    v_add_f32 v28, v28, v46
    s_waitcnt lgkmcnt(4)
    v_mfma_f32_32x32x16_bf16 v[80:95], a[224:227], v[104:107], v[80:95]
    ds_read_b128 a[216:219], v20 offset:34816
    v_add_f32 v28, v28, v47
    v_cmp_lt_f32 vcc, s58, v28
    v_cvt_pk_bf16_f32 v207, v46, v47
    s_cbranch_vccnz C_rare9
C_back9:
    v_add_f32 v27, v27, v28
    v_mfma_f32_32x32x16_bf16 v[80:95], a[228:231], v[108:111], v[80:95]
    ds_read_b128 a[220:223], v21 offset:34816
    v_fma_f32 v32, v64, s59, -v26
    v_exp_f32 v32, v32
    v_fma_f32 v33, v65, s59, -v26
    v_fma_f32 v34, v66, s59, -v26
    v_mfma_f32_32x32x16_bf16 v[80:95], a[232:235], v[112:115], v[80:95]
    ds_read_b128 a[224:227], v18 offset:35840
    v_exp_f32 v33, v33
    v_exp_f32 v34, v34
    v_add_f32 v28, v32, v33
    v_mfma_f32_32x32x16_bf16 v[80:95], a[236:239], v[116:119], v[80:95]
    ds_read_b128 a[228:231], v19 offset:35840
    v_fma_f32 v35, v67, s59, -v26
    v_exp_f32 v35, v35
    v_add_f32 v28, v28, v34
    s_waitcnt lgkmcnt(4)
    v_mfma_f32_32x32x16_bf16 v[80:95], a[240:243], v[120:123], v[80:95]
    ds_read_b128 a[232:235], v20 offset:35840
    v_fma_f32 v36, v68, s59, -v26
    v_exp_f32 v36, v36
    v_add_f32 v28, v28, v35
    v_cvt_pk_bf16_f32 v208, v32, v33
    v_mfma_f32_32x32x16_bf16 v[80:95], a[244:247], v[124:127], v[80:95]
    ds_read_b128 a[236:239], v21 offset:35840
    v_fma_f32 v37, v69, s59, -v26
    v_exp_f32 v37, v37
    v_add_f32 v28, v28, v36
    v_cvt_pk_bf16_f32 v209, v34, v35
    v_mfma_f32_32x32x16_bf16 v[80:95], a[248:251], a[160:163], v[80:95]
    s_barrier
    ds_read_b128 a[240:243], v18 offset:49152
    v_fma_f32 v38, v70, s59, -v26
    v_exp_f32 v38, v38
    v_add_f32 v28, v28, v37
    v_mfma_f32_32x32x16_bf16 v[80:95], a[252:255], a[164:167], v[80:95]
    ds_read_b128 a[244:247], v19 offset:49152
    v_fma_f32 v39, v71, s59, -v26
    v_exp_f32 v39, v39
    v_add_f32 v28, v28, v38
    s_waitcnt lgkmcnt(4)
    v_mfma_f32_32x32x16_bf16 v[80:95], a[216:219], a[168:171], v[80:95]
    ds_read_b128 a[248:251], v20 offset:49152
    v_fma_f32 v40, v72, s59, -v26
    v_exp_f32 v40, v40
    v_add_f32 v28, v28, v39
    v_cvt_pk_bf16_f32 v210, v36, v37
    v_mfma_f32_32x32x16_bf16 v[80:95], a[220:223], a[172:175], v[80:95]
    ds_read_b128 a[252:255], v21 offset:49152
    v_fma_f32 v41, v73, s59, -v26
    v_exp_f32 v41, v41
    v_add_f32 v28, v28, v40
    v_cvt_pk_bf16_f32 v211, v38, v39
    v_mfma_f32_32x32x16_bf16 v[80:95], a[224:227], a[176:179], v[80:95]
    ds_read_b128 a[216:219], v18 offset:50176
    v_fma_f32 v42, v74, s59, -v26
    v_exp_f32 v42, v42
    v_add_f32 v28, v28, v41
    v_cvt_pk_bf16_f32 v212, v40, v41
    v_mfma_f32_32x32x16_bf16 v[80:95], a[228:231], a[180:183], v[80:95]
    ds_read_b128 a[220:223], v19 offset:50176
    v_fma_f32 v43, v75, s59, -v26
    v_exp_f32 v43, v43
    v_add_f32 v28, v28, v42
    s_waitcnt lgkmcnt(4)
    v_mfma_f32_32x32x16_bf16 v[80:95], a[232:235], a[184:187], v[80:95]
    ds_read_b128 a[224:227], v20 offset:50176
    v_fma_f32 v44, v76, s59, -v26
    v_exp_f32 v44, v44
    v_add_f32 v28, v28, v43
    v_cvt_pk_bf16_f32 v213, v42, v43
    v_mfma_f32_32x32x16_bf16 v[80:95], a[236:239], a[188:191], v[80:95]
    ds_read_b128 a[228:231], v21 offset:50176
    v_fma_f32 v45, v77, s59, -v26
    v_exp_f32 v45, v45
    v_add_f32 v28, v28, v44
    v_mfma_f32_32x32x16_bf16 v[48:63], a[240:243], v[96:99], 0
    ds_read_b128 a[232:235], v18 offset:51200
    v_fma_f32 v46, v78, s59, -v26
    v_exp_f32 v46, v46
    v_add_f32 v28, v28, v45
    v_cvt_pk_bf16_f32 v214, v44, v45
    v_mfma_f32_32x32x16_bf16 v[48:63], a[244:247], v[100:103], v[48:63]
    ds_read_b128 a[236:239], v19 offset:51200
    v_fma_f32 v47, v79, s59, -v26
    v_exp_f32 v47, v47
    v_add_f32 v28, v28, v46
    s_waitcnt lgkmcnt(4)
    v_mfma_f32_32x32x16_bf16 v[48:63], a[248:251], v[104:107], v[48:63]
    ds_read_b128 a[240:243], v20 offset:51200
    v_add_f32 v28, v28, v47
    v_cmp_lt_f32 vcc, s58, v28
    v_cvt_pk_bf16_f32 v215, v46, v47
    s_cbranch_vccnz C_rare10
C_back10:
    v_add_f32 v27, v27, v28
    v_mfma_f32_32x32x16_bf16 v[48:63], a[252:255], v[108:111], v[48:63]
    ds_read_b128 a[244:247], v21 offset:51200
    v_fma_f32 v32, v80, s59, -v26
    v_exp_f32 v32, v32
    v_fma_f32 v33, v81, s59, -v26
    v_fma_f32 v34, v82, s59, -v26
    v_mfma_f32_32x32x16_bf16 v[48:63], a[216:219], v[112:115], v[48:63]
    ds_read_b128 a[248:251], v18 offset:52224
    v_exp_f32 v33, v33
    v_exp_f32 v34, v34
    v_add_f32 v28, v32, v33
    v_mfma_f32_32x32x16_bf16 v[48:63], a[220:223], v[116:119], v[48:63]
    ds_read_b128 a[252:255], v19 offset:52224
    v_fma_f32 v35, v83, s59, -v26
    v_exp_f32 v35, v35
    v_add_f32 v28, v28, v34
    s_waitcnt lgkmcnt(4)
    v_mfma_f32_32x32x16_bf16 v[48:63], a[224:227], v[120:123], v[48:63]
    ds_read_b128 a[216:219], v20 offset:52224
    v_fma_f32 v36, v84, s59, -v26
    v_exp_f32 v36, v36
    v_add_f32 v28, v28, v35
    v_cvt_pk_bf16_f32 v216, v32, v33
    v_mfma_f32_32x32x16_bf16 v[48:63], a[228:231], v[124:127], v[48:63]
    ds_read_b128 a[220:223], v21 offset:52224
    v_fma_f32 v37, v85, s59, -v26
    v_exp_f32 v37, v37
    v_add_f32 v28, v28, v36
    v_cvt_pk_bf16_f32 v217, v34, v35
    v_mfma_f32_32x32x16_bf16 v[48:63], a[232:235], a[160:163], v[48:63]
    s_barrier
    ds_read_b128 a[224:227], v22 offset:0
    v_fma_f32 v38, v86, s59, -v26
    v_exp_f32 v38, v38
    v_add_f32 v28, v28, v37
    v_mfma_f32_32x32x16_bf16 v[48:63], a[236:239], a[164:167], v[48:63]
    ds_read_b128 a[228:231], v23 offset:0
    v_fma_f32 v39, v87, s59, -v26
    v_exp_f32 v39, v39
    v_add_f32 v28, v28, v38
    s_waitcnt lgkmcnt(4)
    v_mfma_f32_32x32x16_bf16 v[48:63], a[240:243], a[168:171], v[48:63]
    ds_read_b128 a[232:235], v24 offset:0
    v_fma_f32 v40, v88, s59, -v26
    v_exp_f32 v40, v40
    v_add_f32 v28, v28, v39
    v_cvt_pk_bf16_f32 v218, v36, v37
    v_mfma_f32_32x32x16_bf16 v[48:63], a[244:247], a[172:175], v[48:63]
    ds_read_b128 a[236:239], v25 offset:0
    v_fma_f32 v41, v89, s59, -v26
    v_exp_f32 v41, v41
    v_add_f32 v28, v28, v40
    v_cvt_pk_bf16_f32 v219, v38, v39
    v_mfma_f32_32x32x16_bf16 v[48:63], a[248:251], a[176:179], v[48:63]
    ds_read_b128 a[240:243], v22 offset:1024
    v_fma_f32 v42, v90, s59, -v26
    v_exp_f32 v42, v42
    v_add_f32 v28, v28, v41
    v_cvt_pk_bf16_f32 v220, v40, v41
    v_mfma_f32_32x32x16_bf16 v[48:63], a[252:255], a[180:183], v[48:63]
    ds_read_b128 a[244:247], v23 offset:1024
    v_fma_f32 v43, v91, s59, -v26
    v_exp_f32 v43, v43
    v_add_f32 v28, v28, v42
    s_waitcnt lgkmcnt(4)
    v_mfma_f32_32x32x16_bf16 v[48:63], a[216:219], a[184:187], v[48:63]
    ds_read_b128 a[248:251], v24 offset:1024
    v_fma_f32 v44, v92, s59, -v26
    v_exp_f32 v44, v44
    v_add_f32 v28, v28, v43
    v_cvt_pk_bf16_f32 v221, v42, v43
    v_mfma_f32_32x32x16_bf16 v[48:63], a[220:223], a[188:191], v[48:63]
    ds_read_b128 a[252:255], v25 offset:1024
    v_fma_f32 v45, v93, s59, -v26
    v_exp_f32 v45, v45
    v_add_f32 v28, v28, v44
    v_mfma_f32_32x32x16_bf16 v[64:79], a[224:227], v[96:99], 0
    ds_read_b128 a[216:219], v22 offset:2048
    v_fma_f32 v46, v94, s59, -v26
    v_exp_f32 v46, v46
    v_add_f32 v28, v28, v45
    v_cvt_pk_bf16_f32 v222, v44, v45
    v_mfma_f32_32x32x16_bf16 v[64:79], a[228:231], v[100:103], v[64:79]
    ds_read_b128 a[220:223], v23 offset:2048
    v_fma_f32 v47, v95, s59, -v26
    v_exp_f32 v47, v47
    v_add_f32 v28, v28, v46
    s_waitcnt lgkmcnt(4)
    v_mfma_f32_32x32x16_bf16 v[64:79], a[232:235], v[104:107], v[64:79]
    ds_read_b128 a[224:227], v24 offset:2048
    v_add_f32 v28, v28, v47
    v_cmp_lt_f32 vcc, s58, v28
    v_cvt_pk_bf16_f32 v223, v46, v47
    s_cbranch_vccnz C_rare11
C_back11:
    v_add_f32 v27, v27, v28
    v_mfma_f32_32x32x16_bf16 v[64:79], a[236:239], v[108:111], v[64:79]
    ds_read_b128 a[228:231], v25 offset:2048
    v_fma_f32 v32, v48, s59, -v26
    v_exp_f32 v32, v32
    v_fma_f32 v33, v49, s59, -v26
    v_fma_f32 v34, v50, s59, -v26
    v_mfma_f32_32x32x16_bf16 v[64:79], a[240:243], v[112:115], v[64:79]
    ds_read_b128 a[232:235], v22 offset:3072
    v_exp_f32 v33, v33
    v_exp_f32 v34, v34
    v_add_f32 v28, v32, v33
    v_mfma_f32_32x32x16_bf16 v[64:79], a[244:247], v[116:119], v[64:79]
    ds_read_b128 a[236:239], v23 offset:3072
    v_fma_f32 v35, v51, s59, -v26
    v_exp_f32 v35, v35
    v_add_f32 v28, v28, v34
    s_waitcnt lgkmcnt(4)
    v_mfma_f32_32x32x16_bf16 v[64:79], a[248:251], v[120:123], v[64:79]
    ds_read_b128 a[240:243], v24 offset:3072
    v_fma_f32 v36, v52, s59, -v26
    v_exp_f32 v36, v36
    v_add_f32 v28, v28, v35
    v_cvt_pk_bf16_f32 v224, v32, v33
    v_mfma_f32_32x32x16_bf16 v[64:79], a[252:255], v[124:127], v[64:79]
    ds_read_b128 a[244:247], v25 offset:3072
    v_fma_f32 v37, v53, s59, -v26
    v_exp_f32 v37, v37
    v_add_f32 v28, v28, v36
    v_cvt_pk_bf16_f32 v225, v34, v35
    v_mfma_f32_32x32x16_bf16 v[64:79], a[216:219], a[160:163], v[64:79]
    s_barrier
    ds_read_b128 a[248:251], v22 offset:16384
    v_fma_f32 v38, v54, s59, -v26
    v_exp_f32 v38, v38
    v_add_f32 v28, v28, v37
    v_mfma_f32_32x32x16_bf16 v[64:79], a[220:223], a[164:167], v[64:79]
    ds_read_b128 a[252:255], v23 offset:16384
    v_fma_f32 v39, v55, s59, -v26
    v_exp_f32 v39, v39
    v_add_f32 v28, v28, v38
    s_waitcnt lgkmcnt(4)
    v_mfma_f32_32x32x16_bf16 v[64:79], a[224:227], a[168:171], v[64:79]
    ds_read_b128 a[216:219], v24 offset:16384
    v_fma_f32 v40, v56, s59, -v26
    v_exp_f32 v40, v40
    v_add_f32 v28, v28, v39
    v_cvt_pk_bf16_f32 v226, v36, v37
    v_mfma_f32_32x32x16_bf16 v[64:79], a[228:231], a[172:175], v[64:79]
    ds_read_b128 a[220:223], v25 offset:16384
    v_fma_f32 v41, v57, s59, -v26
    v_exp_f32 v41, v41
    v_add_f32 v28, v28, v40
    v_cvt_pk_bf16_f32 v227, v38, v39
    v_mfma_f32_32x32x16_bf16 v[64:79], a[232:235], a[176:179], v[64:79]
    ds_read_b128 a[224:227], v22 offset:17408
    v_fma_f32 v42, v58, s59, -v26
    v_exp_f32 v42, v42
    v_add_f32 v28, v28, v41
    v_cvt_pk_bf16_f32 v228, v40, v41
    v_mfma_f32_32x32x16_bf16 v[64:79], a[236:239], a[180:183], v[64:79]
    ds_read_b128 a[228:231], v23 offset:17408
    v_fma_f32 v43, v59, s59, -v26
    v_exp_f32 v43, v43
    v_add_f32 v28, v28, v42
    s_waitcnt lgkmcnt(4)
    v_mfma_f32_32x32x16_bf16 v[64:79], a[240:243], a[184:187], v[64:79]
    ds_read_b128 a[232:235], v24 offset:17408
    v_fma_f32 v44, v60, s59, -v26
    v_exp_f32 v44, v44
    v_add_f32 v28, v28, v43
    v_cvt_pk_bf16_f32 v229, v42, v43
    v_mfma_f32_32x32x16_bf16 v[64:79], a[244:247], a[188:191], v[64:79]
    ds_read_b128 a[236:239], v25 offset:17408
    v_fma_f32 v45, v61, s59, -v26
    v_exp_f32 v45, v45
    v_add_f32 v28, v28, v44
    v_mfma_f32_32x32x16_bf16 v[80:95], a[248:251], v[96:99], 0
    ds_read_b128 a[240:243], v22 offset:18432
    v_fma_f32 v46, v62, s59, -v26
    v_exp_f32 v46, v46
    v_add_f32 v28, v28, v45
    v_cvt_pk_bf16_f32 v230, v44, v45
    v_mfma_f32_32x32x16_bf16 v[80:95], a[252:255], v[100:103], v[80:95]
    ds_read_b128 a[244:247], v23 offset:18432
    v_fma_f32 v47, v63, s59, -v26
    v_exp_f32 v47, v47
    v_add_f32 v28, v28, v46
    s_waitcnt lgkmcnt(4)
    v_mfma_f32_32x32x16_bf16 v[80:95], a[216:219], v[104:107], v[80:95]
    ds_read_b128 a[248:251], v24 offset:18432
    v_add_f32 v28, v28, v47
    v_cmp_lt_f32 vcc, s58, v28
    v_cvt_pk_bf16_f32 v231, v46, v47
    s_cbranch_vccnz C_rare12
C_back12:
    v_add_f32 v27, v27, v28
    v_mfma_f32_32x32x16_bf16 v[80:95], a[220:223], v[108:111], v[80:95]
    ds_read_b128 a[252:255], v25 offset:18432
    v_fma_f32 v32, v64, s59, -v26
    v_exp_f32 v32, v32
    v_fma_f32 v33, v65, s59, -v26
    v_fma_f32 v34, v66, s59, -v26
    v_mfma_f32_32x32x16_bf16 v[80:95], a[224:227], v[112:115], v[80:95]
    ds_read_b128 a[216:219], v22 offset:19456
    v_exp_f32 v33, v33
    v_exp_f32 v34, v34
    v_add_f32 v28, v32, v33
    v_mfma_f32_32x32x16_bf16 v[80:95], a[228:231], v[116:119], v[80:95]
    ds_read_b128 a[220:223], v23 offset:19456
    v_fma_f32 v35, v67, s59, -v26
    v_exp_f32 v35, v35
    v_add_f32 v28, v28, v34
    s_waitcnt lgkmcnt(4)
    v_mfma_f32_32x32x16_bf16 v[80:95], a[232:235], v[120:123], v[80:95]
    ds_read_b128 a[224:227], v24 offset:19456
    v_fma_f32 v36, v68, s59, -v26
    v_exp_f32 v36, v36
    v_add_f32 v28, v28, v35
    v_cvt_pk_bf16_f32 v232, v32, v33
    v_mfma_f32_32x32x16_bf16 v[80:95], a[236:239], v[124:127], v[80:95]
    ds_read_b128 a[228:231], v25 offset:19456
    v_fma_f32 v37, v69, s59, -v26
    v_exp_f32 v37, v37
    v_add_f32 v28, v28, v36
    v_cvt_pk_bf16_f32 v233, v34, v35
    v_mfma_f32_32x32x16_bf16 v[80:95], a[240:243], a[160:163], v[80:95]
    s_barrier
    ds_read_b128 a[232:235], v22 offset:32768
    v_fma_f32 v38, v70, s59, -v26
    v_exp_f32 v38, v38
    v_add_f32 v28, v28, v37
    v_mfma_f32_32x32x16_bf16 v[80:95], a[244:247], a[164:167], v[80:95]
    ds_read_b128 a[236:239], v23 offset:32768
    v_fma_f32 v39, v71, s59, -v26
    v_exp_f32 v39, v39
    v_add_f32 v28, v28, v38
    s_waitcnt lgkmcnt(4)
    v_mfma_f32_32x32x16_bf16 v[80:95], a[248:251], a[168:171], v[80:95]
    ds_read_b128 a[240:243], v24 offset:32768
    v_fma_f32 v40, v72, s59, -v26
    v_exp_f32 v40, v40
    v_add_f32 v28, v28, v39
    v_cvt_pk_bf16_f32 v234, v36, v37
    v_mfma_f32_32x32x16_bf16 v[80:95], a[252:255], a[172:175], v[80:95]
    ds_read_b128 a[244:247], v25 offset:32768
    v_fma_f32 v41, v73, s59, -v26
    v_exp_f32 v41, v41
    v_add_f32 v28, v28, v40
    v_cvt_pk_bf16_f32 v235, v38, v39
    v_mfma_f32_32x32x16_bf16 v[80:95], a[216:219], a[176:179], v[80:95]
    ds_read_b128 a[248:251], v22 offset:33792
    v_fma_f32 v42, v74, s59, -v26
    v_exp_f32 v42, v42
    v_add_f32 v28, v28, v41
    v_cvt_pk_bf16_f32 v236, v40, v41
    v_mfma_f32_32x32x16_bf16 v[80:95], a[220:223], a[180:183], v[80:95]
    ds_read_b128 a[252:255], v23 offset:33792
    v_fma_f32 v43, v75, s59, -v26
    v_exp_f32 v43, v43
    v_add_f32 v28, v28, v42
    s_waitcnt lgkmcnt(4)
    v_mfma_f32_32x32x16_bf16 v[80:95], a[224:227], a[184:187], v[80:95]
    ds_read_b128 a[216:219], v24 offset:33792
    v_fma_f32 v44, v76, s59, -v26
    v_exp_f32 v44, v44
    v_add_f32 v28, v28, v43
    v_cvt_pk_bf16_f32 v237, v42, v43
    v_mfma_f32_32x32x16_bf16 v[80:95], a[228:231], a[188:191], v[80:95]
    ds_read_b128 a[220:223], v25 offset:33792
    v_fma_f32 v45, v77, s59, -v26
    v_exp_f32 v45, v45
    v_add_f32 v28, v28, v44
    v_mfma_f32_32x32x16_bf16 v[48:63], a[232:235], v[96:99], 0
    ds_read_b128 a[224:227], v22 offset:34816
    v_fma_f32 v46, v78, s59, -v26
    v_exp_f32 v46, v46
    v_add_f32 v28, v28, v45
    v_cvt_pk_bf16_f32 v238, v44, v45
    v_mfma_f32_32x32x16_bf16 v[48:63], a[236:239], v[100:103], v[48:63]
    ds_read_b128 a[228:231], v23 offset:34816
    v_fma_f32 v47, v79, s59, -v26
    v_exp_f32 v47, v47
    v_add_f32 v28, v28, v46
    s_waitcnt lgkmcnt(4)
    v_mfma_f32_32x32x16_bf16 v[48:63], a[240:243], v[104:107], v[48:63]
    ds_read_b128 a[232:235], v24 offset:34816
    v_add_f32 v28, v28, v47
    v_cmp_lt_f32 vcc, s58, v28
    v_cvt_pk_bf16_f32 v239, v46, v47
    s_cbranch_vccnz C_rare13
C_back13:
    v_add_f32 v27, v27, v28
    v_mfma_f32_32x32x16_bf16 v[48:63], a[244:247], v[108:111], v[48:63]
    ds_read_b128 a[236:239], v25 offset:34816
    v_fma_f32 v32, v80, s59, -v26
    v_exp_f32 v32, v32
    v_fma_f32 v33, v81, s59, -v26
    v_fma_f32 v34, v82, s59, -v26
    v_mfma_f32_32x32x16_bf16 v[48:63], a[248:251], v[112:115], v[48:63]
    ds_read_b128 a[240:243], v22 offset:35840
    v_exp_f32 v33, v33
    v_exp_f32 v34, v34
    v_add_f32 v28, v32, v33
    v_mfma_f32_32x32x16_bf16 v[48:63], a[252:255], v[116:119], v[48:63]
    ds_read_b128 a[244:247], v23 offset:35840
    v_fma_f32 v35, v83, s59, -v26
    v_exp_f32 v35, v35
    v_add_f32 v28, v28, v34
    s_waitcnt lgkmcnt(4)
    v_mfma_f32_32x32x16_bf16 v[48:63], a[216:219], v[120:123], v[48:63]
    ds_read_b128 a[248:251], v24 offset:35840
    v_fma_f32 v36, v84, s59, -v26
    v_exp_f32 v36, v36
    v_add_f32 v28, v28, v35
    v_cvt_pk_bf16_f32 v240, v32, v33
    v_mfma_f32_32x32x16_bf16 v[48:63], a[220:223], v[124:127], v[48:63]
    ds_read_b128 a[252:255], v25 offset:35840
    v_fma_f32 v37, v85, s59, -v26
    v_exp_f32 v37, v37
    v_add_f32 v28, v28, v36
    v_cvt_pk_bf16_f32 v241, v34, v35
    v_mfma_f32_32x32x16_bf16 v[48:63], a[224:227], a[160:163], v[48:63]
    v_add_u32 v14, 0x10000, v14
    v_fma_f32 v38, v86, s59, -v26
    v_exp_f32 v38, v38
    v_add_f32 v28, v28, v37
    v_cvt_pk_bf16_f32 v242, v36, v37
    v_mfma_f32_32x32x16_bf16 v[48:63], a[228:231], a[164:167], v[48:63]
    v_add_u32 v15, 0x10000, v15
    v_fma_f32 v39, v87, s59, -v26
    v_exp_f32 v39, v39
    v_add_f32 v28, v28, v38
    s_waitcnt lgkmcnt(2)
    v_mfma_f32_32x32x16_bf16 v[48:63], a[232:235], a[168:171], v[48:63]
    v_add_u32 v16, 0x10000, v16
    v_fma_f32 v40, v88, s59, -v26
    v_exp_f32 v40, v40
    v_add_f32 v28, v28, v39
    v_cvt_pk_bf16_f32 v243, v38, v39
    v_mfma_f32_32x32x16_bf16 v[48:63], a[236:239], a[172:175], v[48:63]
    s_barrier
    ds_read_b64_tr_b16 a[216:217], v14 offset:49152
    ds_read_b64_tr_b16 a[218:219], v14 offset:51200
    v_add_u32 v17, 0x10000, v17
    v_fma_f32 v41, v89, s59, -v26
    v_exp_f32 v41, v41
    v_add_f32 v28, v28, v40
    v_mfma_f32_32x32x16_bf16 v[48:63], a[240:243], a[176:179], v[48:63]
    ds_read_b64_tr_b16 a[220:221], v15 offset:49152
    ds_read_b64_tr_b16 a[222:223], v15 offset:51200
    v_fma_f32 v42, v90, s59, -v26
    v_exp_f32 v42, v42
    v_add_f32 v28, v28, v41
    v_cvt_pk_bf16_f32 v244, v40, v41
    v_mfma_f32_32x32x16_bf16 v[48:63], a[244:247], a[180:183], v[48:63]
    ds_read_b64_tr_b16 a[224:225], v16 offset:49152
    ds_read_b64_tr_b16 a[226:227], v16 offset:51200
    v_fma_f32 v43, v91, s59, -v26
    v_exp_f32 v43, v43
    v_add_f32 v28, v28, v42
    s_waitcnt lgkmcnt(2)
    v_mfma_f32_32x32x16_bf16 v[48:63], a[248:251], a[184:187], v[48:63]
    ds_read_b64_tr_b16 a[228:229], v17 offset:49152
    ds_read_b64_tr_b16 a[230:231], v17 offset:51200
    v_fma_f32 v44, v92, s59, -v26
    v_exp_f32 v44, v44
    v_add_f32 v28, v28, v43
    v_cvt_pk_bf16_f32 v245, v42, v43
    v_mfma_f32_32x32x16_bf16 v[48:63], a[252:255], a[188:191], v[48:63]
    ds_read_b64_tr_b16 a[232:233], v14 offset:53248
    ds_read_b64_tr_b16 a[234:235], v14 offset:55296
    v_fma_f32 v45, v93, s59, -v26
    v_exp_f32 v45, v45
    v_add_f32 v28, v28, v44
    v_mfma_f32_32x32x16_bf16 v[64:79], a[216:219], v[128:131], 0
    ds_read_b64_tr_b16 a[236:237], v15 offset:53248
    ds_read_b64_tr_b16 a[238:239], v15 offset:55296
    v_fma_f32 v46, v94, s59, -v26
    v_exp_f32 v46, v46
    v_add_f32 v28, v28, v45
    v_cvt_pk_bf16_f32 v246, v44, v45
    v_mfma_f32_32x32x16_bf16 v[96:111], a[220:223], v[128:131], 0
    ds_read_b64_tr_b16 a[240:241], v16 offset:53248
    ds_read_b64_tr_b16 a[242:243], v16 offset:55296
    v_fma_f32 v47, v95, s59, -v26
    v_exp_f32 v47, v47
    v_add_f32 v28, v28, v46
    s_waitcnt lgkmcnt(6)
    v_mfma_f32_32x32x16_bf16 v[112:127], a[224:227], v[128:131], 0
    ds_read_b64_tr_b16 a[244:245], v17 offset:53248
    ds_read_b64_tr_b16 a[246:247], v17 offset:55296
    v_add_f32 v28, v28, v47
    v_cmp_lt_f32 vcc, s58, v28
    v_cvt_pk_bf16_f32 v247, v46, v47
    s_cbranch_vccnz C_rare14
C_back14:
    v_add_f32 v27, v27, v28
    v_mfma_f32_32x32x16_bf16 v[80:95], a[228:231], v[128:131], 0
    ds_read_b64_tr_b16 a[248:249], v14 offset:57344
    ds_read_b64_tr_b16 a[250:251], v14 offset:59392
    v_fma_f32 v32, v48, s59, -v26
    s_waitcnt lgkmcnt(6)
    v_mfma_f32_32x32x16_bf16 v[64:79], a[232:235], v[132:135], v[64:79]
    ds_read_b64_tr_b16 a[252:253], v15 offset:57344
    ds_read_b64_tr_b16 a[254:255], v15 offset:59392
    v_exp_f32 v32, v32
    v_fma_f32 v33, v49, s59, -v26
    v_mfma_f32_32x32x16_bf16 v[96:111], a[236:239], v[132:135], v[96:111]
    ds_read_b64_tr_b16 a[216:217], v16 offset:57344
    ds_read_b64_tr_b16 a[218:219], v16 offset:59392
    v_fma_f32 v34, v50, s59, -v26
    s_waitcnt lgkmcnt(6)
    v_mfma_f32_32x32x16_bf16 v[112:127], a[240:243], v[132:135], v[112:127]
    ds_read_b64_tr_b16 a[220:221], v17 offset:57344
    ds_read_b64_tr_b16 a[222:223], v17 offset:59392
    v_exp_f32 v33, v33
    v_mfma_f32_32x32x16_bf16 v[80:95], a[244:247], v[132:135], v[80:95]
    ds_read_b64_tr_b16 a[224:225], v14 offset:61440
    ds_read_b64_tr_b16 a[226:227], v14 offset:63488
    v_exp_f32 v34, v34
    s_waitcnt lgkmcnt(6)
    v_mfma_f32_32x32x16_bf16 v[64:79], a[248:251], v[136:139], v[64:79]
    ds_read_b64_tr_b16 a[228:229], v15 offset:61440
    ds_read_b64_tr_b16 a[230:231], v15 offset:63488
    v_add_f32 v28, v32, v33
    v_fma_f32 v35, v51, s59, -v26
    v_mfma_f32_32x32x16_bf16 v[96:111], a[252:255], v[136:139], v[96:111]
    ds_read_b64_tr_b16 a[232:233], v16 offset:61440
    ds_read_b64_tr_b16 a[234:235], v16 offset:63488
    v_add_u32 v14, 0x10000, v14
    s_waitcnt lgkmcnt(6)
    v_mfma_f32_32x32x16_bf16 v[112:127], a[216:219], v[136:139], v[112:127]
    ds_read_b64_tr_b16 a[236:237], v17 offset:61440
    ds_read_b64_tr_b16 a[238:239], v17 offset:63488
    v_add_u32 v15, 0x10000, v15
    v_exp_f32 v35, v35
    v_mfma_f32_32x32x16_bf16 v[80:95], a[220:223], v[136:139], v[80:95]
    s_barrier
    ds_read_b64_tr_b16 a[240:241], v14 offset:0
    ds_read_b64_tr_b16 a[242:243], v14 offset:2048
    v_add_u32 v16, 0x10000, v16
    s_waitcnt lgkmcnt(6)
    v_mfma_f32_32x32x16_bf16 v[64:79], a[224:227], v[140:143], v[64:79]
    ds_read_b64_tr_b16 a[244:245], v15 offset:0
    ds_read_b64_tr_b16 a[246:247], v15 offset:2048
    v_add_u32 v17, 0x10000, v17
    v_add_f32 v28, v28, v34
    v_cvt_pk_bf16_f32 v248, v32, v33
    v_mfma_f32_32x32x16_bf16 v[96:111], a[228:231], v[140:143], v[96:111]
    ds_read_b64_tr_b16 a[248:249], v16 offset:0
    ds_read_b64_tr_b16 a[250:251], v16 offset:2048
    v_fma_f32 v36, v52, s59, -v26
    s_waitcnt lgkmcnt(6)
    v_mfma_f32_32x32x16_bf16 v[112:127], a[232:235], v[140:143], v[112:127]
    ds_read_b64_tr_b16 a[252:253], v17 offset:0
    ds_read_b64_tr_b16 a[254:255], v17 offset:2048
    v_exp_f32 v36, v36
    v_add_f32 v28, v28, v35
    v_mfma_f32_32x32x16_bf16 v[80:95], a[236:239], v[140:143], v[80:95]
    ds_read_b64_tr_b16 a[216:217], v14 offset:4096
    ds_read_b64_tr_b16 a[218:219], v14 offset:6144
    v_fma_f32 v37, v53, s59, -v26
    s_waitcnt lgkmcnt(6)
    v_mfma_f32_32x32x16_bf16 v[64:79], a[240:243], v[144:147], v[64:79]
    ds_read_b64_tr_b16 a[220:221], v15 offset:4096
    ds_read_b64_tr_b16 a[222:223], v15 offset:6144
    v_exp_f32 v37, v37
    v_add_f32 v28, v28, v36
    v_mfma_f32_32x32x16_bf16 v[96:111], a[244:247], v[144:147], v[96:111]
    ds_read_b64_tr_b16 a[224:225], v16 offset:4096
    ds_read_b64_tr_b16 a[226:227], v16 offset:6144
    v_cvt_pk_bf16_f32 v249, v34, v35
    v_fma_f32 v38, v54, s59, -v26
    s_waitcnt lgkmcnt(6)
    v_mfma_f32_32x32x16_bf16 v[112:127], a[248:251], v[144:147], v[112:127]
    ds_read_b64_tr_b16 a[228:229], v17 offset:4096
    ds_read_b64_tr_b16 a[230:231], v17 offset:6144
    v_exp_f32 v38, v38
    v_add_f32 v28, v28, v37
    v_mfma_f32_32x32x16_bf16 v[80:95], a[252:255], v[144:147], v[80:95]
    ds_read_b64_tr_b16 a[232:233], v14 offset:8192
    ds_read_b64_tr_b16 a[234:235], v14 offset:10240
    v_fma_f32 v39, v55, s59, -v26
    s_waitcnt lgkmcnt(6)
    v_mfma_f32_32x32x16_bf16 v[64:79], a[216:219], v[148:151], v[64:79]
    ds_read_b64_tr_b16 a[236:237], v15 offset:8192
    ds_read_b64_tr_b16 a[238:239], v15 offset:10240
    v_exp_f32 v39, v39
    v_add_f32 v28, v28, v38
    v_mfma_f32_32x32x16_bf16 v[96:111], a[220:223], v[148:151], v[96:111]
    ds_read_b64_tr_b16 a[240:241], v16 offset:8192
    ds_read_b64_tr_b16 a[242:243], v16 offset:10240
    v_cvt_pk_bf16_f32 v250, v36, v37
    v_fma_f32 v40, v56, s59, -v26
    s_waitcnt lgkmcnt(6)
    v_mfma_f32_32x32x16_bf16 v[112:127], a[224:227], v[148:151], v[112:127]
    ds_read_b64_tr_b16 a[244:245], v17 offset:8192
    ds_read_b64_tr_b16 a[246:247], v17 offset:10240
    v_exp_f32 v40, v40
    v_add_f32 v28, v28, v39
    v_mfma_f32_32x32x16_bf16 v[80:95], a[228:231], v[148:151], v[80:95]
    ds_read_b64_tr_b16 a[248:249], v14 offset:12288
    ds_read_b64_tr_b16 a[250:251], v14 offset:14336
    v_fma_f32 v41, v57, s59, -v26
    s_waitcnt lgkmcnt(6)
    v_mfma_f32_32x32x16_bf16 v[64:79], a[232:235], v[152:155], v[64:79]
    ds_read_b64_tr_b16 a[252:253], v15 offset:12288
    ds_read_b64_tr_b16 a[254:255], v15 offset:14336
    v_exp_f32 v41, v41
    v_add_f32 v28, v28, v40
    v_mfma_f32_32x32x16_bf16 v[96:111], a[236:239], v[152:155], v[96:111]
    ds_read_b64_tr_b16 a[216:217], v16 offset:12288
    ds_read_b64_tr_b16 a[218:219], v16 offset:14336
    v_cvt_pk_bf16_f32 v251, v38, v39
    v_fma_f32 v42, v58, s59, -v26
    s_waitcnt lgkmcnt(6)
    v_mfma_f32_32x32x16_bf16 v[112:127], a[240:243], v[152:155], v[112:127]
    ds_read_b64_tr_b16 a[220:221], v17 offset:12288
    ds_read_b64_tr_b16 a[222:223], v17 offset:14336
    v_exp_f32 v42, v42
    v_add_f32 v28, v28, v41
    v_mfma_f32_32x32x16_bf16 v[80:95], a[244:247], v[152:155], v[80:95]
    s_barrier
    ds_read_b64_tr_b16 a[224:225], v14 offset:16384
    ds_read_b64_tr_b16 a[226:227], v14 offset:18432
    v_fma_f32 v43, v59, s59, -v26
    s_waitcnt lgkmcnt(6)
    v_mfma_f32_32x32x16_bf16 v[64:79], a[248:251], v[156:159], v[64:79]
    ds_read_b64_tr_b16 a[228:229], v15 offset:16384
    ds_read_b64_tr_b16 a[230:231], v15 offset:18432
C_pad5:
    s_cbranch_execz C_pad8
    v_exp_f32 v43, v43
    v_add_f32 v28, v28, v42
    v_mfma_f32_32x32x16_bf16 v[96:111], a[252:255], v[156:159], v[96:111]
    ds_read_b64_tr_b16 a[232:233], v16 offset:16384
    ds_read_b64_tr_b16 a[234:235], v16 offset:18432
    v_cvt_pk_bf16_f32 v252, v40, v41
    v_fma_f32 v44, v60, s59, -v26
    s_waitcnt lgkmcnt(6)
    v_mfma_f32_32x32x16_bf16 v[112:127], a[216:219], v[156:159], v[112:127]
    ds_read_b64_tr_b16 a[236:237], v17 offset:16384
    ds_read_b64_tr_b16 a[238:239], v17 offset:18432
    v_exp_f32 v44, v44
    v_add_f32 v28, v28, v43
    v_mfma_f32_32x32x16_bf16 v[80:95], a[220:223], v[156:159], v[80:95]
    ds_read_b64_tr_b16 a[240:241], v14 offset:20480
    ds_read_b64_tr_b16 a[242:243], v14 offset:22528
    v_fma_f32 v45, v61, s59, -v26
    s_waitcnt lgkmcnt(6)
    v_mfma_f32_32x32x16_bf16 v[64:79], a[224:227], v[160:163], v[64:79]
    ds_read_b64_tr_b16 a[244:245], v15 offset:20480
    ds_read_b64_tr_b16 a[246:247], v15 offset:22528
    v_exp_f32 v45, v45
    v_add_f32 v28, v28, v44
    v_mfma_f32_32x32x16_bf16 v[96:111], a[228:231], v[160:163], v[96:111]
    ds_read_b64_tr_b16 a[248:249], v16 offset:20480
    ds_read_b64_tr_b16 a[250:251], v16 offset:22528
    v_cvt_pk_bf16_f32 v253, v42, v43
    v_fma_f32 v46, v62, s59, -v26
    s_waitcnt lgkmcnt(6)
    v_mfma_f32_32x32x16_bf16 v[112:127], a[232:235], v[160:163], v[112:127]
    ds_read_b64_tr_b16 a[252:253], v17 offset:20480
    ds_read_b64_tr_b16 a[254:255], v17 offset:22528
    v_exp_f32 v46, v46
    v_add_f32 v28, v28, v45
    v_mfma_f32_32x32x16_bf16 v[80:95], a[236:239], v[160:163], v[80:95]
    ds_read_b64_tr_b16 a[216:217], v14 offset:24576
    ds_read_b64_tr_b16 a[218:219], v14 offset:26624
    v_fma_f32 v47, v63, s59, -v26
    s_waitcnt lgkmcnt(6)
    v_mfma_f32_32x32x16_bf16 v[64:79], a[240:243], v[164:167], v[64:79]
    ds_read_b64_tr_b16 a[220:221], v15 offset:24576
    ds_read_b64_tr_b16 a[222:223], v15 offset:26624
    v_exp_f32 v47, v47
    v_add_f32 v28, v28, v46
    v_mfma_f32_32x32x16_bf16 v[96:111], a[244:247], v[164:167], v[96:111]
    ds_read_b64_tr_b16 a[224:225], v16 offset:24576
    ds_read_b64_tr_b16 a[226:227], v16 offset:26624
    v_cvt_pk_bf16_f32 v254, v44, v45
    v_add_f32 v28, v28, v47
    s_waitcnt lgkmcnt(6)
    v_mfma_f32_32x32x16_bf16 v[112:127], a[248:251], v[164:167], v[112:127]
    ds_read_b64_tr_b16 a[228:229], v17 offset:24576
    ds_read_b64_tr_b16 a[230:231], v17 offset:26624
    v_cmp_lt_f32 vcc, s58, v28
    v_cvt_pk_bf16_f32 v255, v46, v47
    s_cbranch_vccnz C_rare15
C_back15:
    v_mfma_f32_32x32x16_bf16 v[80:95], a[252:255], v[164:167], v[80:95]
    ds_read_b64_tr_b16 a[232:233], v14 offset:28672
    ds_read_b64_tr_b16 a[234:235], v14 offset:30720
    v_add_f32 v27, v27, v28
    s_waitcnt lgkmcnt(6)
    v_mfma_f32_32x32x16_bf16 v[64:79], a[216:219], v[168:171], v[64:79]
    ds_read_b64_tr_b16 a[236:237], v15 offset:28672
    ds_read_b64_tr_b16 a[238:239], v15 offset:30720
    v_mov_b32 v30, v27
    s_add_u32 s56, s64, 4096
    s_add_u32 s60, s64, 8192
    v_permlane32_swap_b32 v27, v30
    v_mfma_f32_32x32x16_bf16 v[96:111], a[220:223], v[168:171], v[96:111]
    ds_read_b64_tr_b16 a[240:241], v16 offset:28672
    ds_read_b64_tr_b16 a[242:243], v16 offset:30720
    v_add_u32 v14, 0xfffe0000, v14
    v_add_f32 v27, v27, v30
    s_add_u32 s61, s65, 4096
    s_waitcnt lgkmcnt(6)
    v_mfma_f32_32x32x16_bf16 v[112:127], a[224:227], v[168:171], v[112:127]
    ds_read_b64_tr_b16 a[244:245], v17 offset:28672
    ds_read_b64_tr_b16 a[246:247], v17 offset:30720
    v_add_u32 v15, 0xfffe0000, v15
    s_add_u32 s62, s65, 8192
    v_mfma_f32_32x32x16_bf16 v[80:95], a[228:231], v[168:171], v[80:95]
    s_barrier
    ds_read_b64_tr_b16 a[248:249], v14 offset:0
    ds_read_b64_tr_b16 a[250:251], v14 offset:2048
    v_add_u32 v16, 0xfffe0000, v16
    s_waitcnt lgkmcnt(6)
    v_mfma_f32_32x32x16_bf16 v[64:79], a[232:235], v[172:175], v[64:79]
    ds_read_b64_tr_b16 a[252:253], v15 offset:0
    ds_read_b64_tr_b16 a[254:255], v15 offset:2048
    v_add_u32 v17, 0xfffe0000, v17
    buffer_store_dwordx2 v[26:27], v7, s[36:39], s64 offen
    v_mfma_f32_32x32x16_bf16 v[96:111], a[236:239], v[172:175], v[96:111]
    ds_read_b64_tr_b16 a[216:217], v16 offset:0
    ds_read_b64_tr_b16 a[218:219], v16 offset:2048
    v_accvgpr_write_b32 a96, v192
    v_accvgpr_write_b32 a97, v193
    s_waitcnt lgkmcnt(6)
    v_mfma_f32_32x32x16_bf16 v[112:127], a[240:243], v[172:175], v[112:127]
    ds_read_b64_tr_b16 a[220:221], v17 offset:0
    ds_read_b64_tr_b16 a[222:223], v17 offset:2048
    v_accvgpr_write_b32 a98, v194
    v_accvgpr_write_b32 a99, v195
    v_accvgpr_write_b32 a100, v196
    v_mfma_f32_32x32x16_bf16 v[80:95], a[244:247], v[172:175], v[80:95]
    ds_read_b64_tr_b16 a[224:225], v14 offset:4096
    ds_read_b64_tr_b16 a[226:227], v14 offset:6144
    v_accvgpr_write_b32 a101, v197
    v_accvgpr_write_b32 a102, v198
    s_waitcnt lgkmcnt(6)
    v_mfma_f32_32x32x16_bf16 v[64:79], a[248:251], v[176:179], v[64:79]
    ds_read_b64_tr_b16 a[228:229], v15 offset:4096
    ds_read_b64_tr_b16 a[230:231], v15 offset:6144
    v_accvgpr_write_b32 a103, v199
    v_accvgpr_write_b32 a104, v200
    v_accvgpr_write_b32 a105, v201
    v_mfma_f32_32x32x16_bf16 v[96:111], a[252:255], v[176:179], v[96:111]
    ds_read_b64_tr_b16 a[232:233], v16 offset:4096
    ds_read_b64_tr_b16 a[234:235], v16 offset:6144
    v_accvgpr_write_b32 a106, v202
    v_accvgpr_write_b32 a107, v203
    s_waitcnt lgkmcnt(6)
    v_mfma_f32_32x32x16_bf16 v[112:127], a[216:219], v[176:179], v[112:127]
    ds_read_b64_tr_b16 a[236:237], v17 offset:4096
    ds_read_b64_tr_b16 a[238:239], v17 offset:6144
    v_accvgpr_write_b32 a108, v204
    v_accvgpr_write_b32 a109, v205
    v_accvgpr_write_b32 a110, v206
    v_mfma_f32_32x32x16_bf16 v[80:95], a[220:223], v[176:179], v[80:95]
    ds_read_b64_tr_b16 a[240:241], v14 offset:8192
    ds_read_b64_tr_b16 a[242:243], v14 offset:10240
    v_accvgpr_write_b32 a111, v207
    s_waitcnt lgkmcnt(6)
    v_mfma_f32_32x32x16_bf16 v[64:79], a[224:227], v[180:183], v[64:79]
    ds_read_b64_tr_b16 a[244:245], v15 offset:8192
    ds_read_b64_tr_b16 a[246:247], v15 offset:10240
    buffer_load_dword v1, v3, s[36:39], s35 offen sc1
    v_mfma_f32_32x32x16_bf16 v[96:111], a[228:231], v[180:183], v[96:111]
    ds_read_b64_tr_b16 a[248:249], v16 offset:8192
    ds_read_b64_tr_b16 a[250:251], v16 offset:10240
    v_accvgpr_write_b32 a112, v208
    v_accvgpr_write_b32 a113, v209
    s_waitcnt lgkmcnt(6)
    v_mfma_f32_32x32x16_bf16 v[112:127], a[232:235], v[180:183], v[112:127]
    ds_read_b64_tr_b16 a[252:253], v17 offset:8192
    ds_read_b64_tr_b16 a[254:255], v17 offset:10240
    v_accvgpr_write_b32 a114, v210
    v_accvgpr_write_b32 a115, v211
    v_accvgpr_write_b32 a116, v212
    v_mfma_f32_32x32x16_bf16 v[80:95], a[236:239], v[180:183], v[80:95]
    ds_read_b64_tr_b16 a[216:217], v14 offset:12288
    ds_read_b64_tr_b16 a[218:219], v14 offset:14336
    v_accvgpr_write_b32 a117, v213
    v_accvgpr_write_b32 a118, v214
    s_waitcnt lgkmcnt(6)
    v_mfma_f32_32x32x16_bf16 v[64:79], a[240:243], v[184:187], v[64:79]
    ds_read_b64_tr_b16 a[220:221], v15 offset:12288
    ds_read_b64_tr_b16 a[222:223], v15 offset:14336
    v_accvgpr_write_b32 a119, v215
    v_accvgpr_write_b32 a120, v216
    v_accvgpr_write_b32 a121, v217
    v_mfma_f32_32x32x16_bf16 v[96:111], a[244:247], v[184:187], v[96:111]
    ds_read_b64_tr_b16 a[224:225], v16 offset:12288
    ds_read_b64_tr_b16 a[226:227], v16 offset:14336
    v_accvgpr_write_b32 a122, v218
    v_accvgpr_write_b32 a123, v219
    s_waitcnt lgkmcnt(6)
    v_mfma_f32_32x32x16_bf16 v[112:127], a[248:251], v[184:187], v[112:127]
    ds_read_b64_tr_b16 a[228:229], v17 offset:12288
    ds_read_b64_tr_b16 a[230:231], v17 offset:14336
    v_accvgpr_write_b32 a124, v220
    v_accvgpr_write_b32 a125, v221
    v_accvgpr_write_b32 a126, v222
    v_mfma_f32_32x32x16_bf16 v[80:95], a[252:255], v[184:187], v[80:95]
    s_barrier
    ds_read_b64_tr_b16 a[232:233], v14 offset:16384
    ds_read_b64_tr_b16 a[234:235], v14 offset:18432
    v_accvgpr_write_b32 a127, v223
    s_waitcnt lgkmcnt(6)
    v_mfma_f32_32x32x16_bf16 v[64:79], a[216:219], v[188:191], v[64:79]
    ds_read_b64_tr_b16 a[236:237], v15 offset:16384
    ds_read_b64_tr_b16 a[238:239], v15 offset:18432
    v_mov_b32 v18, v9
    v_xor_b32 v19, 64, v9
    v_accvgpr_write_b32 a128, v224
    v_mfma_f32_32x32x16_bf16 v[96:111], a[220:223], v[188:191], v[96:111]
    ds_read_b64_tr_b16 a[240:241], v16 offset:16384
    ds_read_b64_tr_b16 a[242:243], v16 offset:18432
    v_accvgpr_write_b32 a129, v225
    v_accvgpr_write_b32 a130, v226
    s_waitcnt lgkmcnt(6)
    v_mfma_f32_32x32x16_bf16 v[112:127], a[224:227], v[188:191], v[112:127]
    ds_read_b64_tr_b16 a[244:245], v17 offset:16384
    ds_read_b64_tr_b16 a[246:247], v17 offset:18432
    v_accvgpr_write_b32 a131, v227
    v_accvgpr_write_b32 a132, v228
    v_accvgpr_write_b32 a133, v229
    v_mfma_f32_32x32x16_bf16 v[80:95], a[228:231], v[188:191], v[80:95]
    ds_read_b64_tr_b16 a[248:249], v14 offset:20480
    ds_read_b64_tr_b16 a[250:251], v14 offset:22528
    v_accvgpr_write_b32 a134, v230
    v_accvgpr_write_b32 a135, v231
    s_waitcnt lgkmcnt(6)
    v_mfma_f32_32x32x16_bf16 v[64:79], a[232:235], v[192:195], v[64:79]
    ds_read_b64_tr_b16 a[252:253], v15 offset:20480
    ds_read_b64_tr_b16 a[254:255], v15 offset:22528
    v_accvgpr_write_b32 a136, v232
    v_accvgpr_write_b32 a137, v233
    v_accvgpr_write_b32 a138, v234
    v_mfma_f32_32x32x16_bf16 v[96:111], a[236:239], v[192:195], v[96:111]
    ds_read_b64_tr_b16 a[216:217], v16 offset:20480
    ds_read_b64_tr_b16 a[218:219], v16 offset:22528
    v_accvgpr_write_b32 a139, v235
    v_accvgpr_write_b32 a140, v236
    s_waitcnt lgkmcnt(6)
    v_mfma_f32_32x32x16_bf16 v[112:127], a[240:243], v[192:195], v[112:127]
    ds_read_b64_tr_b16 a[220:221], v17 offset:20480
    ds_read_b64_tr_b16 a[222:223], v17 offset:22528
    v_accvgpr_write_b32 a141, v237
    v_accvgpr_write_b32 a142, v238
    v_accvgpr_write_b32 a143, v239
    v_mfma_f32_32x32x16_bf16 v[80:95], a[244:247], v[192:195], v[80:95]
    ds_read_b64_tr_b16 a[224:225], v14 offset:24576
    ds_read_b64_tr_b16 a[226:227], v14 offset:26624
    v_accvgpr_write_b32 a144, v240
    v_accvgpr_write_b32 a145, v241
    s_waitcnt lgkmcnt(6)
    v_mfma_f32_32x32x16_bf16 v[64:79], a[248:251], v[196:199], v[64:79]
    ds_read_b64_tr_b16 a[228:229], v15 offset:24576
    ds_read_b64_tr_b16 a[230:231], v15 offset:26624
    v_accvgpr_write_b32 a146, v242
    v_accvgpr_write_b32 a147, v243
    v_accvgpr_write_b32 a148, v244
    v_mfma_f32_32x32x16_bf16 v[96:111], a[252:255], v[196:199], v[96:111]
    ds_read_b64_tr_b16 a[232:233], v16 offset:24576
    ds_read_b64_tr_b16 a[234:235], v16 offset:26624
    v_accvgpr_write_b32 a149, v245
    v_accvgpr_write_b32 a150, v246
    s_waitcnt lgkmcnt(6)
    v_mfma_f32_32x32x16_bf16 v[112:127], a[216:219], v[196:199], v[112:127]
    ds_read_b64_tr_b16 a[236:237], v17 offset:24576
    ds_read_b64_tr_b16 a[238:239], v17 offset:26624
    v_accvgpr_write_b32 a151, v247
    v_accvgpr_write_b32 a152, v248
    v_accvgpr_write_b32 a153, v249
    v_mfma_f32_32x32x16_bf16 v[80:95], a[220:223], v[196:199], v[80:95]
    ds_read_b64_tr_b16 a[240:241], v14 offset:28672
    ds_read_b64_tr_b16 a[242:243], v14 offset:30720
    v_accvgpr_write_b32 a154, v250
    v_accvgpr_write_b32 a155, v251
    s_waitcnt lgkmcnt(6)
    v_mfma_f32_32x32x16_bf16 v[64:79], a[224:227], v[200:203], v[64:79]
    ds_read_b64_tr_b16 a[244:245], v15 offset:28672
    ds_read_b64_tr_b16 a[246:247], v15 offset:30720
    v_accvgpr_write_b32 a156, v252
    v_accvgpr_write_b32 a157, v253
    v_accvgpr_write_b32 a158, v254
    v_mfma_f32_32x32x16_bf16 v[96:111], a[228:231], v[200:203], v[96:111]
    ds_read_b64_tr_b16 a[248:249], v16 offset:28672
    ds_read_b64_tr_b16 a[250:251], v16 offset:30720
    v_accvgpr_write_b32 a159, v255
    s_waitcnt lgkmcnt(6)
    v_mfma_f32_32x32x16_bf16 v[112:127], a[232:235], v[200:203], v[112:127]
    ds_read_b64_tr_b16 a[252:253], v17 offset:28672
    ds_read_b64_tr_b16 a[254:255], v17 offset:30720
    v_mfma_f32_32x32x16_bf16 v[80:95], a[236:239], v[200:203], v[80:95]
    s_barrier
    ds_read_b64_tr_b16 a[216:217], v14 offset:32768
    ds_read_b64_tr_b16 a[218:219], v14 offset:34816
    s_waitcnt lgkmcnt(6)
    v_mfma_f32_32x32x16_bf16 v[64:79], a[240:243], v[204:207], v[64:79]
    ds_read_b64_tr_b16 a[220:221], v15 offset:32768
    ds_read_b64_tr_b16 a[222:223], v15 offset:34816
    v_mfma_f32_32x32x16_bf16 v[96:111], a[244:247], v[204:207], v[96:111]
    ds_read_b64_tr_b16 a[224:225], v16 offset:32768
    ds_read_b64_tr_b16 a[226:227], v16 offset:34816
    s_waitcnt lgkmcnt(6)
    v_mfma_f32_32x32x16_bf16 v[112:127], a[248:251], v[204:207], v[112:127]
    ds_read_b64_tr_b16 a[228:229], v17 offset:32768
    ds_read_b64_tr_b16 a[230:231], v17 offset:34816
    v_mfma_f32_32x32x16_bf16 v[80:95], a[252:255], v[204:207], v[80:95]
    ds_read_b64_tr_b16 a[232:233], v14 offset:36864
    ds_read_b64_tr_b16 a[234:235], v14 offset:38912
    s_waitcnt lgkmcnt(6)
    v_mfma_f32_32x32x16_bf16 v[64:79], a[216:219], v[208:211], v[64:79]
    ds_read_b64_tr_b16 a[236:237], v15 offset:36864
    ds_read_b64_tr_b16 a[238:239], v15 offset:38912
    v_mfma_f32_32x32x16_bf16 v[96:111], a[220:223], v[208:211], v[96:111]
    ds_read_b64_tr_b16 a[240:241], v16 offset:36864
    ds_read_b64_tr_b16 a[242:243], v16 offset:38912
    s_waitcnt lgkmcnt(6)
    v_mfma_f32_32x32x16_bf16 v[112:127], a[224:227], v[208:211], v[112:127]
    ds_read_b64_tr_b16 a[244:245], v17 offset:36864
    ds_read_b64_tr_b16 a[246:247], v17 offset:38912
    v_mfma_f32_32x32x16_bf16 v[80:95], a[228:231], v[208:211], v[80:95]
    ds_read_b64_tr_b16 a[248:249], v14 offset:40960
    ds_read_b64_tr_b16 a[250:251], v14 offset:43008
    s_waitcnt lgkmcnt(6)
    v_mfma_f32_32x32x16_bf16 v[64:79], a[232:235], v[212:215], v[64:79]
    ds_read_b64_tr_b16 a[252:253], v15 offset:40960
    ds_read_b64_tr_b16 a[254:255], v15 offset:43008
    v_mfma_f32_32x32x16_bf16 v[96:111], a[236:239], v[212:215], v[96:111]
    ds_read_b64_tr_b16 a[216:217], v16 offset:40960
    ds_read_b64_tr_b16 a[218:219], v16 offset:43008
    s_waitcnt lgkmcnt(6)
    v_mfma_f32_32x32x16_bf16 v[112:127], a[240:243], v[212:215], v[112:127]
    ds_read_b64_tr_b16 a[220:221], v17 offset:40960
    ds_read_b64_tr_b16 a[222:223], v17 offset:43008
    v_mfma_f32_32x32x16_bf16 v[80:95], a[244:247], v[212:215], v[80:95]
    ds_read_b64_tr_b16 a[224:225], v14 offset:45056
    ds_read_b64_tr_b16 a[226:227], v14 offset:47104
    s_waitcnt lgkmcnt(6)
    v_mfma_f32_32x32x16_bf16 v[64:79], a[248:251], v[216:219], v[64:79]
    ds_read_b64_tr_b16 a[228:229], v15 offset:45056
    ds_read_b64_tr_b16 a[230:231], v15 offset:47104
    v_mfma_f32_32x32x16_bf16 v[96:111], a[252:255], v[216:219], v[96:111]
    ds_read_b64_tr_b16 a[232:233], v16 offset:45056
    ds_read_b64_tr_b16 a[234:235], v16 offset:47104
    s_waitcnt lgkmcnt(6)
    v_mfma_f32_32x32x16_bf16 v[112:127], a[216:219], v[216:219], v[112:127]
    ds_read_b64_tr_b16 a[236:237], v17 offset:45056
    ds_read_b64_tr_b16 a[238:239], v17 offset:47104
    v_mfma_f32_32x32x16_bf16 v[80:95], a[220:223], v[216:219], v[80:95]
    s_barrier
    ds_read_b64_tr_b16 a[240:241], v14 offset:49152
    ds_read_b64_tr_b16 a[242:243], v14 offset:51200
    s_waitcnt lgkmcnt(6)
    v_mfma_f32_32x32x16_bf16 v[64:79], a[224:227], v[220:223], v[64:79]
    ds_read_b64_tr_b16 a[244:245], v15 offset:49152
    ds_read_b64_tr_b16 a[246:247], v15 offset:51200
    v_mfma_f32_32x32x16_bf16 v[96:111], a[228:231], v[220:223], v[96:111]
    ds_read_b64_tr_b16 a[248:249], v16 offset:49152
    ds_read_b64_tr_b16 a[250:251], v16 offset:51200
    s_waitcnt lgkmcnt(6)
    v_mfma_f32_32x32x16_bf16 v[112:127], a[232:235], v[220:223], v[112:127]
    ds_read_b64_tr_b16 a[252:253], v17 offset:49152
    ds_read_b64_tr_b16 a[254:255], v17 offset:51200
    v_mfma_f32_32x32x16_bf16 v[80:95], a[236:239], v[220:223], v[80:95]
    ds_read_b64_tr_b16 a[216:217], v14 offset:53248
    ds_read_b64_tr_b16 a[218:219], v14 offset:55296
    s_waitcnt lgkmcnt(6)
    v_mfma_f32_32x32x16_bf16 v[64:79], a[240:243], v[224:227], v[64:79]
    ds_read_b64_tr_b16 a[220:221], v15 offset:53248
    ds_read_b64_tr_b16 a[222:223], v15 offset:55296
    v_mfma_f32_32x32x16_bf16 v[96:111], a[244:247], v[224:227], v[96:111]
    ds_read_b64_tr_b16 a[224:225], v16 offset:53248
    ds_read_b64_tr_b16 a[226:227], v16 offset:55296
    s_waitcnt lgkmcnt(6)
    v_mfma_f32_32x32x16_bf16 v[112:127], a[248:251], v[224:227], v[112:127]
    ds_read_b64_tr_b16 a[228:229], v17 offset:53248
    ds_read_b64_tr_b16 a[230:231], v17 offset:55296
    s_waitcnt vmcnt(0)
    v_cmp_ne_u32 vcc, s28, v1
    s_nop 1
    s_or_b32 s29, vcc_lo, vcc_hi
    v_mfma_f32_32x32x16_bf16 v[80:95], a[252:255], v[224:227], v[80:95]
    ds_read_b64_tr_b16 a[232:233], v14 offset:57344
    ds_read_b64_tr_b16 a[234:235], v14 offset:59392
    s_waitcnt lgkmcnt(6)
    v_mfma_f32_32x32x16_bf16 v[64:79], a[216:219], v[228:231], v[64:79]
    ds_read_b64_tr_b16 a[236:237], v15 offset:57344
    ds_read_b64_tr_b16 a[238:239], v15 offset:59392
    v_mfma_f32_32x32x16_bf16 v[96:111], a[220:223], v[228:231], v[96:111]
    ds_read_b64_tr_b16 a[240:241], v16 offset:57344
    ds_read_b64_tr_b16 a[242:243], v16 offset:59392
    s_waitcnt lgkmcnt(6)
    v_mfma_f32_32x32x16_bf16 v[112:127], a[224:227], v[228:231], v[112:127]
    ds_read_b64_tr_b16 a[244:245], v17 offset:57344
    ds_read_b64_tr_b16 a[246:247], v17 offset:59392
    v_mfma_f32_32x32x16_bf16 v[80:95], a[228:231], v[228:231], v[80:95]
    ds_read_b64_tr_b16 a[248:249], v14 offset:61440
    ds_read_b64_tr_b16 a[250:251], v14 offset:63488
    s_waitcnt lgkmcnt(6)
    v_mfma_f32_32x32x16_bf16 v[64:79], a[232:235], v[232:235], v[64:79]
    ds_read_b64_tr_b16 a[252:253], v15 offset:61440
    ds_read_b64_tr_b16 a[254:255], v15 offset:63488
    v_mfma_f32_32x32x16_bf16 v[96:111], a[236:239], v[232:235], v[96:111]
    ds_read_b64_tr_b16 a[216:217], v16 offset:61440
    ds_read_b64_tr_b16 a[218:219], v16 offset:63488
    v_add_u32 v14, 0x10000, v14
    s_waitcnt lgkmcnt(6)
    v_mfma_f32_32x32x16_bf16 v[112:127], a[240:243], v[232:235], v[112:127]
    ds_read_b64_tr_b16 a[220:221], v17 offset:61440
    ds_read_b64_tr_b16 a[222:223], v17 offset:63488
    v_mfma_f32_32x32x16_bf16 v[80:95], a[244:247], v[232:235], v[80:95]
    s_barrier
    ds_read_b64_tr_b16 a[224:225], v14 offset:0
    ds_read_b64_tr_b16 a[226:227], v14 offset:2048
    s_waitcnt lgkmcnt(6)
    v_mfma_f32_32x32x16_bf16 v[64:79], a[248:251], v[236:239], v[64:79]
    ds_read_b64_tr_b16 a[228:229], v14 offset:4096
    ds_read_b64_tr_b16 a[230:231], v14 offset:6144
    v_mfma_f32_32x32x16_bf16 v[96:111], a[252:255], v[236:239], v[96:111]
    ds_read_b64_tr_b16 a[232:233], v14 offset:8192
    ds_read_b64_tr_b16 a[234:235], v14 offset:10240
    v_add_u32 v15, 0x10000, v15
    s_waitcnt lgkmcnt(6)
    v_mfma_f32_32x32x16_bf16 v[112:127], a[216:219], v[236:239], v[112:127]
    ds_read_b64_tr_b16 a[236:237], v14 offset:12288
    ds_read_b64_tr_b16 a[238:239], v14 offset:14336
    v_mfma_f32_32x32x16_bf16 v[80:95], a[220:223], v[236:239], v[80:95]
    ds_read_b64_tr_b16 a[240:241], v15 offset:0
    ds_read_b64_tr_b16 a[242:243], v15 offset:2048
    s_waitcnt lgkmcnt(6)
    v_mfma_f32_32x32x16_bf16 v[64:79], a[224:227], v[240:243], v[64:79]
    ds_read_b64_tr_b16 a[244:245], v15 offset:4096
    ds_read_b64_tr_b16 a[246:247], v15 offset:6144
    v_add_u32 v16, 0x10000, v16
    v_mfma_f32_32x32x16_bf16 v[64:79], a[228:231], v[244:247], v[64:79]
    ds_read_b64_tr_b16 a[248:249], v15 offset:8192
    ds_read_b64_tr_b16 a[250:251], v15 offset:10240
    s_waitcnt lgkmcnt(6)
    v_mfma_f32_32x32x16_bf16 v[64:79], a[232:235], v[248:251], v[64:79]
    ds_read_b64_tr_b16 a[252:253], v15 offset:12288
    ds_read_b64_tr_b16 a[254:255], v15 offset:14336
    v_mfma_f32_32x32x16_bf16 v[64:79], a[236:239], v[252:255], v[64:79]
    ds_read_b64_tr_b16 a[216:217], v16 offset:0
    ds_read_b64_tr_b16 a[218:219], v16 offset:2048
    s_waitcnt lgkmcnt(6)
    v_mfma_f32_32x32x16_bf16 v[96:111], a[240:243], v[240:243], v[96:111]
    ds_read_b64_tr_b16 a[220:221], v16 offset:4096
    ds_read_b64_tr_b16 a[222:223], v16 offset:6144
    v_add_u32 v17, 0x10000, v17
    v_mfma_f32_32x32x16_bf16 v[96:111], a[244:247], v[244:247], v[96:111]
    ds_read_b64_tr_b16 a[224:225], v16 offset:8192
    ds_read_b64_tr_b16 a[226:227], v16 offset:10240
    s_waitcnt lgkmcnt(6)
    v_mfma_f32_32x32x16_bf16 v[96:111], a[248:251], v[248:251], v[96:111]
    ds_read_b64_tr_b16 a[228:229], v16 offset:12288
    ds_read_b64_tr_b16 a[230:231], v16 offset:14336
    v_mfma_f32_32x32x16_bf16 v[96:111], a[252:255], v[252:255], v[96:111]
    ds_read_b64_tr_b16 a[232:233], v17 offset:0
    ds_read_b64_tr_b16 a[234:235], v17 offset:2048
    v_cvt_pk_bf16_f32 v32, v64, v65
    v_cvt_pk_bf16_f32 v33, v66, v67
    v_cvt_pk_bf16_f32 v34, v68, v69
    s_waitcnt lgkmcnt(6)
    v_mfma_f32_32x32x16_bf16 v[112:127], a[216:219], v[240:243], v[112:127]
    ds_read_b64_tr_b16 a[236:237], v17 offset:4096
    ds_read_b64_tr_b16 a[238:239], v17 offset:6144
    v_cvt_pk_bf16_f32 v35, v70, v71
    buffer_store_dwordx4 v[32:35], v29, s[36:39], s64 offen offset:1024
    v_mfma_f32_32x32x16_bf16 v[112:127], a[220:223], v[244:247], v[112:127]
    ds_read_b64_tr_b16 a[240:241], v17 offset:8192
    ds_read_b64_tr_b16 a[242:243], v17 offset:10240
    v_cvt_pk_bf16_f32 v36, v72, v73
    v_cvt_pk_bf16_f32 v37, v74, v75
    v_cvt_pk_bf16_f32 v38, v76, v77
    s_waitcnt lgkmcnt(6)
    v_mfma_f32_32x32x16_bf16 v[112:127], a[224:227], v[248:251], v[112:127]
    ds_read_b64_tr_b16 a[244:245], v17 offset:12288
    ds_read_b64_tr_b16 a[246:247], v17 offset:14336
    v_cvt_pk_bf16_f32 v39, v78, v79
    v_cvt_pk_bf16_f32 v40, v96, v97
    v_cvt_pk_bf16_f32 v41, v98, v99
    v_cvt_pk_bf16_f32 v42, v100, v101
    v_mfma_f32_32x32x16_bf16 v[112:127], a[228:231], v[252:255], v[112:127]
    s_barrier
    ds_read_b64_tr_b16 a[248:249], v14 offset:16384
    ds_read_b64_tr_b16 a[250:251], v14 offset:18432
    v_cvt_pk_bf16_f32 v43, v102, v103
    v_cvt_pk_bf16_f32 v44, v104, v105
    s_waitcnt lgkmcnt(6)
    v_mfma_f32_32x32x16_bf16 v[80:95], a[232:235], v[240:243], v[80:95]
    ds_read_b64_tr_b16 a[252:253], v15 offset:16384
    ds_read_b64_tr_b16 a[254:255], v15 offset:18432
    buffer_store_dwordx4 v[36:39], v29, s[36:39], s64 offen offset:2048
    v_cvt_pk_bf16_f32 v45, v106, v107
    v_mfma_f32_32x32x16_bf16 v[80:95], a[236:239], v[244:247], v[80:95]
    ds_read_b64_tr_b16 a[216:217], v16 offset:16384
    ds_read_b64_tr_b16 a[218:219], v16 offset:18432
    v_cvt_pk_bf16_f32 v46, v108, v109
    v_cvt_pk_bf16_f32 v47, v110, v111
    v_cvt_pk_bf16_f32 v48, v112, v113
    s_waitcnt lgkmcnt(6)
    v_mfma_f32_32x32x16_bf16 v[80:95], a[240:243], v[248:251], v[80:95]
    ds_read_b64_tr_b16 a[220:221], v17 offset:16384
    ds_read_b64_tr_b16 a[222:223], v17 offset:18432
    v_cvt_pk_bf16_f32 v49, v114, v115
    v_cvt_pk_bf16_f32 v50, v116, v117
    v_cvt_pk_bf16_f32 v51, v118, v119
    v_cvt_pk_bf16_f32 v52, v120, v121
    v_mfma_f32_32x32x16_bf16 v[80:95], a[244:247], v[252:255], v[80:95]
    ds_read_b64_tr_b16 a[224:225], v14 offset:20480
    ds_read_b64_tr_b16 a[226:227], v14 offset:22528
    v_cvt_pk_bf16_f32 v53, v122, v123
    v_cvt_pk_bf16_f32 v54, v124, v125
    v_cvt_pk_bf16_f32 v55, v126, v127
    s_waitcnt lgkmcnt(6)
    v_mfma_f32_32x32x16_bf16 v[192:207], a[248:251], v[128:131], 0
    ds_read_b64_tr_b16 a[228:229], v15 offset:20480
    ds_read_b64_tr_b16 a[230:231], v15 offset:22528
    buffer_store_dwordx4 v[40:43], v29, s[36:39], s64 offen offset:3072
    v_mfma_f32_32x32x16_bf16 v[208:223], a[252:255], v[128:131], 0
    ds_read_b64_tr_b16 a[232:233], v16 offset:20480
    ds_read_b64_tr_b16 a[234:235], v16 offset:22528
    v_cvt_pk_bf16_f32 v56, v80, v81
    v_cvt_pk_bf16_f32 v57, v82, v83
    v_cvt_pk_bf16_f32 v58, v84, v85
    s_waitcnt lgkmcnt(6)
    v_mfma_f32_32x32x16_bf16 v[224:239], a[216:219], v[128:131], 0
    ds_read_b64_tr_b16 a[236:237], v17 offset:20480
    ds_read_b64_tr_b16 a[238:239], v17 offset:22528
    v_cvt_pk_bf16_f32 v59, v86, v87
    v_cvt_pk_bf16_f32 v60, v88, v89
    v_cvt_pk_bf16_f32 v61, v90, v91
    v_cvt_pk_bf16_f32 v62, v92, v93
    v_mfma_f32_32x32x16_bf16 v[240:255], a[220:223], v[128:131], 0
    ds_read_b64_tr_b16 a[240:241], v14 offset:24576
    ds_read_b64_tr_b16 a[242:243], v14 offset:26624
    v_cvt_pk_bf16_f32 v63, v94, v95
    s_waitcnt lgkmcnt(6)
    v_mfma_f32_32x32x16_bf16 v[192:207], a[224:227], v[132:135], v[192:207]
    ds_read_b64_tr_b16 a[244:245], v15 offset:24576
    ds_read_b64_tr_b16 a[246:247], v15 offset:26624
    buffer_store_dwordx4 v[44:47], v29, s[36:39], s56 offen offset:0
    v_mfma_f32_32x32x16_bf16 v[208:223], a[228:231], v[132:135], v[208:223]
    ds_read_b64_tr_b16 a[248:249], v16 offset:24576
    ds_read_b64_tr_b16 a[250:251], v16 offset:26624
    s_waitcnt lgkmcnt(6)
    v_mfma_f32_32x32x16_bf16 v[224:239], a[232:235], v[132:135], v[224:239]
    ds_read_b64_tr_b16 a[252:253], v17 offset:24576
    ds_read_b64_tr_b16 a[254:255], v17 offset:26624
    v_mfma_f32_32x32x16_bf16 v[240:255], a[236:239], v[132:135], v[240:255]
    ds_read_b64_tr_b16 a[216:217], v14 offset:28672
    ds_read_b64_tr_b16 a[218:219], v14 offset:30720
    s_waitcnt lgkmcnt(6)
    v_mfma_f32_32x32x16_bf16 v[192:207], a[240:243], v[136:139], v[192:207]
    ds_read_b64_tr_b16 a[220:221], v15 offset:28672
    ds_read_b64_tr_b16 a[222:223], v15 offset:30720
    buffer_store_dwordx4 v[48:51], v29, s[36:39], s56 offen offset:1024
    v_mfma_f32_32x32x16_bf16 v[208:223], a[244:247], v[136:139], v[208:223]
    ds_read_b64_tr_b16 a[224:225], v16 offset:28672
    ds_read_b64_tr_b16 a[226:227], v16 offset:30720
    s_waitcnt lgkmcnt(6)
    v_mfma_f32_32x32x16_bf16 v[224:239], a[248:251], v[136:139], v[224:239]
    ds_read_b64_tr_b16 a[228:229], v17 offset:28672
    ds_read_b64_tr_b16 a[230:231], v17 offset:30720
    v_mfma_f32_32x32x16_bf16 v[240:255], a[252:255], v[136:139], v[240:255]
    s_barrier
    ds_read_b64_tr_b16 a[232:233], v14 offset:32768
    ds_read_b64_tr_b16 a[234:235], v14 offset:34816
    s_waitcnt lgkmcnt(6)
    v_mfma_f32_32x32x16_bf16 v[192:207], a[216:219], v[140:143], v[192:207]
    ds_read_b64_tr_b16 a[236:237], v15 offset:32768
    ds_read_b64_tr_b16 a[238:239], v15 offset:34816
    buffer_store_dwordx4 v[52:55], v29, s[36:39], s56 offen offset:2048
    v_mfma_f32_32x32x16_bf16 v[208:223], a[220:223], v[140:143], v[208:223]
    ds_read_b64_tr_b16 a[240:241], v16 offset:32768
    ds_read_b64_tr_b16 a[242:243], v16 offset:34816
    s_waitcnt lgkmcnt(6)
    v_mfma_f32_32x32x16_bf16 v[224:239], a[224:227], v[140:143], v[224:239]
    ds_read_b64_tr_b16 a[244:245], v17 offset:32768
    ds_read_b64_tr_b16 a[246:247], v17 offset:34816
    v_mfma_f32_32x32x16_bf16 v[240:255], a[228:231], v[140:143], v[240:255]
    ds_read_b64_tr_b16 a[248:249], v14 offset:36864
C_pad6:
    s_cbranch_execz L_ret1
    ds_read_b64_tr_b16 a[250:251], v14 offset:38912
    s_waitcnt lgkmcnt(6)
    v_mfma_f32_32x32x16_bf16 v[192:207], a[232:235], v[144:147], v[192:207]
    ds_read_b64_tr_b16 a[252:253], v15 offset:36864
    ds_read_b64_tr_b16 a[254:255], v15 offset:38912
    buffer_store_dwordx4 v[56:59], v29, s[36:39], s56 offen offset:3072
    v_mfma_f32_32x32x16_bf16 v[208:223], a[236:239], v[144:147], v[208:223]
    ds_read_b64_tr_b16 a[216:217], v16 offset:36864
    ds_read_b64_tr_b16 a[218:219], v16 offset:38912
    s_waitcnt lgkmcnt(6)
    v_mfma_f32_32x32x16_bf16 v[224:239], a[240:243], v[144:147], v[224:239]
    ds_read_b64_tr_b16 a[220:221], v17 offset:36864
    ds_read_b64_tr_b16 a[222:223], v17 offset:38912
    v_mfma_f32_32x32x16_bf16 v[240:255], a[244:247], v[144:147], v[240:255]
    ds_read_b64_tr_b16 a[224:225], v14 offset:40960
    ds_read_b64_tr_b16 a[226:227], v14 offset:43008
    s_waitcnt lgkmcnt(6)
    v_mfma_f32_32x32x16_bf16 v[192:207], a[248:251], v[148:151], v[192:207]
    ds_read_b64_tr_b16 a[228:229], v15 offset:40960
    ds_read_b64_tr_b16 a[230:231], v15 offset:43008
    buffer_store_dwordx4 v[60:63], v29, s[36:39], s60 offen offset:0
    v_mfma_f32_32x32x16_bf16 v[208:223], a[252:255], v[148:151], v[208:223]
    ds_read_b64_tr_b16 a[232:233], v16 offset:40960
    ds_read_b64_tr_b16 a[234:235], v16 offset:43008
    s_waitcnt lgkmcnt(6)
    v_mfma_f32_32x32x16_bf16 v[224:239], a[216:219], v[148:151], v[224:239]
    ds_read_b64_tr_b16 a[236:237], v17 offset:40960
    ds_read_b64_tr_b16 a[238:239], v17 offset:43008
    v_mfma_f32_32x32x16_bf16 v[240:255], a[220:223], v[148:151], v[240:255]
    ds_read_b64_tr_b16 a[240:241], v14 offset:45056
    ds_read_b64_tr_b16 a[242:243], v14 offset:47104
    s_waitcnt lgkmcnt(6)
    v_mfma_f32_32x32x16_bf16 v[192:207], a[224:227], v[152:155], v[192:207]
    ds_read_b64_tr_b16 a[244:245], v15 offset:45056
    ds_read_b64_tr_b16 a[246:247], v15 offset:47104
    v_mfma_f32_32x32x16_bf16 v[208:223], a[228:231], v[152:155], v[208:223]
    ds_read_b64_tr_b16 a[248:249], v16 offset:45056
    ds_read_b64_tr_b16 a[250:251], v16 offset:47104
    s_waitcnt lgkmcnt(6)
    v_mfma_f32_32x32x16_bf16 v[224:239], a[232:235], v[152:155], v[224:239]
    ds_read_b64_tr_b16 a[252:253], v17 offset:45056
    ds_read_b64_tr_b16 a[254:255], v17 offset:47104
    v_mfma_f32_32x32x16_bf16 v[240:255], a[236:239], v[152:155], v[240:255]
    s_barrier
    ds_read_b64_tr_b16 a[216:217], v14 offset:49152
    ds_read_b64_tr_b16 a[218:219], v14 offset:51200
    s_waitcnt lgkmcnt(6)
    v_mfma_f32_32x32x16_bf16 v[192:207], a[240:243], v[156:159], v[192:207]
    ds_read_b64_tr_b16 a[220:221], v15 offset:49152
    ds_read_b64_tr_b16 a[222:223], v15 offset:51200
    v_mfma_f32_32x32x16_bf16 v[208:223], a[244:247], v[156:159], v[208:223]
    ds_read_b64_tr_b16 a[224:225], v16 offset:49152
    ds_read_b64_tr_b16 a[226:227], v16 offset:51200
    s_waitcnt lgkmcnt(6)
    v_mfma_f32_32x32x16_bf16 v[224:239], a[248:251], v[156:159], v[224:239]
    ds_read_b64_tr_b16 a[228:229], v17 offset:49152
    ds_read_b64_tr_b16 a[230:231], v17 offset:51200
    v_mfma_f32_32x32x16_bf16 v[240:255], a[252:255], v[156:159], v[240:255]
    ds_read_b64_tr_b16 a[232:233], v14 offset:53248
    ds_read_b64_tr_b16 a[234:235], v14 offset:55296
    s_waitcnt lgkmcnt(6)
    v_mfma_f32_32x32x16_bf16 v[192:207], a[216:219], v[160:163], v[192:207]
    ds_read_b64_tr_b16 a[236:237], v15 offset:53248
    ds_read_b64_tr_b16 a[238:239], v15 offset:55296
    v_mfma_f32_32x32x16_bf16 v[208:223], a[220:223], v[160:163], v[208:223]
    ds_read_b64_tr_b16 a[240:241], v16 offset:53248
    ds_read_b64_tr_b16 a[242:243], v16 offset:55296
    s_waitcnt lgkmcnt(6)
    v_mfma_f32_32x32x16_bf16 v[224:239], a[224:227], v[160:163], v[224:239]
    ds_read_b64_tr_b16 a[244:245], v17 offset:53248
    ds_read_b64_tr_b16 a[246:247], v17 offset:55296
    v_mfma_f32_32x32x16_bf16 v[240:255], a[228:231], v[160:163], v[240:255]
    ds_read_b64_tr_b16 a[248:249], v14 offset:57344
    ds_read_b64_tr_b16 a[250:251], v14 offset:59392
    s_waitcnt lgkmcnt(6)
    v_mfma_f32_32x32x16_bf16 v[192:207], a[232:235], v[164:167], v[192:207]
    ds_read_b64_tr_b16 a[252:253], v15 offset:57344
    ds_read_b64_tr_b16 a[254:255], v15 offset:59392
    v_mfma_f32_32x32x16_bf16 v[208:223], a[236:239], v[164:167], v[208:223]
    ds_read_b64_tr_b16 a[216:217], v16 offset:57344
    ds_read_b64_tr_b16 a[218:219], v16 offset:59392
    s_waitcnt lgkmcnt(6)
    v_mfma_f32_32x32x16_bf16 v[224:239], a[240:243], v[164:167], v[224:239]
    ds_read_b64_tr_b16 a[220:221], v17 offset:57344
    ds_read_b64_tr_b16 a[222:223], v17 offset:59392
    v_mfma_f32_32x32x16_bf16 v[240:255], a[244:247], v[164:167], v[240:255]
    ds_read_b64_tr_b16 a[224:225], v14 offset:61440
    ds_read_b64_tr_b16 a[226:227], v14 offset:63488
    s_waitcnt lgkmcnt(6)
    v_mfma_f32_32x32x16_bf16 v[192:207], a[248:251], v[168:171], v[192:207]
    ds_read_b64_tr_b16 a[228:229], v15 offset:61440
    ds_read_b64_tr_b16 a[230:231], v15 offset:63488
    v_mfma_f32_32x32x16_bf16 v[208:223], a[252:255], v[168:171], v[208:223]
    ds_read_b64_tr_b16 a[232:233], v16 offset:61440
    ds_read_b64_tr_b16 a[234:235], v16 offset:63488
    v_add_u32 v14, 0x10000, v14
    s_waitcnt lgkmcnt(6)
    v_mfma_f32_32x32x16_bf16 v[224:239], a[216:219], v[168:171], v[224:239]
    ds_read_b64_tr_b16 a[236:237], v17 offset:61440
    ds_read_b64_tr_b16 a[238:239], v17 offset:63488
    v_add_u32 v15, 0x10000, v15
    v_mfma_f32_32x32x16_bf16 v[240:255], a[220:223], v[168:171], v[240:255]
    s_barrier
    ds_read_b64_tr_b16 a[240:241], v14 offset:0
    ds_read_b64_tr_b16 a[242:243], v14 offset:2048
    v_add_u32 v16, 0x10000, v16
    s_waitcnt lgkmcnt(6)
    v_mfma_f32_32x32x16_bf16 v[192:207], a[224:227], v[172:175], v[192:207]
    ds_read_b64_tr_b16 a[244:245], v15 offset:0
    ds_read_b64_tr_b16 a[246:247], v15 offset:2048
    v_add_u32 v17, 0x10000, v17
    v_mfma_f32_32x32x16_bf16 v[208:223], a[228:231], v[172:175], v[208:223]
    ds_read_b64_tr_b16 a[248:249], v16 offset:0
    ds_read_b64_tr_b16 a[250:251], v16 offset:2048
    s_waitcnt lgkmcnt(6)
    v_mfma_f32_32x32x16_bf16 v[224:239], a[232:235], v[172:175], v[224:239]
    ds_read_b64_tr_b16 a[252:253], v17 offset:0
    ds_read_b64_tr_b16 a[254:255], v17 offset:2048
    v_mfma_f32_32x32x16_bf16 v[240:255], a[236:239], v[172:175], v[240:255]
    ds_read_b64_tr_b16 a[216:217], v14 offset:4096
    ds_read_b64_tr_b16 a[218:219], v14 offset:6144
    s_waitcnt lgkmcnt(6)
    v_mfma_f32_32x32x16_bf16 v[192:207], a[240:243], v[176:179], v[192:207]
    ds_read_b64_tr_b16 a[220:221], v15 offset:4096
    ds_read_b64_tr_b16 a[222:223], v15 offset:6144
    v_mfma_f32_32x32x16_bf16 v[208:223], a[244:247], v[176:179], v[208:223]
    ds_read_b64_tr_b16 a[224:225], v16 offset:4096
    ds_read_b64_tr_b16 a[226:227], v16 offset:6144
    s_waitcnt lgkmcnt(6)
    v_mfma_f32_32x32x16_bf16 v[224:239], a[248:251], v[176:179], v[224:239]
    ds_read_b64_tr_b16 a[228:229], v17 offset:4096
    ds_read_b64_tr_b16 a[230:231], v17 offset:6144
    s_waitcnt vmcnt(0)
    v_mov_b32 v1, 1
    s_cmp_lg_u32 s29, 0
    s_mov_b64 exec, 1
    s_cbranch_scc1 C_gs1
    buffer_store_dword v1, v0, s[36:39], s50 offen
C_gb1:
    s_mov_b64 exec, -1
    v_mfma_f32_32x32x16_bf16 v[240:255], a[252:255], v[176:179], v[240:255]
    ds_read_b64_tr_b16 a[232:233], v14 offset:8192
    ds_read_b64_tr_b16 a[234:235], v14 offset:10240
    s_add_u32 s56, s66, 4096
    buffer_load_dword v1, v0, s[36:39], s70 offen sc1
    s_waitcnt lgkmcnt(6)
    v_mfma_f32_32x32x16_bf16 v[192:207], a[216:219], v[180:183], v[192:207]
    ds_read_b64_tr_b16 a[236:237], v15 offset:8192
    ds_read_b64_tr_b16 a[238:239], v15 offset:10240
    v_mfma_f32_32x32x16_bf16 v[208:223], a[220:223], v[180:183], v[208:223]
    ds_read_b64_tr_b16 a[240:241], v16 offset:8192
    ds_read_b64_tr_b16 a[242:243], v16 offset:10240
    s_waitcnt lgkmcnt(6)
    v_mfma_f32_32x32x16_bf16 v[224:239], a[224:227], v[180:183], v[224:239]
    ds_read_b64_tr_b16 a[244:245], v17 offset:8192
    ds_read_b64_tr_b16 a[246:247], v17 offset:10240
    v_mfma_f32_32x32x16_bf16 v[240:255], a[228:231], v[180:183], v[240:255]
    ds_read_b64_tr_b16 a[248:249], v14 offset:12288
    ds_read_b64_tr_b16 a[250:251], v14 offset:14336
    s_waitcnt lgkmcnt(6)
    v_mfma_f32_32x32x16_bf16 v[192:207], a[232:235], v[184:187], v[192:207]
    ds_read_b64_tr_b16 a[252:253], v15 offset:12288
    ds_read_b64_tr_b16 a[254:255], v15 offset:14336
    v_mfma_f32_32x32x16_bf16 v[208:223], a[236:239], v[184:187], v[208:223]
    ds_read_b64_tr_b16 a[216:217], v16 offset:12288
    ds_read_b64_tr_b16 a[218:219], v16 offset:14336
    s_waitcnt lgkmcnt(6)
    v_mfma_f32_32x32x16_bf16 v[224:239], a[240:243], v[184:187], v[224:239]
    ds_read_b64_tr_b16 a[220:221], v17 offset:12288
    ds_read_b64_tr_b16 a[222:223], v17 offset:14336
    v_mfma_f32_32x32x16_bf16 v[240:255], a[244:247], v[184:187], v[240:255]
    s_barrier
    ds_read_b64_tr_b16 a[224:225], v14 offset:16384
    ds_read_b64_tr_b16 a[226:227], v14 offset:18432
    s_waitcnt lgkmcnt(6)
    v_mfma_f32_32x32x16_bf16 v[192:207], a[248:251], v[188:191], v[192:207]
    ds_read_b64_tr_b16 a[228:229], v15 offset:16384
    ds_read_b64_tr_b16 a[230:231], v15 offset:18432
    v_mfma_f32_32x32x16_bf16 v[208:223], a[252:255], v[188:191], v[208:223]
    ds_read_b64_tr_b16 a[232:233], v16 offset:16384
    ds_read_b64_tr_b16 a[234:235], v16 offset:18432
    s_waitcnt lgkmcnt(6)
    v_mfma_f32_32x32x16_bf16 v[224:239], a[216:219], v[188:191], v[224:239]
    ds_read_b64_tr_b16 a[236:237], v17 offset:16384
    ds_read_b64_tr_b16 a[238:239], v17 offset:18432
C_slx1:
    s_waitcnt vmcnt(0)
    v_cmp_gt_u32 vcc, 1, v1
    s_sub_u32 s73, s73, 1
    s_cbranch_vccz C_sbx1
    buffer_load_dword v1, v0, s[36:39], s70 offen sc1
    s_cbranch_scc0 C_slx1
    s_mov_b32 s73, 16
C_sbx1:
    s_cmp_lg_u32 s29, 0
    s_cbranch_scc1 C_asx1
C_abx1:
    v_mfma_f32_32x32x16_bf16 v[240:255], a[220:223], v[188:191], v[240:255]
    ds_read_b64_tr_b16 a[240:241], v14 offset:20480
    ds_read_b64_tr_b16 a[242:243], v14 offset:22528
    buffer_load_dwordx2 v[22:23], v7, s[36:39], s65 offen nt
    s_waitcnt lgkmcnt(6)
    v_mfma_f32_32x32x16_bf16 v[192:207], a[224:227], a[96:99], v[192:207]
    ds_read_b64_tr_b16 a[244:245], v15 offset:20480
    ds_read_b64_tr_b16 a[246:247], v15 offset:22528
    buffer_load_dwordx4 v[32:35], v29, s[36:39], s65 offen offset:1024 nt
    v_mfma_f32_32x32x16_bf16 v[208:223], a[228:231], a[96:99], v[208:223]
    ds_read_b64_tr_b16 a[248:249], v16 offset:20480
    ds_read_b64_tr_b16 a[250:251], v16 offset:22528
    buffer_load_dwordx4 v[36:39], v29, s[36:39], s65 offen offset:2048 nt
    s_waitcnt lgkmcnt(6)
    v_mfma_f32_32x32x16_bf16 v[224:239], a[232:235], a[96:99], v[224:239]
    ds_read_b64_tr_b16 a[252:253], v17 offset:20480
    ds_read_b64_tr_b16 a[254:255], v17 offset:22528
    buffer_load_dwordx4 v[40:43], v29, s[36:39], s65 offen offset:3072 nt
    v_mfma_f32_32x32x16_bf16 v[240:255], a[236:239], a[96:99], v[240:255]
    ds_read_b64_tr_b16 a[216:217], v14 offset:24576
    ds_read_b64_tr_b16 a[218:219], v14 offset:26624
    buffer_load_dwordx4 v[44:47], v29, s[36:39], s61 offen offset:0 nt
    s_waitcnt lgkmcnt(6)
    v_mfma_f32_32x32x16_bf16 v[192:207], a[240:243], a[100:103], v[192:207]
    ds_read_b64_tr_b16 a[220:221], v15 offset:24576
    ds_read_b64_tr_b16 a[222:223], v15 offset:26624
    buffer_load_dwordx4 v[48:51], v29, s[36:39], s61 offen offset:1024 nt
    v_mfma_f32_32x32x16_bf16 v[208:223], a[244:247], a[100:103], v[208:223]
    ds_read_b64_tr_b16 a[224:225], v16 offset:24576
    ds_read_b64_tr_b16 a[226:227], v16 offset:26624
    buffer_load_dwordx4 v[52:55], v29, s[36:39], s61 offen offset:2048 nt
    s_waitcnt lgkmcnt(6)
    v_mfma_f32_32x32x16_bf16 v[224:239], a[248:251], a[100:103], v[224:239]
    ds_read_b64_tr_b16 a[228:229], v17 offset:24576
    ds_read_b64_tr_b16 a[230:231], v17 offset:26624
    buffer_load_dwordx4 v[56:59], v29, s[36:39], s61 offen offset:3072 nt
    v_mfma_f32_32x32x16_bf16 v[240:255], a[252:255], a[100:103], v[240:255]
    ds_read_b64_tr_b16 a[232:233], v14 offset:28672
    ds_read_b64_tr_b16 a[234:235], v14 offset:30720
    buffer_load_dwordx4 v[60:63], v29, s[36:39], s62 offen offset:0 nt
    s_waitcnt lgkmcnt(6)
    v_mfma_f32_32x32x16_bf16 v[192:207], a[216:219], a[104:107], v[192:207]
    ds_read_b64_tr_b16 a[236:237], v15 offset:28672
    ds_read_b64_tr_b16 a[238:239], v15 offset:30720
    v_mfma_f32_32x32x16_bf16 v[208:223], a[220:223], a[104:107], v[208:223]
    ds_read_b64_tr_b16 a[240:241], v16 offset:28672
    ds_read_b64_tr_b16 a[242:243], v16 offset:30720
    v_add_u32 v14, 0xfffe0000, v14
    s_waitcnt lgkmcnt(6)
    v_mfma_f32_32x32x16_bf16 v[224:239], a[224:227], a[104:107], v[224:239]
    ds_read_b64_tr_b16 a[244:245], v17 offset:28672
    ds_read_b64_tr_b16 a[246:247], v17 offset:30720
    v_add_u32 v15, 0xfffe0000, v15
    v_mfma_f32_32x32x16_bf16 v[240:255], a[228:231], a[104:107], v[240:255]
    s_barrier
    ds_read_b64_tr_b16 a[248:249], v14 offset:0
    ds_read_b64_tr_b16 a[250:251], v14 offset:2048
    v_add_u32 v16, 0xfffe0000, v16
    s_waitcnt lgkmcnt(6)
    v_mfma_f32_32x32x16_bf16 v[192:207], a[232:235], a[108:111], v[192:207]
    ds_read_b64_tr_b16 a[252:253], v15 offset:0
    ds_read_b64_tr_b16 a[254:255], v15 offset:2048
    v_add_u32 v17, 0xfffe0000, v17
    v_mfma_f32_32x32x16_bf16 v[208:223], a[236:239], a[108:111], v[208:223]
    ds_read_b64_tr_b16 a[216:217], v16 offset:0
    ds_read_b64_tr_b16 a[218:219], v16 offset:2048
    s_waitcnt lgkmcnt(6)
    v_mfma_f32_32x32x16_bf16 v[224:239], a[240:243], a[108:111], v[224:239]
    ds_read_b64_tr_b16 a[220:221], v17 offset:0
    ds_read_b64_tr_b16 a[222:223], v17 offset:2048
    v_mfma_f32_32x32x16_bf16 v[240:255], a[244:247], a[108:111], v[240:255]
    ds_read_b64_tr_b16 a[224:225], v14 offset:4096
    ds_read_b64_tr_b16 a[226:227], v14 offset:6144
    s_waitcnt lgkmcnt(6)
    v_mfma_f32_32x32x16_bf16 v[192:207], a[248:251], a[112:115], v[192:207]
    ds_read_b64_tr_b16 a[228:229], v15 offset:4096
    ds_read_b64_tr_b16 a[230:231], v15 offset:6144
    v_mfma_f32_32x32x16_bf16 v[208:223], a[252:255], a[112:115], v[208:223]
    ds_read_b64_tr_b16 a[232:233], v16 offset:4096
    ds_read_b64_tr_b16 a[234:235], v16 offset:6144
    s_waitcnt lgkmcnt(6)
    v_mfma_f32_32x32x16_bf16 v[224:239], a[216:219], a[112:115], v[224:239]
    ds_read_b64_tr_b16 a[236:237], v17 offset:4096
    ds_read_b64_tr_b16 a[238:239], v17 offset:6144
    v_mfma_f32_32x32x16_bf16 v[240:255], a[220:223], a[112:115], v[240:255]
    ds_read_b64_tr_b16 a[240:241], v14 offset:8192
    ds_read_b64_tr_b16 a[242:243], v14 offset:10240
    s_waitcnt lgkmcnt(6)
    v_mfma_f32_32x32x16_bf16 v[192:207], a[224:227], a[116:119], v[192:207]
    ds_read_b64_tr_b16 a[244:245], v15 offset:8192
    ds_read_b64_tr_b16 a[246:247], v15 offset:10240
    v_mfma_f32_32x32x16_bf16 v[208:223], a[228:231], a[116:119], v[208:223]
    ds_read_b64_tr_b16 a[248:249], v16 offset:8192
    ds_read_b64_tr_b16 a[250:251], v16 offset:10240
    s_waitcnt lgkmcnt(6)
    v_mfma_f32_32x32x16_bf16 v[224:239], a[232:235], a[116:119], v[224:239]
    ds_read_b64_tr_b16 a[252:253], v17 offset:8192
    ds_read_b64_tr_b16 a[254:255], v17 offset:10240
    v_mfma_f32_32x32x16_bf16 v[240:255], a[236:239], a[116:119], v[240:255]
    ds_read_b64_tr_b16 a[216:217], v14 offset:12288
    ds_read_b64_tr_b16 a[218:219], v14 offset:14336
    s_waitcnt lgkmcnt(6)
    v_mfma_f32_32x32x16_bf16 v[192:207], a[240:243], a[120:123], v[192:207]
    ds_read_b64_tr_b16 a[220:221], v15 offset:12288
    ds_read_b64_tr_b16 a[222:223], v15 offset:14336
    v_mfma_f32_32x32x16_bf16 v[208:223], a[244:247], a[120:123], v[208:223]
    ds_read_b64_tr_b16 a[224:225], v16 offset:12288
    ds_read_b64_tr_b16 a[226:227], v16 offset:14336
    s_waitcnt lgkmcnt(6)
    v_mfma_f32_32x32x16_bf16 v[224:239], a[248:251], a[120:123], v[224:239]
    ds_read_b64_tr_b16 a[228:229], v17 offset:12288
    ds_read_b64_tr_b16 a[230:231], v17 offset:14336
    v_mfma_f32_32x32x16_bf16 v[240:255], a[252:255], a[120:123], v[240:255]
    s_barrier
    ds_read_b64_tr_b16 a[232:233], v14 offset:16384
    ds_read_b64_tr_b16 a[234:235], v14 offset:18432
    s_waitcnt lgkmcnt(6)
    v_mfma_f32_32x32x16_bf16 v[192:207], a[216:219], a[124:127], v[192:207]
    ds_read_b64_tr_b16 a[236:237], v15 offset:16384
    ds_read_b64_tr_b16 a[238:239], v15 offset:18432
    v_mfma_f32_32x32x16_bf16 v[208:223], a[220:223], a[124:127], v[208:223]
    ds_read_b64_tr_b16 a[240:241], v16 offset:16384
    ds_read_b64_tr_b16 a[242:243], v16 offset:18432
    s_waitcnt lgkmcnt(6)
    v_mfma_f32_32x32x16_bf16 v[224:239], a[224:227], a[124:127], v[224:239]
    ds_read_b64_tr_b16 a[244:245], v17 offset:16384
    ds_read_b64_tr_b16 a[246:247], v17 offset:18432
    v_mfma_f32_32x32x16_bf16 v[240:255], a[228:231], a[124:127], v[240:255]
    ds_read_b64_tr_b16 a[248:249], v14 offset:20480
    ds_read_b64_tr_b16 a[250:251], v14 offset:22528
    s_waitcnt lgkmcnt(6)
    v_mfma_f32_32x32x16_bf16 v[192:207], a[232:235], a[128:131], v[192:207]
    ds_read_b64_tr_b16 a[252:253], v15 offset:20480
    ds_read_b64_tr_b16 a[254:255], v15 offset:22528
    s_waitcnt vmcnt(8)
    v_max_f32 v21, v26, v22
    v_sub_f32 v24, v26, v21
    v_sub_f32 v25, v22, v21
    v_mfma_f32_32x32x16_bf16 v[208:223], a[236:239], a[128:131], v[208:223]
    ds_read_b64_tr_b16 a[216:217], v16 offset:20480
    ds_read_b64_tr_b16 a[218:219], v16 offset:22528
    v_exp_f32 v24, v24
    s_waitcnt lgkmcnt(6)
    v_mfma_f32_32x32x16_bf16 v[224:239], a[240:243], a[128:131], v[224:239]
    ds_read_b64_tr_b16 a[220:221], v17 offset:20480
    ds_read_b64_tr_b16 a[222:223], v17 offset:22528
    v_exp_f32 v25, v25
    v_mul_f32 v21, v24, v27
    v_fma_f32 v21, v25, v23, v21
    v_mfma_f32_32x32x16_bf16 v[240:255], a[244:247], a[128:131], v[240:255]
    ds_read_b64_tr_b16 a[224:225], v14 offset:24576
    ds_read_b64_tr_b16 a[226:227], v14 offset:26624
    v_rcp_f32 v21, v21
    s_nop 0
    s_waitcnt lgkmcnt(6)
    v_mfma_f32_32x32x16_bf16 v[192:207], a[248:251], a[132:135], v[192:207]
    ds_read_b64_tr_b16 a[228:229], v15 offset:24576
    ds_read_b64_tr_b16 a[230:231], v15 offset:26624
    v_mul_f32 v24, v24, v21
    v_mul_f32 v25, v25, v21
    v_mfma_f32_32x32x16_bf16 v[208:223], a[252:255], a[132:135], v[208:223]
    ds_read_b64_tr_b16 a[232:233], v16 offset:24576
    ds_read_b64_tr_b16 a[234:235], v16 offset:26624
    s_waitcnt vmcnt(7)
    v_lshlrev_b32 v64, 16, v32
    v_and_b32 v65, s57, v32
    s_waitcnt lgkmcnt(6)
    v_mfma_f32_32x32x16_bf16 v[224:239], a[216:219], a[132:135], v[224:239]
    ds_read_b64_tr_b16 a[236:237], v17 offset:24576
    ds_read_b64_tr_b16 a[238:239], v17 offset:26624
    v_lshlrev_b32 v66, 16, v33
    v_and_b32 v67, s57, v33
    v_lshlrev_b32 v68, 16, v34
    v_and_b32 v69, s57, v34
    v_mfma_f32_32x32x16_bf16 v[240:255], a[220:223], a[132:135], v[240:255]
    ds_read_b64_tr_b16 a[240:241], v14 offset:28672
    ds_read_b64_tr_b16 a[242:243], v14 offset:30720
    v_lshlrev_b32 v70, 16, v35
    v_and_b32 v71, s57, v35
    v_mul_f32 v64, v64, v25
    s_waitcnt lgkmcnt(6)
    v_mfma_f32_32x32x16_bf16 v[192:207], a[224:227], a[136:139], v[192:207]
    ds_read_b64_tr_b16 a[244:245], v15 offset:28672
    ds_read_b64_tr_b16 a[246:247], v15 offset:30720
    v_mul_f32 v65, v65, v25
    s_waitcnt vmcnt(6)
    v_lshlrev_b32 v72, 16, v36
    v_and_b32 v73, s57, v36
    v_mfma_f32_32x32x16_bf16 v[208:223], a[228:231], a[136:139], v[208:223]
    ds_read_b64_tr_b16 a[248:249], v16 offset:28672
    ds_read_b64_tr_b16 a[250:251], v16 offset:30720
    v_lshlrev_b32 v74, 16, v37
    v_and_b32 v75, s57, v37
    v_lshlrev_b32 v76, 16, v38
    s_waitcnt lgkmcnt(6)
    v_mfma_f32_32x32x16_bf16 v[224:239], a[232:235], a[136:139], v[224:239]
    ds_read_b64_tr_b16 a[252:253], v17 offset:28672
    ds_read_b64_tr_b16 a[254:255], v17 offset:30720
    v_and_b32 v77, s57, v38
    v_lshlrev_b32 v78, 16, v39
    v_and_b32 v79, s57, v39
    v_mul_f32 v72, v72, v25
    v_mfma_f32_32x32x16_bf16 v[240:255], a[236:239], a[136:139], v[240:255]
    s_barrier
    ds_read_b64_tr_b16 a[216:217], v14 offset:32768
    ds_read_b64_tr_b16 a[218:219], v14 offset:34816
    v_mul_f32 v73, v73, v25
    s_waitcnt vmcnt(5)
    s_waitcnt lgkmcnt(6)
    v_mfma_f32_32x32x16_bf16 v[192:207], a[240:243], a[140:143], v[192:207]
    ds_read_b64_tr_b16 a[220:221], v14 offset:36864
    ds_read_b64_tr_b16 a[222:223], v14 offset:38912
    v_lshlrev_b32 v96, 16, v40
    v_and_b32 v97, s57, v40
    v_lshlrev_b32 v98, 16, v41
    v_and_b32 v99, s57, v41
    v_mfma_f32_32x32x16_bf16 v[208:223], a[244:247], a[140:143], v[208:223]
    ds_read_b64_tr_b16 a[224:225], v14 offset:40960
    ds_read_b64_tr_b16 a[226:227], v14 offset:43008
    v_lshlrev_b32 v100, 16, v42
    v_and_b32 v101, s57, v42
    v_lshlrev_b32 v102, 16, v43
    s_waitcnt lgkmcnt(6)
    v_mfma_f32_32x32x16_bf16 v[224:239], a[248:251], a[140:143], v[224:239]
    ds_read_b64_tr_b16 a[228:229], v14 offset:45056
    ds_read_b64_tr_b16 a[230:231], v14 offset:47104
    v_and_b32 v103, s57, v43
    s_waitcnt vmcnt(4)
    v_lshlrev_b32 v104, 16, v44
    v_and_b32 v105, s57, v44
    v_mfma_f32_32x32x16_bf16 v[240:255], a[252:255], a[140:143], v[240:255]
    ds_read_b64_tr_b16 a[232:233], v15 offset:32768
    ds_read_b64_tr_b16 a[234:235], v15 offset:34816
    v_lshlrev_b32 v106, 16, v45
    v_and_b32 v107, s57, v45
    v_lshlrev_b32 v108, 16, v46
    s_waitcnt lgkmcnt(6)
    v_mfma_f32_32x32x16_bf16 v[192:207], a[216:219], a[144:147], v[192:207]
    ds_read_b64_tr_b16 a[236:237], v15 offset:36864
    ds_read_b64_tr_b16 a[238:239], v15 offset:38912
    v_and_b32 v109, s57, v46
    v_lshlrev_b32 v110, 16, v47
    v_and_b32 v111, s57, v47
    v_mul_f32 v104, v104, v25
    v_mfma_f32_32x32x16_bf16 v[192:207], a[220:223], a[148:151], v[192:207]
    ds_read_b64_tr_b16 a[240:241], v15 offset:40960
    ds_read_b64_tr_b16 a[242:243], v15 offset:43008
    v_mul_f32 v105, v105, v25
    s_waitcnt vmcnt(3)
    v_lshlrev_b32 v112, 16, v48
    s_waitcnt lgkmcnt(6)
    v_mfma_f32_32x32x16_bf16 v[192:207], a[224:227], a[152:155], v[192:207]
    ds_read_b64_tr_b16 a[244:245], v15 offset:45056
    ds_read_b64_tr_b16 a[246:247], v15 offset:47104
    v_and_b32 v113, s57, v48
    v_lshlrev_b32 v114, 16, v49
    v_and_b32 v115, s57, v49
    v_lshlrev_b32 v116, 16, v50
    v_mfma_f32_32x32x16_bf16 v[192:207], a[228:231], a[156:159], v[192:207]
    ds_read_b64_tr_b16 a[248:249], v16 offset:32768
    ds_read_b64_tr_b16 a[250:251], v16 offset:34816
    v_and_b32 v117, s57, v50
    v_lshlrev_b32 v118, 16, v51
    v_and_b32 v119, s57, v51
    s_waitcnt lgkmcnt(6)
    v_mfma_f32_32x32x16_bf16 v[208:223], a[232:235], a[144:147], v[208:223]
    ds_read_b64_tr_b16 a[252:253], v16 offset:36864
    ds_read_b64_tr_b16 a[254:255], v16 offset:38912
    v_mul_f32 v112, v112, v25
    v_mul_f32 v113, v113, v25
    s_waitcnt vmcnt(2)
    v_lshlrev_b32 v120, 16, v52
    v_mfma_f32_32x32x16_bf16 v[208:223], a[236:239], a[148:151], v[208:223]
    ds_read_b64_tr_b16 a[216:217], v16 offset:40960
    ds_read_b64_tr_b16 a[218:219], v16 offset:43008
    v_and_b32 v121, s57, v52
    v_lshlrev_b32 v122, 16, v53
    v_and_b32 v123, s57, v53
    s_waitcnt lgkmcnt(6)
    v_mfma_f32_32x32x16_bf16 v[208:223], a[240:243], a[152:155], v[208:223]
    ds_read_b64_tr_b16 a[220:221], v16 offset:45056
    ds_read_b64_tr_b16 a[222:223], v16 offset:47104
    v_lshlrev_b32 v124, 16, v54
    v_and_b32 v125, s57, v54
    v_lshlrev_b32 v126, 16, v55
    v_and_b32 v127, s57, v55
    v_mfma_f32_32x32x16_bf16 v[208:223], a[244:247], a[156:159], v[208:223]
    ds_read_b64_tr_b16 a[224:225], v17 offset:32768
    ds_read_b64_tr_b16 a[226:227], v17 offset:34816
    v_mul_f32 v120, v120, v25
    v_mul_f32 v121, v121, v25
    s_waitcnt vmcnt(1)
    s_waitcnt lgkmcnt(6)
    v_mfma_f32_32x32x16_bf16 v[224:239], a[248:251], a[144:147], v[224:239]
    ds_read_b64_tr_b16 a[228:229], v17 offset:36864
    ds_read_b64_tr_b16 a[230:231], v17 offset:38912
    v_lshlrev_b32 v80, 16, v56
    v_and_b32 v81, s57, v56
    v_lshlrev_b32 v82, 16, v57
    v_and_b32 v83, s57, v57
    v_mfma_f32_32x32x16_bf16 v[224:239], a[252:255], a[148:151], v[224:239]
    ds_read_b64_tr_b16 a[232:233], v17 offset:40960
    ds_read_b64_tr_b16 a[234:235], v17 offset:43008
    v_lshlrev_b32 v84, 16, v58
    v_and_b32 v85, s57, v58
    v_lshlrev_b32 v86, 16, v59
    s_waitcnt lgkmcnt(6)
    v_mfma_f32_32x32x16_bf16 v[224:239], a[216:219], a[152:155], v[224:239]
    ds_read_b64_tr_b16 a[236:237], v17 offset:45056
    ds_read_b64_tr_b16 a[238:239], v17 offset:47104
    v_and_b32 v87, s57, v59
    s_waitcnt vmcnt(0)
    v_lshlrev_b32 v88, 16, v60
    v_and_b32 v89, s57, v60
    v_mfma_f32_32x32x16_bf16 v[224:239], a[220:223], a[156:159], v[224:239]
    s_barrier
    ds_read_b64_tr_b16 a[240:241], v18 offset:49152
    ds_read_b64_tr_b16 a[242:243], v18 offset:50176
    v_lshlrev_b32 v90, 16, v61
    v_and_b32 v91, s57, v61
    s_waitcnt lgkmcnt(6)
    v_mfma_f32_32x32x16_bf16 v[240:255], a[224:227], a[144:147], v[240:255]
    ds_read_b64_tr_b16 a[244:245], v19 offset:49152
    ds_read_b64_tr_b16 a[246:247], v19 offset:50176
    v_lshlrev_b32 v92, 16, v62
    v_and_b32 v93, s57, v62
    v_lshlrev_b32 v94, 16, v63
    v_and_b32 v95, s57, v63
    v_mfma_f32_32x32x16_bf16 v[240:255], a[228:231], a[148:151], v[240:255]
    ds_read_b64_tr_b16 a[248:249], v18 offset:51200
    ds_read_b64_tr_b16 a[250:251], v18 offset:52224
    v_mul_f32 v88, v88, v25
    v_mul_f32 v89, v89, v25
    v_mul_f32 v66, v66, v25
    s_waitcnt lgkmcnt(6)
    v_mfma_f32_32x32x16_bf16 v[240:255], a[232:235], a[152:155], v[240:255]
    ds_read_b64_tr_b16 a[252:253], v19 offset:51200
    ds_read_b64_tr_b16 a[254:255], v19 offset:52224
    v_mul_f32 v67, v67, v25
    v_mul_f32 v68, v68, v25
    v_mul_f32 v69, v69, v25
    v_mfma_f32_32x32x16_bf16 v[240:255], a[236:239], a[156:159], v[240:255]
    ds_read_b64_tr_b16 a[216:217], v18 offset:53248
    ds_read_b64_tr_b16 a[218:219], v18 offset:54272
    v_pk_mul_f32 v[70:71], v[70:71], v[24:25] op_sel:[0,1] op_sel_hi:[1,1]
    v_pk_fma_f32 v[64:65], v[192:193], v[24:25], v[64:65] op_sel_hi:[1,0,1]
    v_pk_fma_f32 v[66:67], v[194:195], v[24:25], v[66:67] op_sel_hi:[1,0,1]
    v_pk_fma_f32 v[68:69], v[196:197], v[24:25], v[68:69] op_sel_hi:[1,0,1]
    v_pk_fma_f32 v[70:71], v[198:199], v[24:25], v[70:71] op_sel_hi:[1,0,1]
    v_cvt_pk_bf16_f32 v128, v64, v65
    v_cvt_pk_bf16_f32 v129, v66, v67
    v_cvt_pk_bf16_f32 v130, v68, v69
    v_cvt_pk_bf16_f32 v131, v70, v71
    buffer_store_dwordx4 v[128:131], v29, s[36:39], s66 offen offset:0
    v_pk_mul_f32 v[74:75], v[74:75], v[24:25] op_sel:[0,1] op_sel_hi:[1,1]
    v_pk_mul_f32 v[76:77], v[76:77], v[24:25] op_sel:[0,1] op_sel_hi:[1,1]
    v_pk_mul_f32 v[78:79], v[78:79], v[24:25] op_sel:[0,1] op_sel_hi:[1,1]
    v_pk_fma_f32 v[72:73], v[200:201], v[24:25], v[72:73] op_sel_hi:[1,0,1]
    v_pk_fma_f32 v[74:75], v[202:203], v[24:25], v[74:75] op_sel_hi:[1,0,1]
    v_pk_fma_f32 v[76:77], v[204:205], v[24:25], v[76:77] op_sel_hi:[1,0,1]
    v_pk_fma_f32 v[78:79], v[206:207], v[24:25], v[78:79] op_sel_hi:[1,0,1]
    v_cvt_pk_bf16_f32 v132, v72, v73
    v_cvt_pk_bf16_f32 v133, v74, v75
    v_cvt_pk_bf16_f32 v134, v76, v77
    v_cvt_pk_bf16_f32 v135, v78, v79
    buffer_store_dwordx4 v[132:135], v29, s[36:39], s66 offen offset:1024
    v_pk_mul_f32 v[96:97], v[96:97], v[24:25] op_sel:[0,1] op_sel_hi:[1,1]
    v_pk_mul_f32 v[98:99], v[98:99], v[24:25] op_sel:[0,1] op_sel_hi:[1,1]
    v_pk_mul_f32 v[100:101], v[100:101], v[24:25] op_sel:[0,1] op_sel_hi:[1,1]
    v_pk_mul_f32 v[102:103], v[102:103], v[24:25] op_sel:[0,1] op_sel_hi:[1,1]
    v_pk_fma_f32 v[96:97], v[208:209], v[24:25], v[96:97] op_sel_hi:[1,0,1]
    v_pk_fma_f32 v[98:99], v[210:211], v[24:25], v[98:99] op_sel_hi:[1,0,1]
    v_pk_fma_f32 v[100:101], v[212:213], v[24:25], v[100:101] op_sel_hi:[1,0,1]
    v_pk_fma_f32 v[102:103], v[214:215], v[24:25], v[102:103] op_sel_hi:[1,0,1]
    v_cvt_pk_bf16_f32 v136, v96, v97
    v_cvt_pk_bf16_f32 v137, v98, v99
    v_cvt_pk_bf16_f32 v138, v100, v101
    v_cvt_pk_bf16_f32 v139, v102, v103
    buffer_store_dwordx4 v[136:139], v29, s[36:39], s66 offen offset:2048
    v_pk_mul_f32 v[106:107], v[106:107], v[24:25] op_sel:[0,1] op_sel_hi:[1,1]
    v_pk_mul_f32 v[108:109], v[108:109], v[24:25] op_sel:[0,1] op_sel_hi:[1,1]
    v_pk_mul_f32 v[110:111], v[110:111], v[24:25] op_sel:[0,1] op_sel_hi:[1,1]
    v_pk_fma_f32 v[104:105], v[216:217], v[24:25], v[104:105] op_sel_hi:[1,0,1]
    v_pk_fma_f32 v[106:107], v[218:219], v[24:25], v[106:107] op_sel_hi:[1,0,1]
    v_pk_fma_f32 v[108:109], v[220:221], v[24:25], v[108:109] op_sel_hi:[1,0,1]
    v_pk_fma_f32 v[110:111], v[222:223], v[24:25], v[110:111] op_sel_hi:[1,0,1]
    v_cvt_pk_bf16_f32 v140, v104, v105
    v_cvt_pk_bf16_f32 v141, v106, v107
    v_cvt_pk_bf16_f32 v142, v108, v109
    v_cvt_pk_bf16_f32 v143, v110, v111
    buffer_store_dwordx4 v[140:143], v29, s[36:39], s66 offen offset:3072
    v_pk_mul_f32 v[114:115], v[114:115], v[24:25] op_sel:[0,1] op_sel_hi:[1,1]
    v_pk_mul_f32 v[116:117], v[116:117], v[24:25] op_sel:[0,1] op_sel_hi:[1,1]
    v_pk_mul_f32 v[118:119], v[118:119], v[24:25] op_sel:[0,1] op_sel_hi:[1,1]
    v_pk_fma_f32 v[112:113], v[224:225], v[24:25], v[112:113] op_sel_hi:[1,0,1]
    v_pk_fma_f32 v[114:115], v[226:227], v[24:25], v[114:115] op_sel_hi:[1,0,1]
    v_pk_fma_f32 v[116:117], v[228:229], v[24:25], v[116:117] op_sel_hi:[1,0,1]
    v_pk_fma_f32 v[118:119], v[230:231], v[24:25], v[118:119] op_sel_hi:[1,0,1]
    v_cvt_pk_bf16_f32 v144, v112, v113
    v_cvt_pk_bf16_f32 v145, v114, v115
    v_cvt_pk_bf16_f32 v146, v116, v117
    v_cvt_pk_bf16_f32 v147, v118, v119
    buffer_store_dwordx4 v[144:147], v29, s[36:39], s56 offen offset:0
    v_pk_mul_f32 v[122:123], v[122:123], v[24:25] op_sel:[0,1] op_sel_hi:[1,1]
    v_pk_mul_f32 v[124:125], v[124:125], v[24:25] op_sel:[0,1] op_sel_hi:[1,1]
    v_pk_mul_f32 v[126:127], v[126:127], v[24:25] op_sel:[0,1] op_sel_hi:[1,1]
C_pad7:
    s_cbranch_execz L_ret1
    v_pk_fma_f32 v[120:121], v[232:233], v[24:25], v[120:121] op_sel_hi:[1,0,1]
    v_pk_fma_f32 v[122:123], v[234:235], v[24:25], v[122:123] op_sel_hi:[1,0,1]
    v_pk_fma_f32 v[124:125], v[236:237], v[24:25], v[124:125] op_sel_hi:[1,0,1]
    v_pk_fma_f32 v[126:127], v[238:239], v[24:25], v[126:127] op_sel_hi:[1,0,1]
    v_cvt_pk_bf16_f32 v148, v120, v121
    v_cvt_pk_bf16_f32 v149, v122, v123
    v_cvt_pk_bf16_f32 v150, v124, v125
    v_cvt_pk_bf16_f32 v151, v126, v127
    buffer_store_dwordx4 v[148:151], v29, s[36:39], s56 offen offset:1024
    v_pk_mul_f32 v[80:81], v[80:81], v[24:25] op_sel:[0,1] op_sel_hi:[1,1]
    v_pk_mul_f32 v[82:83], v[82:83], v[24:25] op_sel:[0,1] op_sel_hi:[1,1]
    v_pk_mul_f32 v[84:85], v[84:85], v[24:25] op_sel:[0,1] op_sel_hi:[1,1]
    v_pk_mul_f32 v[86:87], v[86:87], v[24:25] op_sel:[0,1] op_sel_hi:[1,1]
    v_pk_fma_f32 v[80:81], v[240:241], v[24:25], v[80:81] op_sel_hi:[1,0,1]
    v_pk_fma_f32 v[82:83], v[242:243], v[24:25], v[82:83] op_sel_hi:[1,0,1]
    v_pk_fma_f32 v[84:85], v[244:245], v[24:25], v[84:85] op_sel_hi:[1,0,1]
    v_pk_fma_f32 v[86:87], v[246:247], v[24:25], v[86:87] op_sel_hi:[1,0,1]
    v_cvt_pk_bf16_f32 v152, v80, v81
    v_cvt_pk_bf16_f32 v153, v82, v83
    v_cvt_pk_bf16_f32 v154, v84, v85
    v_cvt_pk_bf16_f32 v155, v86, v87
    buffer_store_dwordx4 v[152:155], v29, s[36:39], s56 offen offset:2048
    v_pk_mul_f32 v[90:91], v[90:91], v[24:25] op_sel:[0,1] op_sel_hi:[1,1]
    v_pk_mul_f32 v[92:93], v[92:93], v[24:25] op_sel:[0,1] op_sel_hi:[1,1]
    v_pk_mul_f32 v[94:95], v[94:95], v[24:25] op_sel:[0,1] op_sel_hi:[1,1]
    v_pk_fma_f32 v[88:89], v[248:249], v[24:25], v[88:89] op_sel_hi:[1,0,1]
    v_pk_fma_f32 v[90:91], v[250:251], v[24:25], v[90:91] op_sel_hi:[1,0,1]
    v_pk_fma_f32 v[92:93], v[252:253], v[24:25], v[92:93] op_sel_hi:[1,0,1]
    v_pk_fma_f32 v[94:95], v[254:255], v[24:25], v[94:95] op_sel_hi:[1,0,1]
    v_cvt_pk_bf16_f32 v156, v88, v89
    v_cvt_pk_bf16_f32 v157, v90, v91
    v_cvt_pk_bf16_f32 v158, v92, v93
    v_cvt_pk_bf16_f32 v159, v94, v95
    buffer_store_dwordx4 v[156:159], v29, s[36:39], s56 offen offset:3072
    s_waitcnt lgkmcnt(6)
    v_mfma_f32_32x32x16_bf16 v[160:175], a[240:243], v[128:131], 0
    ds_read_b64_tr_b16 a[220:221], v19 offset:53248
    ds_read_b64_tr_b16 a[222:223], v19 offset:54272
    v_mfma_f32_32x32x16_bf16 v[176:191], a[244:247], v[128:131], 0
    ds_read_b64_tr_b16 a[224:225], v18 offset:55296
    ds_read_b64_tr_b16 a[226:227], v18 offset:56320
    s_xor_b32 s34, s50, 16
    s_add_u32 s30, s67, 4096
    s_add_u32 s31, s68, 4096
    s_waitcnt lgkmcnt(6)
    v_mfma_f32_32x32x16_bf16 v[160:175], a[248:251], v[132:135], v[160:175]
    ds_read_b64_tr_b16 a[228:229], v19 offset:55296
    ds_read_b64_tr_b16 a[230:231], v19 offset:56320
    s_add_u32 s32, s69, 4096
    v_mfma_f32_32x32x16_bf16 v[176:191], a[252:255], v[132:135], v[176:191]
    ds_read_b64_tr_b16 a[232:233], v18 offset:57344
    ds_read_b64_tr_b16 a[234:235], v18 offset:58368
    s_waitcnt lgkmcnt(6)
    v_mfma_f32_32x32x16_bf16 v[160:175], a[216:219], v[136:139], v[160:175]
    ds_read_b64_tr_b16 a[236:237], v19 offset:57344
    ds_read_b64_tr_b16 a[238:239], v19 offset:58368
    v_mfma_f32_32x32x16_bf16 v[176:191], a[220:223], v[136:139], v[176:191]
    ds_read_b64_tr_b16 a[240:241], v18 offset:59392
    ds_read_b64_tr_b16 a[242:243], v18 offset:60416
    s_waitcnt lgkmcnt(6)
    v_mfma_f32_32x32x16_bf16 v[160:175], a[224:227], v[140:143], v[160:175]
    ds_read_b64_tr_b16 a[244:245], v19 offset:59392
    ds_read_b64_tr_b16 a[246:247], v19 offset:60416
    v_mfma_f32_32x32x16_bf16 v[176:191], a[228:231], v[140:143], v[176:191]
    ds_read_b64_tr_b16 a[248:249], v18 offset:61440
    ds_read_b64_tr_b16 a[250:251], v18 offset:62464
    s_waitcnt lgkmcnt(6)
    v_mfma_f32_32x32x16_bf16 v[160:175], a[232:235], v[144:147], v[160:175]
    ds_read_b64_tr_b16 a[252:253], v19 offset:61440
    ds_read_b64_tr_b16 a[254:255], v19 offset:62464
    v_mfma_f32_32x32x16_bf16 v[176:191], a[236:239], v[144:147], v[176:191]
    ds_read_b64_tr_b16 a[216:217], v18 offset:63488
    ds_read_b64_tr_b16 a[218:219], v18 offset:64512
    v_add_u32 v18, 0x10000, v18
    s_waitcnt lgkmcnt(6)
    v_mfma_f32_32x32x16_bf16 v[160:175], a[240:243], v[148:151], v[160:175]
    ds_read_b64_tr_b16 a[220:221], v19 offset:63488
    ds_read_b64_tr_b16 a[222:223], v19 offset:64512
    v_add_u32 v19, 0x10000, v19
    s_waitcnt vmcnt(0)
    v_mov_b32 v1, 2
    s_cmp_lg_u32 s29, 0
    s_mov_b64 exec, 1
    s_cbranch_scc1 C_gs2
    buffer_store_dword v1, v0, s[36:39], s50 offen
C_gb2:
    s_mov_b64 exec, -1
    v_mfma_f32_32x32x16_bf16 v[176:191], a[244:247], v[148:151], v[176:191]
    s_barrier
    ds_read_b64_tr_b16 a[224:225], v18 offset:0
    ds_read_b64_tr_b16 a[226:227], v18 offset:1024
    buffer_load_dword v1, v4, s[36:39], 0 offen sc1
    s_waitcnt lgkmcnt(6)
    v_mfma_f32_32x32x16_bf16 v[160:175], a[248:251], v[152:155], v[160:175]
    ds_read_b64_tr_b16 a[228:229], v19 offset:0
    ds_read_b64_tr_b16 a[230:231], v19 offset:1024
    v_mfma_f32_32x32x16_bf16 v[176:191], a[252:255], v[152:155], v[176:191]
    ds_read_b64_tr_b16 a[232:233], v18 offset:2048
    ds_read_b64_tr_b16 a[234:235], v18 offset:3072
    s_waitcnt lgkmcnt(6)
    v_mfma_f32_32x32x16_bf16 v[160:175], a[216:219], v[156:159], v[160:175]
    ds_read_b64_tr_b16 a[236:237], v19 offset:2048
    ds_read_b64_tr_b16 a[238:239], v19 offset:3072
    v_mfma_f32_32x32x16_bf16 v[176:191], a[220:223], v[156:159], v[176:191]
    ds_read_b64_tr_b16 a[240:241], v18 offset:4096
    ds_read_b64_tr_b16 a[242:243], v18 offset:5120
    s_waitcnt lgkmcnt(6)
    v_mfma_f32_32x32x16_bf16 v[32:47], a[224:227], v[128:131], 0
    ds_read_b64_tr_b16 a[244:245], v19 offset:4096
    ds_read_b64_tr_b16 a[246:247], v19 offset:5120
    v_mfma_f32_32x32x16_bf16 v[48:63], a[228:231], v[128:131], 0
    ds_read_b64_tr_b16 a[248:249], v18 offset:6144
    ds_read_b64_tr_b16 a[250:251], v18 offset:7168
    s_waitcnt lgkmcnt(6)
    v_mfma_f32_32x32x16_bf16 v[32:47], a[232:235], v[132:135], v[32:47]
    ds_read_b64_tr_b16 a[252:253], v19 offset:6144
    ds_read_b64_tr_b16 a[254:255], v19 offset:7168
    v_mfma_f32_32x32x16_bf16 v[48:63], a[236:239], v[132:135], v[48:63]
    ds_read_b64_tr_b16 a[216:217], v18 offset:8192
    ds_read_b64_tr_b16 a[218:219], v18 offset:9216
C_slx2:
    s_waitcnt vmcnt(0)
    v_cmp_gt_u32 vcc, 2, v1
    s_sub_u32 s73, s73, 1
    s_cbranch_vccz C_sbx2
    buffer_load_dword v1, v4, s[36:39], 0 offen sc1
    s_cbranch_scc0 C_slx2
    s_mov_b32 s73, 16
C_sbx2:
    s_cmp_lg_u32 s29, 0
    s_cbranch_scc1 C_asx2
C_abx2:
    s_waitcnt lgkmcnt(6)
    v_mfma_f32_32x32x16_bf16 v[32:47], a[240:243], v[136:139], v[32:47]
    ds_read_b64_tr_b16 a[220:221], v19 offset:8192
    ds_read_b64_tr_b16 a[222:223], v19 offset:9216
    buffer_load_dwordx4 a[0:3], v29, s[36:39], s67 offen offset:0 nt
    v_mfma_f32_32x32x16_bf16 v[48:63], a[244:247], v[136:139], v[48:63]
    ds_read_b64_tr_b16 a[224:225], v18 offset:10240
    ds_read_b64_tr_b16 a[226:227], v18 offset:11264
    buffer_load_dwordx4 a[4:7], v29, s[36:39], s67 offen offset:1024 nt
    s_waitcnt lgkmcnt(6)
    v_mfma_f32_32x32x16_bf16 v[32:47], a[248:251], v[140:143], v[32:47]
    ds_read_b64_tr_b16 a[228:229], v19 offset:10240
    ds_read_b64_tr_b16 a[230:231], v19 offset:11264
    buffer_load_dwordx4 a[8:11], v29, s[36:39], s67 offen offset:2048 nt
    v_mfma_f32_32x32x16_bf16 v[48:63], a[252:255], v[140:143], v[48:63]
    ds_read_b64_tr_b16 a[232:233], v18 offset:12288
    ds_read_b64_tr_b16 a[234:235], v18 offset:13312
    buffer_load_dwordx4 a[12:15], v29, s[36:39], s67 offen offset:3072 nt
    s_waitcnt lgkmcnt(6)
    v_mfma_f32_32x32x16_bf16 v[32:47], a[216:219], v[144:147], v[32:47]
    ds_read_b64_tr_b16 a[236:237], v19 offset:12288
    ds_read_b64_tr_b16 a[238:239], v19 offset:13312
    buffer_load_dwordx4 a[16:19], v29, s[36:39], s30 offen offset:0 nt
    v_mfma_f32_32x32x16_bf16 v[48:63], a[220:223], v[144:147], v[48:63]
    ds_read_b64_tr_b16 a[240:241], v18 offset:14336
    ds_read_b64_tr_b16 a[242:243], v18 offset:15360
    buffer_load_dwordx4 a[20:23], v29, s[36:39], s30 offen offset:1024 nt
    s_waitcnt lgkmcnt(6)
    v_mfma_f32_32x32x16_bf16 v[32:47], a[224:227], v[148:151], v[32:47]
    ds_read_b64_tr_b16 a[244:245], v19 offset:14336
    ds_read_b64_tr_b16 a[246:247], v19 offset:15360
    buffer_load_dwordx4 a[24:27], v29, s[36:39], s30 offen offset:2048 nt
    v_mfma_f32_32x32x16_bf16 v[48:63], a[228:231], v[148:151], v[48:63]
    s_barrier
    ds_read_b64_tr_b16 a[248:249], v18 offset:16384
    ds_read_b64_tr_b16 a[250:251], v18 offset:17408
    buffer_load_dwordx4 a[28:31], v29, s[36:39], s30 offen offset:3072 nt
    s_waitcnt lgkmcnt(6)
    v_mfma_f32_32x32x16_bf16 v[32:47], a[232:235], v[152:155], v[32:47]
    ds_read_b64_tr_b16 a[252:253], v19 offset:16384
    ds_read_b64_tr_b16 a[254:255], v19 offset:17408
    buffer_load_dwordx4 a[32:35], v29, s[36:39], s68 offen offset:0 nt
    v_mfma_f32_32x32x16_bf16 v[48:63], a[236:239], v[152:155], v[48:63]
    ds_read_b64_tr_b16 a[216:217], v18 offset:18432
    ds_read_b64_tr_b16 a[218:219], v18 offset:19456
    buffer_load_dwordx4 a[36:39], v29, s[36:39], s68 offen offset:1024 nt
    s_waitcnt lgkmcnt(6)
    v_mfma_f32_32x32x16_bf16 v[32:47], a[240:243], v[156:159], v[32:47]
    ds_read_b64_tr_b16 a[220:221], v19 offset:18432
    ds_read_b64_tr_b16 a[222:223], v19 offset:19456
    buffer_load_dwordx4 a[40:43], v29, s[36:39], s68 offen offset:2048 nt
    v_mfma_f32_32x32x16_bf16 v[48:63], a[244:247], v[156:159], v[48:63]
    ds_read_b64_tr_b16 a[224:225], v18 offset:20480
    ds_read_b64_tr_b16 a[226:227], v18 offset:21504
    buffer_load_dwordx4 a[44:47], v29, s[36:39], s68 offen offset:3072 nt
    s_waitcnt vmcnt(10)
    s_waitcnt lgkmcnt(6)
    v_mfma_f32_32x32x16_bf16 v[160:175], a[248:251], a[0:3], v[160:175]
    ds_read_b64_tr_b16 a[228:229], v19 offset:20480
    ds_read_b64_tr_b16 a[230:231], v19 offset:21504
    buffer_load_dwordx4 a[48:51], v29, s[36:39], s31 offen offset:0 nt
    v_mfma_f32_32x32x16_bf16 v[176:191], a[252:255], a[0:3], v[176:191]
    ds_read_b64_tr_b16 a[232:233], v18 offset:22528
    ds_read_b64_tr_b16 a[234:235], v18 offset:23552
    buffer_load_dwordx4 a[52:55], v29, s[36:39], s31 offen offset:1024 nt
    s_waitcnt lgkmcnt(6)
    v_mfma_f32_32x32x16_bf16 v[160:175], a[216:219], a[4:7], v[160:175]
    ds_read_b64_tr_b16 a[236:237], v19 offset:22528
    ds_read_b64_tr_b16 a[238:239], v19 offset:23552
    buffer_load_dwordx4 a[56:59], v29, s[36:39], s31 offen offset:2048 nt
    v_mfma_f32_32x32x16_bf16 v[176:191], a[220:223], a[4:7], v[176:191]
    ds_read_b64_tr_b16 a[240:241], v18 offset:24576
    ds_read_b64_tr_b16 a[242:243], v18 offset:25600
    buffer_load_dwordx4 a[60:63], v29, s[36:39], s31 offen offset:3072 nt
    s_waitcnt vmcnt(12)
    s_waitcnt lgkmcnt(6)
    v_mfma_f32_32x32x16_bf16 v[160:175], a[224:227], a[8:11], v[160:175]
    ds_read_b64_tr_b16 a[244:245], v19 offset:24576
    ds_read_b64_tr_b16 a[246:247], v19 offset:25600
    v_mfma_f32_32x32x16_bf16 v[176:191], a[228:231], a[8:11], v[176:191]
    ds_read_b64_tr_b16 a[248:249], v18 offset:26624
    ds_read_b64_tr_b16 a[250:251], v18 offset:27648
    buffer_load_dwordx4 a[64:67], v29, s[36:39], s69 offen offset:0 nt
    s_waitcnt lgkmcnt(6)
    v_mfma_f32_32x32x16_bf16 v[160:175], a[232:235], a[12:15], v[160:175]
    ds_read_b64_tr_b16 a[252:253], v19 offset:26624
    ds_read_b64_tr_b16 a[254:255], v19 offset:27648
    buffer_load_dwordx4 a[68:71], v29, s[36:39], s69 offen offset:1024 nt
    v_mfma_f32_32x32x16_bf16 v[176:191], a[236:239], a[12:15], v[176:191]
    ds_read_b64_tr_b16 a[216:217], v18 offset:28672
    ds_read_b64_tr_b16 a[218:219], v18 offset:29696
    s_waitcnt vmcnt(12)
    s_waitcnt lgkmcnt(6)
    v_mfma_f32_32x32x16_bf16 v[160:175], a[240:243], a[16:19], v[160:175]
    ds_read_b64_tr_b16 a[220:221], v19 offset:28672
    ds_read_b64_tr_b16 a[222:223], v19 offset:29696
    buffer_load_dwordx4 a[72:75], v29, s[36:39], s69 offen offset:2048 nt
    v_mfma_f32_32x32x16_bf16 v[176:191], a[244:247], a[16:19], v[176:191]
    ds_read_b64_tr_b16 a[224:225], v18 offset:30720
    ds_read_b64_tr_b16 a[226:227], v18 offset:31744
    buffer_load_dwordx4 a[76:79], v29, s[36:39], s69 offen offset:3072 nt
    s_waitcnt lgkmcnt(6)
    v_mfma_f32_32x32x16_bf16 v[160:175], a[248:251], a[20:23], v[160:175]
    ds_read_b64_tr_b16 a[228:229], v19 offset:30720
    ds_read_b64_tr_b16 a[230:231], v19 offset:31744
    v_mfma_f32_32x32x16_bf16 v[176:191], a[252:255], a[20:23], v[176:191]
    s_barrier
    ds_read_b64_tr_b16 a[232:233], v18 offset:32768
    ds_read_b64_tr_b16 a[234:235], v18 offset:33792
    buffer_load_dwordx4 a[80:83], v29, s[36:39], s32 offen offset:0 nt
    s_waitcnt vmcnt(13)
    s_waitcnt lgkmcnt(6)
    v_mfma_f32_32x32x16_bf16 v[160:175], a[216:219], a[24:27], v[160:175]
    ds_read_b64_tr_b16 a[236:237], v19 offset:32768
    ds_read_b64_tr_b16 a[238:239], v19 offset:33792
    buffer_load_dwordx4 a[84:87], v29, s[36:39], s32 offen offset:1024 nt
    v_mfma_f32_32x32x16_bf16 v[176:191], a[220:223], a[24:27], v[176:191]
    ds_read_b64_tr_b16 a[240:241], v18 offset:34816
    ds_read_b64_tr_b16 a[242:243], v18 offset:35840
    s_waitcnt lgkmcnt(6)
    v_mfma_f32_32x32x16_bf16 v[160:175], a[224:227], a[28:31], v[160:175]
    ds_read_b64_tr_b16 a[244:245], v19 offset:34816
    ds_read_b64_tr_b16 a[246:247], v19 offset:35840
    buffer_load_dwordx4 a[88:91], v29, s[36:39], s32 offen offset:2048 nt
    v_mfma_f32_32x32x16_bf16 v[176:191], a[228:231], a[28:31], v[176:191]
    ds_read_b64_tr_b16 a[248:249], v18 offset:36864
    ds_read_b64_tr_b16 a[250:251], v18 offset:37888
    buffer_load_dwordx4 a[92:95], v29, s[36:39], s32 offen offset:3072 nt
    s_waitcnt vmcnt(12)
    s_waitcnt lgkmcnt(6)
    v_mfma_f32_32x32x16_bf16 v[160:175], a[232:235], a[32:35], v[160:175]
    ds_read_b64_tr_b16 a[252:253], v19 offset:36864
    ds_read_b64_tr_b16 a[254:255], v19 offset:37888
    v_mfma_f32_32x32x16_bf16 v[176:191], a[236:239], a[32:35], v[176:191]
    ds_read_b64_tr_b16 a[216:217], v18 offset:38912
    ds_read_b64_tr_b16 a[218:219], v18 offset:39936
    s_waitcnt lgkmcnt(6)
    v_mfma_f32_32x32x16_bf16 v[160:175], a[240:243], a[36:39], v[160:175]
    ds_read_b64_tr_b16 a[220:221], v19 offset:38912
    ds_read_b64_tr_b16 a[222:223], v19 offset:39936
    s_add_u32 s34, s40, s41
    s_and_b32 s34, s34, 7
    s_and_b32 s48, s46, 3
    s_lshl_b32 s33, s48, 1
    v_mfma_f32_32x32x16_bf16 v[176:191], a[244:247], a[36:39], v[176:191]
    ds_read_b64_tr_b16 a[224:225], v18 offset:40960
    ds_read_b64_tr_b16 a[226:227], v18 offset:41984
    s_lshr_b32 s49, s34, 2
    s_add_u32 s33, s33, s49
    v_bfe_u32 v8, v2, 3, 2
    s_waitcnt lgkmcnt(6)
    v_mfma_f32_32x32x16_bf16 v[160:175], a[248:251], a[40:43], v[160:175]
    ds_read_b64_tr_b16 a[228:229], v19 offset:40960
    ds_read_b64_tr_b16 a[230:231], v19 offset:41984
    v_mov_b32 v9, 0x40000000
    v_cmp_eq_u32 vcc, s34, v8
    s_xor_b32 s60, s34, 4
    s_and_b32 s34, s34, 3
    v_mfma_f32_32x32x16_bf16 v[176:191], a[252:255], a[40:43], v[176:191]
    ds_read_b64_tr_b16 a[232:233], v18 offset:43008
    ds_read_b64_tr_b16 a[234:235], v18 offset:44032
    v_cndmask_b32 v11, v29, v9, vcc
    v_cmp_eq_u32 vcc, s60, v8
    s_lshl_b32 s60, s45, 13
    s_waitcnt lgkmcnt(6)
    v_mfma_f32_32x32x16_bf16 v[160:175], a[216:219], a[44:47], v[160:175]
    ds_read_b64_tr_b16 a[236:237], v19 offset:43008
    ds_read_b64_tr_b16 a[238:239], v19 offset:44032
    s_add_u32 s60, s60, 16384
    v_cndmask_b32 v12, v29, v9, vcc
    v_add_u32 v13, s60, v29
    s_lshl_b32 s49, s49, 12
    v_mfma_f32_32x32x16_bf16 v[176:191], a[220:223], a[44:47], v[176:191]
    ds_read_b64_tr_b16 a[240:241], v18 offset:45056
    ds_read_b64_tr_b16 a[242:243], v18 offset:46080
    s_waitcnt vmcnt(8)
    s_add_u32 s60, s60, s49
    s_lshl_b32 s49, s34, 7
    s_waitcnt lgkmcnt(6)
    v_mfma_f32_32x32x16_bf16 v[160:175], a[224:227], a[48:51], v[160:175]
    ds_read_b64_tr_b16 a[244:245], v19 offset:45056
    ds_read_b64_tr_b16 a[246:247], v19 offset:46080
    s_add_u32 s60, s60, s49
    s_and_b32 s48, s54, 0xfffe3e7f
    v_and_b32 v10, 7, v2
    v_lshl_add_u32 v4, v10, 14, s48
    v_mfma_f32_32x32x16_bf16 v[176:191], a[228:231], a[48:51], v[176:191]
    ds_read_b64_tr_b16 a[248:249], v18 offset:47104
    ds_read_b64_tr_b16 a[250:251], v18 offset:48128
    s_mul_i32 s64, s41, 7
    s_add_u32 s64, s64, s33
    s_mul_i32 s64, s64, 3
    s_waitcnt lgkmcnt(6)
    v_mfma_f32_32x32x16_bf16 v[160:175], a[232:235], a[52:55], v[160:175]
    ds_read_b64_tr_b16 a[252:253], v19 offset:47104
    ds_read_b64_tr_b16 a[254:255], v19 offset:48128
    s_add_u32 s64, s64, s45
    s_lshl_b32 s64, s64, 5
    s_add_u32 s64, s64, s40
    s_lshl_b32 s64, s64, 10
    v_mfma_f32_32x32x16_bf16 v[176:191], a[236:239], a[52:55], v[176:191]
    ds_read_b64_tr_b16 a[216:217], v18 offset:49152
    ds_read_b64_tr_b16 a[218:219], v18 offset:50176
    s_add_u32 s64, s64, s49
    s_lshl_b32 s65, s33, 7
    s_mul_i32 s48, s34, 7168
    s_barrier
    s_waitcnt lgkmcnt(6)
    v_mfma_f32_32x32x16_bf16 v[160:175], a[240:243], a[56:59], v[160:175]
    ds_read_b64_tr_b16 a[220:221], v18 offset:51200
    ds_read_b64_tr_b16 a[222:223], v18 offset:52224
    s_add_u32 s65, s65, s48
    s_mul_i32 s48, s41, 3
    s_add_u32 s48, s48, s45
    s_mul_i32 s48, s48, 28672
    v_mfma_f32_32x32x16_bf16 v[176:191], a[244:247], a[56:59], v[176:191]
    ds_read_b64_tr_b16 a[224:225], v18 offset:53248
    ds_read_b64_tr_b16 a[226:227], v18 offset:54272
    s_add_u32 s65, s65, s48
    v_mul_u32_u24 v8, 896, v10
    v_lshrrev_b32 v9, 3, v2
    s_waitcnt lgkmcnt(6)
    v_mfma_f32_32x32x16_bf16 v[160:175], a[248:251], a[60:63], v[160:175]
    ds_read_b64_tr_b16 a[228:229], v18 offset:55296
    ds_read_b64_tr_b16 a[230:231], v18 offset:56320
    v_lshl_add_u32 v8, v9, 4, v8
    v_lshlrev_b32 v10, 4, v10
    v_lshl_add_u32 v20, v9, 9, v10
    v_add_u32 v20, s60, v20
    v_mfma_f32_32x32x16_bf16 v[176:191], a[252:255], a[60:63], v[176:191]
    ds_read_b64_tr_b16 a[232:233], v18 offset:57344
    ds_read_b64_tr_b16 a[234:235], v18 offset:58368
    s_waitcnt vmcnt(4)
    v_and_b32 v9, 1, v9
    v_lshl_add_u32 v10, v9, 9, v10
    s_waitcnt lgkmcnt(6)
    v_mfma_f32_32x32x16_bf16 v[160:175], a[216:219], a[64:67], v[160:175]
    ds_read_b64_tr_b16 a[236:237], v18 offset:59392
    ds_read_b64_tr_b16 a[238:239], v18 offset:60416
    v_lshrrev_b32 v9, 4, v2
    v_lshl_add_u32 v10, v9, 13, v10
    s_mov_b32 s62, 0
    s_mov_b32 s61, 0x7f817f81
    v_mfma_f32_32x32x16_bf16 v[160:175], a[220:223], a[68:71], v[160:175]
    ds_read_b64_tr_b16 a[240:241], v18 offset:61440
    ds_read_b64_tr_b16 a[242:243], v18 offset:62464
    s_xor_b32 s4, s64, 1024
    s_xor_b32 s5, s64, 2048
    s_xor_b32 s6, s64, 3072
    s_waitcnt lgkmcnt(6)
    v_mfma_f32_32x32x16_bf16 v[160:175], a[224:227], a[72:75], v[160:175]
    ds_read_b64_tr_b16 a[244:245], v18 offset:63488
    ds_read_b64_tr_b16 a[246:247], v18 offset:64512
    s_xor_b32 s7, s64, 4096
    s_xor_b32 s8, s64, 5120
    s_xor_b32 s9, s64, 6144
    s_xor_b32 s10, s64, 7168
    v_mfma_f32_32x32x16_bf16 v[160:175], a[228:231], a[76:79], v[160:175]
    ds_read_b64_tr_b16 a[248:249], v19 offset:49152
    ds_read_b64_tr_b16 a[250:251], v19 offset:50176
    s_waitcnt vmcnt(0)
    s_waitcnt lgkmcnt(6)
    v_mfma_f32_32x32x16_bf16 v[160:175], a[232:235], a[80:83], v[160:175]
    ds_read_b64_tr_b16 a[252:253], v19 offset:51200
    ds_read_b64_tr_b16 a[254:255], v19 offset:52224
    v_mfma_f32_32x32x16_bf16 v[160:175], a[236:239], a[84:87], v[160:175]
    ds_read_b64_tr_b16 a[216:217], v19 offset:53248
    ds_read_b64_tr_b16 a[218:219], v19 offset:54272
    s_waitcnt lgkmcnt(6)
    v_mfma_f32_32x32x16_bf16 v[160:175], a[240:243], a[88:91], v[160:175]
    ds_read_b64_tr_b16 a[220:221], v19 offset:55296
    ds_read_b64_tr_b16 a[222:223], v19 offset:56320
    v_mfma_f32_32x32x16_bf16 v[160:175], a[244:247], a[92:95], v[160:175]
    ds_read_b64_tr_b16 a[224:225], v19 offset:57344
    ds_read_b64_tr_b16 a[226:227], v19 offset:58368
    s_waitcnt lgkmcnt(6)
    v_mfma_f32_32x32x16_bf16 v[176:191], a[248:251], a[64:67], v[176:191]
    ds_read_b64_tr_b16 a[228:229], v19 offset:59392
    ds_read_b64_tr_b16 a[230:231], v19 offset:60416
    v_add_u32 v18, 0x10000, v18
    v_mfma_f32_32x32x16_bf16 v[176:191], a[252:255], a[68:71], v[176:191]
    ds_read_b64_tr_b16 a[232:233], v19 offset:61440
    ds_read_b64_tr_b16 a[234:235], v19 offset:62464
    s_waitcnt lgkmcnt(6)
    v_mfma_f32_32x32x16_bf16 v[176:191], a[216:219], a[72:75], v[176:191]
    ds_read_b64_tr_b16 a[236:237], v19 offset:63488
    ds_read_b64_tr_b16 a[238:239], v19 offset:64512
    v_mfma_f32_32x32x16_bf16 v[176:191], a[220:223], a[76:79], v[176:191]
    ds_read_b64_tr_b16 a[240:241], v18 offset:0
    ds_read_b64_tr_b16 a[242:243], v18 offset:1024
    v_cvt_pk_bf16_f32 v64, v160, v161
    v_cvt_pk_bf16_f32 v65, v162, v163
    v_cvt_pk_bf16_f32 v66, v164, v165
    s_waitcnt lgkmcnt(6)
    v_mfma_f32_32x32x16_bf16 v[176:191], a[224:227], a[80:83], v[176:191]
    ds_read_b64_tr_b16 a[244:245], v18 offset:2048
    ds_read_b64_tr_b16 a[246:247], v18 offset:3072
    v_cvt_pk_bf16_f32 v67, v166, v167
    buffer_store_dwordx4 v[64:67], v11, s[36:39], s71 offen sc1
    v_mfma_f32_32x32x16_bf16 v[176:191], a[228:231], a[84:87], v[176:191]
    ds_read_b64_tr_b16 a[248:249], v18 offset:4096
    ds_read_b64_tr_b16 a[250:251], v18 offset:5120
    v_cvt_pk_bf16_f32 v68, v168, v169
    v_cvt_pk_bf16_f32 v69, v170, v171
    v_cvt_pk_bf16_f32 v70, v172, v173
    s_waitcnt lgkmcnt(6)
    v_mfma_f32_32x32x16_bf16 v[176:191], a[232:235], a[88:91], v[176:191]
    ds_read_b64_tr_b16 a[252:253], v18 offset:6144
    ds_read_b64_tr_b16 a[254:255], v18 offset:7168
    v_cvt_pk_bf16_f32 v71, v174, v175
    s_add_u32 s71, s71, 8192
    v_mfma_f32_32x32x16_bf16 v[176:191], a[236:239], a[92:95], v[176:191]
    ds_read_b64_tr_b16 a[216:217], v18 offset:8192
    ds_read_b64_tr_b16 a[218:219], v18 offset:9216
    buffer_store_dwordx4 v[68:71], v11, s[36:39], s71 offen sc1
    s_waitcnt lgkmcnt(6)
    v_mfma_f32_32x32x16_bf16 v[32:47], a[240:243], a[0:3], v[32:47]
    ds_read_b64_tr_b16 a[220:221], v18 offset:10240
    ds_read_b64_tr_b16 a[222:223], v18 offset:11264
    v_mfma_f32_32x32x16_bf16 v[32:47], a[244:247], a[4:7], v[32:47]
    ds_read_b64_tr_b16 a[224:225], v18 offset:12288
    ds_read_b64_tr_b16 a[226:227], v18 offset:13312
    s_waitcnt lgkmcnt(6)
    v_mfma_f32_32x32x16_bf16 v[32:47], a[248:251], a[8:11], v[32:47]
    ds_read_b64_tr_b16 a[228:229], v18 offset:14336
    ds_read_b64_tr_b16 a[230:231], v18 offset:15360
    v_cvt_pk_bf16_f32 v72, v176, v177
    v_cvt_pk_bf16_f32 v73, v178, v179
    v_cvt_pk_bf16_f32 v74, v180, v181
    v_cvt_pk_bf16_f32 v75, v182, v183
    v_mfma_f32_32x32x16_bf16 v[32:47], a[252:255], a[12:15], v[32:47]
    ds_read_b64_tr_b16 a[232:233], v18 offset:16384
    ds_read_b64_tr_b16 a[234:235], v18 offset:17408
    s_add_u32 s71, s71, 8192
    s_waitcnt lgkmcnt(6)
    v_mfma_f32_32x32x16_bf16 v[32:47], a[216:219], a[16:19], v[32:47]
    ds_read_b64_tr_b16 a[236:237], v18 offset:18432
    ds_read_b64_tr_b16 a[238:239], v18 offset:19456
    buffer_store_dwordx4 v[72:75], v11, s[36:39], s71 offen sc1
    v_cvt_pk_bf16_f32 v76, v184, v185
    v_mfma_f32_32x32x16_bf16 v[32:47], a[220:223], a[20:23], v[32:47]
    ds_read_b64_tr_b16 a[240:241], v18 offset:20480
    ds_read_b64_tr_b16 a[242:243], v18 offset:21504
    v_cvt_pk_bf16_f32 v77, v186, v187
    v_cvt_pk_bf16_f32 v78, v188, v189
    v_cvt_pk_bf16_f32 v79, v190, v191
    s_waitcnt lgkmcnt(6)
    v_mfma_f32_32x32x16_bf16 v[32:47], a[224:227], a[24:27], v[32:47]
    ds_read_b64_tr_b16 a[244:245], v18 offset:22528
    ds_read_b64_tr_b16 a[246:247], v18 offset:23552
    s_add_u32 s71, s71, 8192
    buffer_store_dwordx4 v[76:79], v11, s[36:39], s71 offen sc1
    v_mfma_f32_32x32x16_bf16 v[32:47], a[228:231], a[28:31], v[32:47]
    ds_read_b64_tr_b16 a[248:249], v18 offset:24576
    ds_read_b64_tr_b16 a[250:251], v18 offset:25600
    s_waitcnt lgkmcnt(6)
    v_mfma_f32_32x32x16_bf16 v[32:47], a[232:235], a[32:35], v[32:47]
    ds_read_b64_tr_b16 a[252:253], v18 offset:26624
    ds_read_b64_tr_b16 a[254:255], v18 offset:27648
    v_mfma_f32_32x32x16_bf16 v[32:47], a[236:239], a[36:39], v[32:47]
    ds_read_b64_tr_b16 a[216:217], v18 offset:28672
    ds_read_b64_tr_b16 a[218:219], v18 offset:29696
    s_waitcnt lgkmcnt(6)
    v_mfma_f32_32x32x16_bf16 v[32:47], a[240:243], a[40:43], v[32:47]
    ds_read_b64_tr_b16 a[220:221], v18 offset:30720
    ds_read_b64_tr_b16 a[222:223], v18 offset:31744
    v_add_u32 v18, 0xfffe0000, v18
    v_mfma_f32_32x32x16_bf16 v[32:47], a[244:247], a[44:47], v[32:47]
    ds_read_b64_tr_b16 a[224:225], v18 offset:0
    ds_read_b64_tr_b16 a[226:227], v18 offset:1024
    s_waitcnt lgkmcnt(6)
    v_mfma_f32_32x32x16_bf16 v[32:47], a[248:251], a[48:51], v[32:47]
    ds_read_b64_tr_b16 a[228:229], v18 offset:2048
    ds_read_b64_tr_b16 a[230:231], v18 offset:3072
    v_mfma_f32_32x32x16_bf16 v[32:47], a[252:255], a[52:55], v[32:47]
    ds_read_b64_tr_b16 a[232:233], v18 offset:4096
    ds_read_b64_tr_b16 a[234:235], v18 offset:5120
    s_waitcnt lgkmcnt(6)
    v_mfma_f32_32x32x16_bf16 v[32:47], a[216:219], a[56:59], v[32:47]
    ds_read_b64_tr_b16 a[236:237], v18 offset:6144
    ds_read_b64_tr_b16 a[238:239], v18 offset:7168
    v_mfma_f32_32x32x16_bf16 v[32:47], a[220:223], a[60:63], v[32:47]
    ds_read_b64_tr_b16 a[240:241], v18 offset:8192
    ds_read_b64_tr_b16 a[242:243], v18 offset:9216
    s_waitcnt lgkmcnt(6)
    v_mfma_f32_32x32x16_bf16 v[32:47], a[224:227], a[64:67], v[32:47]
    ds_read_b64_tr_b16 a[244:245], v18 offset:10240
    ds_read_b64_tr_b16 a[246:247], v18 offset:11264
    v_add_u32 v19, 0x10000, v19
    v_mfma_f32_32x32x16_bf16 v[32:47], a[228:231], a[68:71], v[32:47]
    ds_read_b64_tr_b16 a[248:249], v18 offset:12288
    ds_read_b64_tr_b16 a[250:251], v18 offset:13312
    s_waitcnt lgkmcnt(6)
    v_mfma_f32_32x32x16_bf16 v[32:47], a[232:235], a[72:75], v[32:47]
    ds_read_b64_tr_b16 a[252:253], v18 offset:14336
    ds_read_b64_tr_b16 a[254:255], v18 offset:15360
    v_mfma_f32_32x32x16_bf16 v[32:47], a[236:239], a[76:79], v[32:47]
    ds_read_b64_tr_b16 a[216:217], v19 offset:0
    ds_read_b64_tr_b16 a[218:219], v19 offset:1024
    s_waitcnt lgkmcnt(6)
    v_mfma_f32_32x32x16_bf16 v[32:47], a[240:243], a[80:83], v[32:47]
    ds_read_b64_tr_b16 a[220:221], v19 offset:2048
    ds_read_b64_tr_b16 a[222:223], v19 offset:3072
    v_mfma_f32_32x32x16_bf16 v[32:47], a[244:247], a[84:87], v[32:47]
    ds_read_b64_tr_b16 a[224:225], v19 offset:4096
    ds_read_b64_tr_b16 a[226:227], v19 offset:5120
    s_waitcnt lgkmcnt(6)
    v_mfma_f32_32x32x16_bf16 v[32:47], a[248:251], a[88:91], v[32:47]
    ds_read_b64_tr_b16 a[228:229], v19 offset:6144
    ds_read_b64_tr_b16 a[230:231], v19 offset:7168
    v_mfma_f32_32x32x16_bf16 v[32:47], a[252:255], a[92:95], v[32:47]
    ds_read_b64_tr_b16 a[232:233], v19 offset:8192
    ds_read_b64_tr_b16 a[234:235], v19 offset:9216
    s_waitcnt lgkmcnt(6)
    v_mfma_f32_32x32x16_bf16 v[48:63], a[216:219], a[0:3], v[48:63]
    ds_read_b64_tr_b16 a[236:237], v19 offset:10240
    ds_read_b64_tr_b16 a[238:239], v19 offset:11264
    s_waitcnt vmcnt(0)
    s_barrier
    v_mfma_f32_32x32x16_bf16 v[48:63], a[220:223], a[4:7], v[48:63]
    ds_read_b64_tr_b16 a[240:241], v19 offset:12288
    ds_read_b64_tr_b16 a[242:243], v19 offset:13312
    s_waitcnt lgkmcnt(6)
    v_mfma_f32_32x32x16_bf16 v[48:63], a[224:227], a[8:11], v[48:63]
    ds_read_b64_tr_b16 a[244:245], v19 offset:14336
    ds_read_b64_tr_b16 a[246:247], v19 offset:15360
    s_barrier
    v_mfma_f32_32x32x16_bf16 v[48:63], a[228:231], a[12:15], v[48:63]
    ds_read_b64_tr_b16 a[248:249], v19 offset:16384
    ds_read_b64_tr_b16 a[250:251], v19 offset:17408
    v_cvt_pk_bf16_f32 v80, v32, v33
    v_cvt_pk_bf16_f32 v81, v34, v35
    v_cvt_pk_bf16_f32 v82, v36, v37
    s_waitcnt lgkmcnt(6)
    v_mfma_f32_32x32x16_bf16 v[48:63], a[232:235], a[16:19], v[48:63]
    ds_read_b64_tr_b16 a[252:253], v19 offset:18432
    ds_read_b64_tr_b16 a[254:255], v19 offset:19456
    v_cvt_pk_bf16_f32 v83, v38, v39
    buffer_store_dwordx4 v[80:83], v12, s[36:39], s72 offen sc1
    v_mfma_f32_32x32x16_bf16 v[48:63], a[236:239], a[20:23], v[48:63]
    ds_read_b64_tr_b16 a[216:217], v19 offset:20480
    ds_read_b64_tr_b16 a[218:219], v19 offset:21504
    v_cvt_pk_bf16_f32 v84, v40, v41
    v_cvt_pk_bf16_f32 v85, v42, v43
    v_cvt_pk_bf16_f32 v86, v44, v45
    s_waitcnt lgkmcnt(6)
C_pad8:
    s_cbranch_execz L_ret1
    v_mfma_f32_32x32x16_bf16 v[48:63], a[240:243], a[24:27], v[48:63]
    ds_read_b64_tr_b16 a[220:221], v19 offset:22528
    ds_read_b64_tr_b16 a[222:223], v19 offset:23552
    v_cvt_pk_bf16_f32 v87, v46, v47
    s_add_u32 s72, s72, 8192
    v_mfma_f32_32x32x16_bf16 v[48:63], a[244:247], a[28:31], v[48:63]
    ds_read_b64_tr_b16 a[224:225], v19 offset:24576
    ds_read_b64_tr_b16 a[226:227], v19 offset:25600
    buffer_store_dwordx4 v[84:87], v12, s[36:39], s72 offen sc1
    s_waitcnt lgkmcnt(6)
    v_mfma_f32_32x32x16_bf16 v[48:63], a[248:251], a[32:35], v[48:63]
    ds_read_b64_tr_b16 a[228:229], v19 offset:26624
    ds_read_b64_tr_b16 a[230:231], v19 offset:27648
    ds_write_b128 v13, v[64:67] offset:0
    v_mfma_f32_32x32x16_bf16 v[48:63], a[252:255], a[36:39], v[48:63]
    ds_read_b64_tr_b16 a[232:233], v19 offset:28672
    ds_read_b64_tr_b16 a[234:235], v19 offset:29696
    s_waitcnt lgkmcnt(7)
    v_mfma_f32_32x32x16_bf16 v[48:63], a[216:219], a[40:43], v[48:63]
    ds_read_b64_tr_b16 a[236:237], v19 offset:30720
    ds_read_b64_tr_b16 a[238:239], v19 offset:31744
    v_add_u32 v19, 0xfffe0000, v19
    ds_write_b128 v13, v[68:71] offset:1024
    v_mfma_f32_32x32x16_bf16 v[48:63], a[220:223], a[44:47], v[48:63]
    ds_read_b64_tr_b16 a[240:241], v19 offset:0
    ds_read_b64_tr_b16 a[242:243], v19 offset:1024
    s_waitcnt lgkmcnt(8)
    v_mfma_f32_32x32x16_bf16 v[48:63], a[224:227], a[48:51], v[48:63]
    ds_read_b64_tr_b16 a[244:245], v19 offset:2048
    ds_read_b64_tr_b16 a[246:247], v19 offset:3072
    ds_write_b128 v13, v[72:75] offset:2048
    v_mfma_f32_32x32x16_bf16 v[48:63], a[228:231], a[52:55], v[48:63]
    ds_read_b64_tr_b16 a[248:249], v19 offset:4096
    ds_read_b64_tr_b16 a[250:251], v19 offset:5120
    s_waitcnt lgkmcnt(8)
    v_mfma_f32_32x32x16_bf16 v[48:63], a[232:235], a[56:59], v[48:63]
    ds_read_b64_tr_b16 a[252:253], v19 offset:6144
    ds_read_b64_tr_b16 a[254:255], v19 offset:7168
    ds_write_b128 v13, v[76:79] offset:3072
    v_mfma_f32_32x32x16_bf16 v[48:63], a[236:239], a[60:63], v[48:63]
    ds_read_b64_tr_b16 a[216:217], v19 offset:8192
    ds_read_b64_tr_b16 a[218:219], v19 offset:9216
    s_waitcnt lgkmcnt(8)
    v_mfma_f32_32x32x16_bf16 v[48:63], a[240:243], a[64:67], v[48:63]
    ds_read_b64_tr_b16 a[220:221], v19 offset:10240
    ds_read_b64_tr_b16 a[222:223], v19 offset:11264
    ds_write_b128 v13, v[80:83] offset:4096
    v_mfma_f32_32x32x16_bf16 v[48:63], a[244:247], a[68:71], v[48:63]
    ds_read_b64_tr_b16 a[224:225], v19 offset:12288
    ds_read_b64_tr_b16 a[226:227], v19 offset:13312
    s_waitcnt lgkmcnt(8)
    v_mfma_f32_32x32x16_bf16 v[48:63], a[248:251], a[72:75], v[48:63]
    ds_read_b64_tr_b16 a[228:229], v19 offset:14336
    ds_read_b64_tr_b16 a[230:231], v19 offset:15360
    buffer_load_dword v1, v4, s[36:39], 0 offen sc1
    v_mfma_f32_32x32x16_bf16 v[48:63], a[252:255], a[76:79], v[48:63]
    s_waitcnt lgkmcnt(5)
    v_mfma_f32_32x32x16_bf16 v[48:63], a[216:219], a[80:83], v[48:63]
    ds_write_b128 v13, v[84:87] offset:5120
    v_mfma_f32_32x32x16_bf16 v[48:63], a[220:223], a[84:87], v[48:63]
    s_waitcnt lgkmcnt(1)
    v_mfma_f32_32x32x16_bf16 v[48:63], a[224:227], a[88:91], v[48:63]
    v_mfma_f32_32x32x16_bf16 v[48:63], a[228:231], a[92:95], v[48:63]
    s_nop 11
    v_cvt_pk_bf16_f32 v88, v48, v49
    v_cvt_pk_bf16_f32 v89, v50, v51
    v_cvt_pk_bf16_f32 v90, v52, v53
    v_cvt_pk_bf16_f32 v91, v54, v55
    s_add_u32 s72, s72, 8192
    buffer_store_dwordx4 v[88:91], v12, s[36:39], s72 offen sc1
    v_cvt_pk_bf16_f32 v92, v56, v57
    v_cvt_pk_bf16_f32 v93, v58, v59
    v_cvt_pk_bf16_f32 v94, v60, v61
    v_cvt_pk_bf16_f32 v95, v62, v63
    s_add_u32 s72, s72, 8192
    buffer_store_dwordx4 v[92:95], v12, s[36:39], s72 offen sc1
    s_cmp_eq_u32 s33, 7
    s_cbranch_scc1 C_fin
    s_waitcnt vmcnt(2)
    v_cmp_gt_u32 vcc, 32, v1
    s_nop 0
    s_cbranch_vccz C_sbx3
    buffer_load_dword v1, v4, s[36:39], 0 offen sc1
C_slx3:
    s_waitcnt vmcnt(0)
    v_cmp_gt_u32 vcc, 32, v1
    s_sub_u32 s73, s73, 1
    s_cbranch_vccz C_sbx3
    buffer_load_dword v1, v4, s[36:39], 0 offen sc1
    s_cbranch_scc0 C_slx3
    s_mov_b32 s73, 16
C_sbx3:
C_r0:
    buffer_load_dwordx4 v[100:103], v10, s[36:39], s4 offen sc1
    buffer_load_dwordx4 v[104:107], v10, s[36:39], s5 offen sc1
    buffer_load_dwordx4 v[108:111], v10, s[36:39], s6 offen sc1
    buffer_load_dwordx4 v[112:115], v10, s[36:39], s7 offen sc1
    buffer_load_dwordx4 v[116:119], v10, s[36:39], s8 offen sc1
    buffer_load_dwordx4 v[120:123], v10, s[36:39], s9 offen sc1
    buffer_load_dwordx4 v[124:127], v10, s[36:39], s10 offen sc1
    ds_write_b128 v13, v[88:91] offset:6144
    ds_write_b128 v13, v[92:95] offset:7168
    ds_read_b128 v[96:99], v20
    s_waitcnt lgkmcnt(0)
    v_lshlrev_b32 v32, 16, v96
    v_and_b32 v33, s57, v96
    v_lshlrev_b32 v34, 16, v97
    v_and_b32 v35, s57, v97
    v_lshlrev_b32 v36, 16, v98
    v_and_b32 v37, s57, v98
    v_lshlrev_b32 v38, 16, v99
    v_and_b32 v39, s57, v99
    s_waitcnt vmcnt(6)
    v_lshlrev_b32 v48, 16, v100
    v_and_b32 v49, s57, v100
    v_pk_add_f32 v[32:33], v[32:33], v[48:49]
    v_lshlrev_b32 v50, 16, v101
    v_and_b32 v51, s57, v101
    v_pk_add_f32 v[34:35], v[34:35], v[50:51]
    v_lshlrev_b32 v52, 16, v102
    v_and_b32 v53, s57, v102
    v_pk_add_f32 v[36:37], v[36:37], v[52:53]
    v_lshlrev_b32 v54, 16, v103
    v_and_b32 v55, s57, v103
    v_pk_add_f32 v[38:39], v[38:39], v[54:55]
    s_waitcnt vmcnt(5)
    v_lshlrev_b32 v48, 16, v104
    v_and_b32 v49, s57, v104
    v_pk_add_f32 v[32:33], v[32:33], v[48:49]
    v_lshlrev_b32 v50, 16, v105
    v_and_b32 v51, s57, v105
    v_pk_add_f32 v[34:35], v[34:35], v[50:51]
    v_lshlrev_b32 v52, 16, v106
    v_and_b32 v53, s57, v106
    v_pk_add_f32 v[36:37], v[36:37], v[52:53]
    v_lshlrev_b32 v54, 16, v107
    v_and_b32 v55, s57, v107
    v_pk_add_f32 v[38:39], v[38:39], v[54:55]
    s_waitcnt vmcnt(4)
    v_lshlrev_b32 v48, 16, v108
    v_and_b32 v49, s57, v108
    v_pk_add_f32 v[32:33], v[32:33], v[48:49]
    v_lshlrev_b32 v50, 16, v109
    v_and_b32 v51, s57, v109
    v_pk_add_f32 v[34:35], v[34:35], v[50:51]
    v_lshlrev_b32 v52, 16, v110
    v_and_b32 v53, s57, v110
    v_pk_add_f32 v[36:37], v[36:37], v[52:53]
    v_lshlrev_b32 v54, 16, v111
    v_and_b32 v55, s57, v111
    v_pk_add_f32 v[38:39], v[38:39], v[54:55]
    s_waitcnt vmcnt(3)
    v_lshlrev_b32 v48, 16, v112
    v_and_b32 v49, s57, v112
    v_pk_add_f32 v[32:33], v[32:33], v[48:49]
    v_lshlrev_b32 v50, 16, v113
    v_and_b32 v51, s57, v113
    v_pk_add_f32 v[34:35], v[34:35], v[50:51]
    v_lshlrev_b32 v52, 16, v114
    v_and_b32 v53, s57, v114
    v_pk_add_f32 v[36:37], v[36:37], v[52:53]
    v_lshlrev_b32 v54, 16, v115
    v_and_b32 v55, s57, v115
    v_pk_add_f32 v[38:39], v[38:39], v[54:55]
    s_waitcnt vmcnt(2)
    v_lshlrev_b32 v48, 16, v116
    v_and_b32 v49, s57, v116
    v_pk_add_f32 v[32:33], v[32:33], v[48:49]
    v_lshlrev_b32 v50, 16, v117
    v_and_b32 v51, s57, v117
    v_pk_add_f32 v[34:35], v[34:35], v[50:51]
    v_lshlrev_b32 v52, 16, v118
    v_and_b32 v53, s57, v118
    v_pk_add_f32 v[36:37], v[36:37], v[52:53]
    v_lshlrev_b32 v54, 16, v119
    v_and_b32 v55, s57, v119
    v_pk_add_f32 v[38:39], v[38:39], v[54:55]
    s_waitcnt vmcnt(1)
    v_lshlrev_b32 v48, 16, v120
    v_and_b32 v49, s57, v120
    v_pk_add_f32 v[32:33], v[32:33], v[48:49]
    v_lshlrev_b32 v50, 16, v121
    v_and_b32 v51, s57, v121
    v_pk_add_f32 v[34:35], v[34:35], v[50:51]
    v_lshlrev_b32 v52, 16, v122
    v_and_b32 v53, s57, v122
    v_pk_add_f32 v[36:37], v[36:37], v[52:53]
    v_lshlrev_b32 v54, 16, v123
    v_and_b32 v55, s57, v123
    v_pk_add_f32 v[38:39], v[38:39], v[54:55]
    s_waitcnt vmcnt(0)
    v_lshlrev_b32 v48, 16, v124
    v_and_b32 v49, s57, v124
    v_pk_add_f32 v[32:33], v[32:33], v[48:49]
    v_lshlrev_b32 v50, 16, v125
    v_and_b32 v51, s57, v125
    v_pk_add_f32 v[34:35], v[34:35], v[50:51]
    v_lshlrev_b32 v52, 16, v126
    v_and_b32 v53, s57, v126
    v_pk_add_f32 v[36:37], v[36:37], v[52:53]
    v_lshlrev_b32 v54, 16, v127
    v_and_b32 v55, s57, v127
    v_pk_add_f32 v[38:39], v[38:39], v[54:55]
    v_pk_add_f32 v[48:49], v[32:33], v[34:35]
    v_pk_add_f32 v[50:51], v[36:37], v[38:39]
    v_pk_add_f32 v[48:49], v[48:49], v[50:51]
    v_cmp_u_f32 vcc, v48, v49
    v_cvt_pk_bf16_f32 v44, v32, v33
    v_cvt_pk_bf16_f32 v45, v34, v35
    v_cvt_pk_bf16_f32 v46, v36, v37
    v_cvt_pk_bf16_f32 v47, v38, v39
    s_cbranch_vccz C_r1
    s_add_u32 s62, s62, 1
    s_and_b32 s48, s62, 7
    s_cbranch_scc1 C_r0
    s_branch C_r2
C_r1:
    buffer_store_dwordx4 v[44:47], v8, s[24:27], s65 offen
C_fin:
M_end:
    s_endpgm
C_rare1:
    s_nop 15
    v_mov_b32 v32, v64
    v_mov_b32 v33, v65
    v_mov_b32 v34, v66
    v_mov_b32 v35, v67
    v_mov_b32 v36, v68
    v_mov_b32 v37, v69
    v_mov_b32 v38, v70
    v_mov_b32 v39, v71
    v_mov_b32 v40, v72
    v_mov_b32 v41, v73
    v_mov_b32 v42, v74
    v_mov_b32 v43, v75
    v_mov_b32 v44, v76
    v_mov_b32 v45, v77
    v_mov_b32 v46, v78
    v_mov_b32 v47, v79
    s_call_b64 s[74:75], C_resc
    v_cvt_pk_bf16_f32 v136, v32, v33
    v_cvt_pk_bf16_f32 v137, v34, v35
    v_cvt_pk_bf16_f32 v138, v36, v37
    v_cvt_pk_bf16_f32 v139, v38, v39
    v_cvt_pk_bf16_f32 v140, v40, v41
    v_cvt_pk_bf16_f32 v141, v42, v43
    v_cvt_pk_bf16_f32 v142, v44, v45
    v_cvt_pk_bf16_f32 v143, v46, v47
    s_nop 3
    s_branch C_back1
C_rare2:
    s_nop 15
    v_mov_b32 v32, v80
    v_mov_b32 v33, v81
    v_mov_b32 v34, v82
    v_mov_b32 v35, v83
    v_mov_b32 v36, v84
    v_mov_b32 v37, v85
    v_mov_b32 v38, v86
    v_mov_b32 v39, v87
    v_mov_b32 v40, v88
    v_mov_b32 v41, v89
    v_mov_b32 v42, v90
    v_mov_b32 v43, v91
    v_mov_b32 v44, v92
    v_mov_b32 v45, v93
    v_mov_b32 v46, v94
    v_mov_b32 v47, v95
    s_call_b64 s[74:75], C_resc
    v_cvt_pk_bf16_f32 v144, v32, v33
    v_cvt_pk_bf16_f32 v145, v34, v35
    v_cvt_pk_bf16_f32 v146, v36, v37
    v_cvt_pk_bf16_f32 v147, v38, v39
    v_cvt_pk_bf16_f32 v148, v40, v41
    v_cvt_pk_bf16_f32 v149, v42, v43
    v_cvt_pk_bf16_f32 v150, v44, v45
    v_cvt_pk_bf16_f32 v151, v46, v47
    s_nop 3
    s_branch C_back2
C_rare3:
    s_nop 15
    v_mov_b32 v32, v48
    v_mov_b32 v33, v49
    v_mov_b32 v34, v50
    v_mov_b32 v35, v51
    v_mov_b32 v36, v52
    v_mov_b32 v37, v53
    v_mov_b32 v38, v54
    v_mov_b32 v39, v55
    v_mov_b32 v40, v56
    v_mov_b32 v41, v57
    v_mov_b32 v42, v58
    v_mov_b32 v43, v59
    v_mov_b32 v44, v60
    v_mov_b32 v45, v61
    v_mov_b32 v46, v62
    v_mov_b32 v47, v63
    s_call_b64 s[74:75], C_resc
    v_cvt_pk_bf16_f32 v152, v32, v33
    v_cvt_pk_bf16_f32 v153, v34, v35
    v_cvt_pk_bf16_f32 v154, v36, v37
    v_cvt_pk_bf16_f32 v155, v38, v39
    v_cvt_pk_bf16_f32 v156, v40, v41
    v_cvt_pk_bf16_f32 v157, v42, v43
    v_cvt_pk_bf16_f32 v158, v44, v45
    v_cvt_pk_bf16_f32 v159, v46, v47
    s_nop 3
    s_branch C_back3
C_rare4:
    s_nop 15
    v_mov_b32 v32, v64
    v_mov_b32 v33, v65
    v_mov_b32 v34, v66
    v_mov_b32 v35, v67
    v_mov_b32 v36, v68
    v_mov_b32 v37, v69
    v_mov_b32 v38, v70
    v_mov_b32 v39, v71
    v_mov_b32 v40, v72
    v_mov_b32 v41, v73
    v_mov_b32 v42, v74
    v_mov_b32 v43, v75
    v_mov_b32 v44, v76
    v_mov_b32 v45, v77
    v_mov_b32 v46, v78
    v_mov_b32 v47, v79
    s_call_b64 s[74:75], C_resc
    v_cvt_pk_bf16_f32 v160, v32, v33
    v_cvt_pk_bf16_f32 v161, v34, v35
    v_cvt_pk_bf16_f32 v162, v36, v37
    v_cvt_pk_bf16_f32 v163, v38, v39
    v_cvt_pk_bf16_f32 v164, v40, v41
    v_cvt_pk_bf16_f32 v165, v42, v43
    v_cvt_pk_bf16_f32 v166, v44, v45
    v_cvt_pk_bf16_f32 v167, v46, v47
    s_nop 3
    s_branch C_back4
C_rare5:
    s_nop 15
    v_mov_b32 v32, v80
    v_mov_b32 v33, v81
    v_mov_b32 v34, v82
    v_mov_b32 v35, v83
    v_mov_b32 v36, v84
    v_mov_b32 v37, v85
    v_mov_b32 v38, v86
    v_mov_b32 v39, v87
    v_mov_b32 v40, v88
    v_mov_b32 v41, v89
    v_mov_b32 v42, v90
    v_mov_b32 v43, v91
    v_mov_b32 v44, v92
    v_mov_b32 v45, v93
    v_mov_b32 v46, v94
    v_mov_b32 v47, v95
    s_call_b64 s[74:75], C_resc
    v_cvt_pk_bf16_f32 v168, v32, v33
    v_cvt_pk_bf16_f32 v169, v34, v35
    v_cvt_pk_bf16_f32 v170, v36, v37
    v_cvt_pk_bf16_f32 v171, v38, v39
    v_cvt_pk_bf16_f32 v172, v40, v41
    v_cvt_pk_bf16_f32 v173, v42, v43
    v_cvt_pk_bf16_f32 v174, v44, v45
    v_cvt_pk_bf16_f32 v175, v46, v47
    s_nop 3
    s_branch C_back5
C_rare6:
    s_nop 15
    v_mov_b32 v32, v48
    v_mov_b32 v33, v49
    v_mov_b32 v34, v50
    v_mov_b32 v35, v51
    v_mov_b32 v36, v52
    v_mov_b32 v37, v53
    v_mov_b32 v38, v54
    v_mov_b32 v39, v55
    v_mov_b32 v40, v56
    v_mov_b32 v41, v57
    v_mov_b32 v42, v58
    v_mov_b32 v43, v59
    v_mov_b32 v44, v60
    v_mov_b32 v45, v61
    v_mov_b32 v46, v62
    v_mov_b32 v47, v63
    s_call_b64 s[74:75], C_resc
    v_cvt_pk_bf16_f32 v176, v32, v33
    v_cvt_pk_bf16_f32 v177, v34, v35
    v_cvt_pk_bf16_f32 v178, v36, v37
    v_cvt_pk_bf16_f32 v179, v38, v39
    v_cvt_pk_bf16_f32 v180, v40, v41
    v_cvt_pk_bf16_f32 v181, v42, v43
    v_cvt_pk_bf16_f32 v182, v44, v45
    v_cvt_pk_bf16_f32 v183, v46, v47
    s_nop 3
    s_branch C_back6
C_rare7:
    s_nop 15
    v_mov_b32 v32, v64
    v_mov_b32 v33, v65
    v_mov_b32 v34, v66
    v_mov_b32 v35, v67
    v_mov_b32 v36, v68
    v_mov_b32 v37, v69
    v_mov_b32 v38, v70
    v_mov_b32 v39, v71
    v_mov_b32 v40, v72
    v_mov_b32 v41, v73
    v_mov_b32 v42, v74
    v_mov_b32 v43, v75
    v_mov_b32 v44, v76
    v_mov_b32 v45, v77
    v_mov_b32 v46, v78
    v_mov_b32 v47, v79
    s_call_b64 s[74:75], C_resc
    v_cvt_pk_bf16_f32 v184, v32, v33
    v_cvt_pk_bf16_f32 v185, v34, v35
    v_cvt_pk_bf16_f32 v186, v36, v37
    v_cvt_pk_bf16_f32 v187, v38, v39
    v_cvt_pk_bf16_f32 v188, v40, v41
    v_cvt_pk_bf16_f32 v189, v42, v43
    v_cvt_pk_bf16_f32 v190, v44, v45
    v_cvt_pk_bf16_f32 v191, v46, v47
    s_nop 3
    s_branch C_back7
C_rare8:
    s_nop 15
    v_mov_b32 v32, v80
    v_mov_b32 v33, v81
    v_mov_b32 v34, v82
    v_mov_b32 v35, v83
    v_mov_b32 v36, v84
    v_mov_b32 v37, v85
    v_mov_b32 v38, v86
    v_mov_b32 v39, v87
    v_mov_b32 v40, v88
    v_mov_b32 v41, v89
    v_mov_b32 v42, v90
    v_mov_b32 v43, v91
    v_mov_b32 v44, v92
    v_mov_b32 v45, v93
    v_mov_b32 v46, v94
    v_mov_b32 v47, v95
    s_call_b64 s[74:75], C_resc
    v_cvt_pk_bf16_f32 v192, v32, v33
    v_cvt_pk_bf16_f32 v193, v34, v35
    v_cvt_pk_bf16_f32 v194, v36, v37
    v_cvt_pk_bf16_f32 v195, v38, v39
    v_cvt_pk_bf16_f32 v196, v40, v41
    v_cvt_pk_bf16_f32 v197, v42, v43
    v_cvt_pk_bf16_f32 v198, v44, v45
    v_cvt_pk_bf16_f32 v199, v46, v47
    s_nop 3
    s_branch C_back8
C_rare9:
    s_nop 15
    v_mov_b32 v32, v48
    v_mov_b32 v33, v49
    v_mov_b32 v34, v50
    v_mov_b32 v35, v51
    v_mov_b32 v36, v52
    v_mov_b32 v37, v53
    v_mov_b32 v38, v54
    v_mov_b32 v39, v55
    v_mov_b32 v40, v56
    v_mov_b32 v41, v57
    v_mov_b32 v42, v58
    v_mov_b32 v43, v59
    v_mov_b32 v44, v60
    v_mov_b32 v45, v61
    v_mov_b32 v46, v62
    v_mov_b32 v47, v63
    s_call_b64 s[74:75], C_resc
    v_cvt_pk_bf16_f32 v200, v32, v33
    v_cvt_pk_bf16_f32 v201, v34, v35
    v_cvt_pk_bf16_f32 v202, v36, v37
    v_cvt_pk_bf16_f32 v203, v38, v39
    v_cvt_pk_bf16_f32 v204, v40, v41
    v_cvt_pk_bf16_f32 v205, v42, v43
    v_cvt_pk_bf16_f32 v206, v44, v45
    v_cvt_pk_bf16_f32 v207, v46, v47
    s_nop 3
    s_branch C_back9
C_rare10:
    s_nop 15
    v_mov_b32 v32, v64
    v_mov_b32 v33, v65
    v_mov_b32 v34, v66
    v_mov_b32 v35, v67
    v_mov_b32 v36, v68
    v_mov_b32 v37, v69
    v_mov_b32 v38, v70
    v_mov_b32 v39, v71
    v_mov_b32 v40, v72
    v_mov_b32 v41, v73
    v_mov_b32 v42, v74
    v_mov_b32 v43, v75
    v_mov_b32 v44, v76
    v_mov_b32 v45, v77
    v_mov_b32 v46, v78
    v_mov_b32 v47, v79
    s_call_b64 s[74:75], C_resc
    v_cvt_pk_bf16_f32 v208, v32, v33
    v_cvt_pk_bf16_f32 v209, v34, v35
    v_cvt_pk_bf16_f32 v210, v36, v37
    v_cvt_pk_bf16_f32 v211, v38, v39
    v_cvt_pk_bf16_f32 v212, v40, v41
    v_cvt_pk_bf16_f32 v213, v42, v43
    v_cvt_pk_bf16_f32 v214, v44, v45
    v_cvt_pk_bf16_f32 v215, v46, v47
    s_nop 3
    s_branch C_back10
C_rare11:
    s_nop 15
    v_mov_b32 v32, v80
    v_mov_b32 v33, v81
    v_mov_b32 v34, v82
    v_mov_b32 v35, v83
    v_mov_b32 v36, v84
    v_mov_b32 v37, v85
    v_mov_b32 v38, v86
    v_mov_b32 v39, v87
    v_mov_b32 v40, v88
    v_mov_b32 v41, v89
    v_mov_b32 v42, v90
    v_mov_b32 v43, v91
    v_mov_b32 v44, v92
    v_mov_b32 v45, v93
    v_mov_b32 v46, v94
    v_mov_b32 v47, v95
    s_call_b64 s[74:75], C_resc
    v_cvt_pk_bf16_f32 v216, v32, v33
    v_cvt_pk_bf16_f32 v217, v34, v35
    v_cvt_pk_bf16_f32 v218, v36, v37
    v_cvt_pk_bf16_f32 v219, v38, v39
    v_cvt_pk_bf16_f32 v220, v40, v41
    v_cvt_pk_bf16_f32 v221, v42, v43
    v_cvt_pk_bf16_f32 v222, v44, v45
    v_cvt_pk_bf16_f32 v223, v46, v47
    s_nop 3
    s_branch C_back11
C_rare12:
    s_nop 15
    v_mov_b32 v32, v48
    v_mov_b32 v33, v49
    v_mov_b32 v34, v50
    v_mov_b32 v35, v51
    v_mov_b32 v36, v52
    v_mov_b32 v37, v53
    v_mov_b32 v38, v54
    v_mov_b32 v39, v55
    v_mov_b32 v40, v56
    v_mov_b32 v41, v57
    v_mov_b32 v42, v58
    v_mov_b32 v43, v59
    v_mov_b32 v44, v60
    v_mov_b32 v45, v61
    v_mov_b32 v46, v62
    v_mov_b32 v47, v63
    s_call_b64 s[74:75], C_resc
    v_cvt_pk_bf16_f32 v224, v32, v33
    v_cvt_pk_bf16_f32 v225, v34, v35
    v_cvt_pk_bf16_f32 v226, v36, v37
    v_cvt_pk_bf16_f32 v227, v38, v39
    v_cvt_pk_bf16_f32 v228, v40, v41
    v_cvt_pk_bf16_f32 v229, v42, v43
    v_cvt_pk_bf16_f32 v230, v44, v45
    v_cvt_pk_bf16_f32 v231, v46, v47
    s_nop 3
    s_branch C_back12
C_rare13:
    s_nop 15
    v_mov_b32 v32, v64
    v_mov_b32 v33, v65
    v_mov_b32 v34, v66
    v_mov_b32 v35, v67
    v_mov_b32 v36, v68
    v_mov_b32 v37, v69
    v_mov_b32 v38, v70
    v_mov_b32 v39, v71
    v_mov_b32 v40, v72
    v_mov_b32 v41, v73
    v_mov_b32 v42, v74
    v_mov_b32 v43, v75
    v_mov_b32 v44, v76
    v_mov_b32 v45, v77
    v_mov_b32 v46, v78
    v_mov_b32 v47, v79
    s_call_b64 s[74:75], C_resc
    v_cvt_pk_bf16_f32 v232, v32, v33
    v_cvt_pk_bf16_f32 v233, v34, v35
    v_cvt_pk_bf16_f32 v234, v36, v37
    v_cvt_pk_bf16_f32 v235, v38, v39
    v_cvt_pk_bf16_f32 v236, v40, v41
    v_cvt_pk_bf16_f32 v237, v42, v43
    v_cvt_pk_bf16_f32 v238, v44, v45
    v_cvt_pk_bf16_f32 v239, v46, v47
    s_nop 3
    s_branch C_back13
C_rare14:
    s_nop 15
    v_mov_b32 v32, v80
    v_mov_b32 v33, v81
    v_mov_b32 v34, v82
    v_mov_b32 v35, v83
    v_mov_b32 v36, v84
    v_mov_b32 v37, v85
    v_mov_b32 v38, v86
    v_mov_b32 v39, v87
    v_mov_b32 v40, v88
    v_mov_b32 v41, v89
    v_mov_b32 v42, v90
    v_mov_b32 v43, v91
    v_mov_b32 v44, v92
    v_mov_b32 v45, v93
    v_mov_b32 v46, v94
    v_mov_b32 v47, v95
    s_call_b64 s[74:75], C_resc
    v_cvt_pk_bf16_f32 v240, v32, v33
    v_cvt_pk_bf16_f32 v241, v34, v35
    v_cvt_pk_bf16_f32 v242, v36, v37
    v_cvt_pk_bf16_f32 v243, v38, v39
    v_cvt_pk_bf16_f32 v244, v40, v41
    v_cvt_pk_bf16_f32 v245, v42, v43
    v_cvt_pk_bf16_f32 v246, v44, v45
    v_cvt_pk_bf16_f32 v247, v46, v47
    v_mul_f32 v64, v64, v31
    v_mul_f32 v65, v65, v31
    v_mul_f32 v66, v66, v31
    v_mul_f32 v67, v67, v31
    v_mul_f32 v68, v68, v31
    v_mul_f32 v69, v69, v31
    v_mul_f32 v70, v70, v31
    v_mul_f32 v71, v71, v31
    v_mul_f32 v72, v72, v31
    v_mul_f32 v73, v73, v31
    v_mul_f32 v74, v74, v31
    v_mul_f32 v75, v75, v31
    v_mul_f32 v76, v76, v31
    v_mul_f32 v77, v77, v31
    v_mul_f32 v78, v78, v31
    v_mul_f32 v79, v79, v31
    v_mul_f32 v96, v96, v31
    v_mul_f32 v97, v97, v31
    v_mul_f32 v98, v98, v31
    v_mul_f32 v99, v99, v31
    v_mul_f32 v100, v100, v31
    v_mul_f32 v101, v101, v31
    v_mul_f32 v102, v102, v31
    v_mul_f32 v103, v103, v31
    v_mul_f32 v104, v104, v31
    v_mul_f32 v105, v105, v31
    v_mul_f32 v106, v106, v31
    v_mul_f32 v107, v107, v31
    v_mul_f32 v108, v108, v31
    v_mul_f32 v109, v109, v31
    v_mul_f32 v110, v110, v31
    v_mul_f32 v111, v111, v31
    v_mul_f32 v112, v112, v31
    v_mul_f32 v113, v113, v31
    v_mul_f32 v114, v114, v31
    v_mul_f32 v115, v115, v31
    v_mul_f32 v116, v116, v31
    v_mul_f32 v117, v117, v31
    v_mul_f32 v118, v118, v31
    v_mul_f32 v119, v119, v31
    v_mul_f32 v120, v120, v31
    v_mul_f32 v121, v121, v31
    v_mul_f32 v122, v122, v31
    v_mul_f32 v123, v123, v31
    v_mul_f32 v124, v124, v31
    v_mul_f32 v125, v125, v31
    v_mul_f32 v126, v126, v31
    v_mul_f32 v127, v127, v31
    v_mul_f32 v80, v80, v31
    v_mul_f32 v81, v81, v31
    v_mul_f32 v82, v82, v31
    v_mul_f32 v83, v83, v31
    v_mul_f32 v84, v84, v31
    v_mul_f32 v85, v85, v31
    v_mul_f32 v86, v86, v31
    v_mul_f32 v87, v87, v31
    v_mul_f32 v88, v88, v31
    v_mul_f32 v89, v89, v31
    v_mul_f32 v90, v90, v31
    v_mul_f32 v91, v91, v31
    v_mul_f32 v92, v92, v31
    v_mul_f32 v93, v93, v31
    v_mul_f32 v94, v94, v31
    v_mul_f32 v95, v95, v31
    s_nop 3
    s_branch C_back14
C_rare15:
    s_nop 15
    v_mov_b32 v32, v48
    v_mov_b32 v33, v49
    v_mov_b32 v34, v50
    v_mov_b32 v35, v51
    v_mov_b32 v36, v52
    v_mov_b32 v37, v53
    v_mov_b32 v38, v54
    v_mov_b32 v39, v55
    v_mov_b32 v40, v56
    v_mov_b32 v41, v57
    v_mov_b32 v42, v58
    v_mov_b32 v43, v59
    v_mov_b32 v44, v60
    v_mov_b32 v45, v61
    v_mov_b32 v46, v62
    v_mov_b32 v47, v63
    s_call_b64 s[74:75], C_resc
    v_cvt_pk_bf16_f32 v248, v32, v33
    v_cvt_pk_bf16_f32 v249, v34, v35
    v_cvt_pk_bf16_f32 v250, v36, v37
    v_cvt_pk_bf16_f32 v251, v38, v39
    v_cvt_pk_bf16_f32 v252, v40, v41
    v_cvt_pk_bf16_f32 v253, v42, v43
    v_cvt_pk_bf16_f32 v254, v44, v45
    v_cvt_pk_bf16_f32 v255, v46, v47
    v_mul_f32 v64, v64, v31
    v_mul_f32 v65, v65, v31
    v_mul_f32 v66, v66, v31
    v_mul_f32 v67, v67, v31
    v_mul_f32 v68, v68, v31
    v_mul_f32 v69, v69, v31
    v_mul_f32 v70, v70, v31
    v_mul_f32 v71, v71, v31
    v_mul_f32 v72, v72, v31
    v_mul_f32 v73, v73, v31
    v_mul_f32 v74, v74, v31
    v_mul_f32 v75, v75, v31
    v_mul_f32 v76, v76, v31
    v_mul_f32 v77, v77, v31
    v_mul_f32 v78, v78, v31
    v_mul_f32 v79, v79, v31
    v_mul_f32 v96, v96, v31
    v_mul_f32 v97, v97, v31
    v_mul_f32 v98, v98, v31
    v_mul_f32 v99, v99, v31
    v_mul_f32 v100, v100, v31
    v_mul_f32 v101, v101, v31
    v_mul_f32 v102, v102, v31
    v_mul_f32 v103, v103, v31
    v_mul_f32 v104, v104, v31
    v_mul_f32 v105, v105, v31
    v_mul_f32 v106, v106, v31
    v_mul_f32 v107, v107, v31
    v_mul_f32 v108, v108, v31
    v_mul_f32 v109, v109, v31
    v_mul_f32 v110, v110, v31
    v_mul_f32 v111, v111, v31
    v_mul_f32 v112, v112, v31
    v_mul_f32 v113, v113, v31
    v_mul_f32 v114, v114, v31
    v_mul_f32 v115, v115, v31
    v_mul_f32 v116, v116, v31
    v_mul_f32 v117, v117, v31
    v_mul_f32 v118, v118, v31
    v_mul_f32 v119, v119, v31
    v_mul_f32 v120, v120, v31
    v_mul_f32 v121, v121, v31
    v_mul_f32 v122, v122, v31
    v_mul_f32 v123, v123, v31
    v_mul_f32 v124, v124, v31
    v_mul_f32 v125, v125, v31
    v_mul_f32 v126, v126, v31
    v_mul_f32 v127, v127, v31
    v_mul_f32 v80, v80, v31
    v_mul_f32 v81, v81, v31
    v_mul_f32 v82, v82, v31
    v_mul_f32 v83, v83, v31
    v_mul_f32 v84, v84, v31
    v_mul_f32 v85, v85, v31
    v_mul_f32 v86, v86, v31
    v_mul_f32 v87, v87, v31
    v_mul_f32 v88, v88, v31
    v_mul_f32 v89, v89, v31
    v_mul_f32 v90, v90, v31
    v_mul_f32 v91, v91, v31
    v_mul_f32 v92, v92, v31
    v_mul_f32 v93, v93, v31
    v_mul_f32 v94, v94, v31
    v_mul_f32 v95, v95, v31
    s_nop 3
    s_branch C_back15
C_resc:
    v_max3_f32 v30, v32, v33, v34
    v_max3_f32 v30, v35, v36, v30
    v_max3_f32 v30, v37, v38, v30
    v_max3_f32 v30, v39, v40, v30
    v_max3_f32 v30, v41, v42, v30
    v_max3_f32 v30, v43, v44, v30
    v_max3_f32 v30, v45, v46, v30
    v_max_f32 v30, v47, v30
    v_mov_b32 v31, v30
    s_nop 1
    v_permlane32_swap_b32 v30, v31
    s_nop 1
    v_max_f32 v30, v30, v31
    v_mul_f32 v30, s59, v30
    v_max_f32 v30, v30, v26
    v_sub_f32 v31, v26, v30
    v_exp_f32 v31, v31
    v_mov_b32 v26, v30
    v_mul_f32 v27, v27, v31
    v_lshlrev_b32 v30, 16, v128
    v_and_b32 v128, s57, v128
    v_mul_f32 v30, v30, v31
    v_mul_f32 v128, v128, v31
    v_cvt_pk_bf16_f32 v128, v30, v128
    v_lshlrev_b32 v30, 16, v129
    v_and_b32 v129, s57, v129
    v_mul_f32 v30, v30, v31
    v_mul_f32 v129, v129, v31
    v_cvt_pk_bf16_f32 v129, v30, v129
    v_lshlrev_b32 v30, 16, v130
    v_and_b32 v130, s57, v130
    v_mul_f32 v30, v30, v31
    v_mul_f32 v130, v130, v31
    v_cvt_pk_bf16_f32 v130, v30, v130
    v_lshlrev_b32 v30, 16, v131
    v_and_b32 v131, s57, v131
    v_mul_f32 v30, v30, v31
    v_mul_f32 v131, v131, v31
    v_cvt_pk_bf16_f32 v131, v30, v131
    v_lshlrev_b32 v30, 16, v132
    v_and_b32 v132, s57, v132
    v_mul_f32 v30, v30, v31
    v_mul_f32 v132, v132, v31
    v_cvt_pk_bf16_f32 v132, v30, v132
    v_lshlrev_b32 v30, 16, v133
    v_and_b32 v133, s57, v133
    v_mul_f32 v30, v30, v31
    v_mul_f32 v133, v133, v31
    v_cvt_pk_bf16_f32 v133, v30, v133
    v_lshlrev_b32 v30, 16, v134
    v_and_b32 v134, s57, v134
    v_mul_f32 v30, v30, v31
    v_mul_f32 v134, v134, v31
    v_cvt_pk_bf16_f32 v134, v30, v134
    v_lshlrev_b32 v30, 16, v135
    v_and_b32 v135, s57, v135
    v_mul_f32 v30, v30, v31
    v_mul_f32 v135, v135, v31
    v_cvt_pk_bf16_f32 v135, v30, v135
    v_lshlrev_b32 v30, 16, v136
    v_and_b32 v136, s57, v136
    v_mul_f32 v30, v30, v31
    v_mul_f32 v136, v136, v31
    v_cvt_pk_bf16_f32 v136, v30, v136
    v_lshlrev_b32 v30, 16, v137
    v_and_b32 v137, s57, v137
    v_mul_f32 v30, v30, v31
    v_mul_f32 v137, v137, v31
    v_cvt_pk_bf16_f32 v137, v30, v137
    v_lshlrev_b32 v30, 16, v138
    v_and_b32 v138, s57, v138
    v_mul_f32 v30, v30, v31
    v_mul_f32 v138, v138, v31
    v_cvt_pk_bf16_f32 v138, v30, v138
    v_lshlrev_b32 v30, 16, v139
    v_and_b32 v139, s57, v139
    v_mul_f32 v30, v30, v31
    v_mul_f32 v139, v139, v31
    v_cvt_pk_bf16_f32 v139, v30, v139
    v_lshlrev_b32 v30, 16, v140
    v_and_b32 v140, s57, v140
    v_mul_f32 v30, v30, v31
    v_mul_f32 v140, v140, v31
    v_cvt_pk_bf16_f32 v140, v30, v140
    v_lshlrev_b32 v30, 16, v141
    v_and_b32 v141, s57, v141
    v_mul_f32 v30, v30, v31
    v_mul_f32 v141, v141, v31
    v_cvt_pk_bf16_f32 v141, v30, v141
    v_lshlrev_b32 v30, 16, v142
    v_and_b32 v142, s57, v142
    v_mul_f32 v30, v30, v31
    v_mul_f32 v142, v142, v31
    v_cvt_pk_bf16_f32 v142, v30, v142
    v_lshlrev_b32 v30, 16, v143
    v_and_b32 v143, s57, v143
    v_mul_f32 v30, v30, v31
    v_mul_f32 v143, v143, v31
    v_cvt_pk_bf16_f32 v143, v30, v143
    v_lshlrev_b32 v30, 16, v144
    v_and_b32 v144, s57, v144
    v_mul_f32 v30, v30, v31
    v_mul_f32 v144, v144, v31
    v_cvt_pk_bf16_f32 v144, v30, v144
    v_lshlrev_b32 v30, 16, v145
    v_and_b32 v145, s57, v145
    v_mul_f32 v30, v30, v31
    v_mul_f32 v145, v145, v31
    v_cvt_pk_bf16_f32 v145, v30, v145
    v_lshlrev_b32 v30, 16, v146
    v_and_b32 v146, s57, v146
    v_mul_f32 v30, v30, v31
    v_mul_f32 v146, v146, v31
    v_cvt_pk_bf16_f32 v146, v30, v146
    v_lshlrev_b32 v30, 16, v147
    v_and_b32 v147, s57, v147
    v_mul_f32 v30, v30, v31
    v_mul_f32 v147, v147, v31
    v_cvt_pk_bf16_f32 v147, v30, v147
    v_lshlrev_b32 v30, 16, v148
    v_and_b32 v148, s57, v148
    v_mul_f32 v30, v30, v31
    v_mul_f32 v148, v148, v31
    v_cvt_pk_bf16_f32 v148, v30, v148
    v_lshlrev_b32 v30, 16, v149
    v_and_b32 v149, s57, v149
    v_mul_f32 v30, v30, v31
    v_mul_f32 v149, v149, v31
    v_cvt_pk_bf16_f32 v149, v30, v149
    v_lshlrev_b32 v30, 16, v150
    v_and_b32 v150, s57, v150
    v_mul_f32 v30, v30, v31
    v_mul_f32 v150, v150, v31
    v_cvt_pk_bf16_f32 v150, v30, v150
    v_lshlrev_b32 v30, 16, v151
    v_and_b32 v151, s57, v151
    v_mul_f32 v30, v30, v31
    v_mul_f32 v151, v151, v31
    v_cvt_pk_bf16_f32 v151, v30, v151
    v_lshlrev_b32 v30, 16, v152
    v_and_b32 v152, s57, v152
    v_mul_f32 v30, v30, v31
    v_mul_f32 v152, v152, v31
    v_cvt_pk_bf16_f32 v152, v30, v152
    v_lshlrev_b32 v30, 16, v153
    v_and_b32 v153, s57, v153
    v_mul_f32 v30, v30, v31
    v_mul_f32 v153, v153, v31
    v_cvt_pk_bf16_f32 v153, v30, v153
    v_lshlrev_b32 v30, 16, v154
    v_and_b32 v154, s57, v154
    v_mul_f32 v30, v30, v31
    v_mul_f32 v154, v154, v31
    v_cvt_pk_bf16_f32 v154, v30, v154
    v_lshlrev_b32 v30, 16, v155
    v_and_b32 v155, s57, v155
    v_mul_f32 v30, v30, v31
    v_mul_f32 v155, v155, v31
    v_cvt_pk_bf16_f32 v155, v30, v155
    v_lshlrev_b32 v30, 16, v156
    v_and_b32 v156, s57, v156
    v_mul_f32 v30, v30, v31
    v_mul_f32 v156, v156, v31
    v_cvt_pk_bf16_f32 v156, v30, v156
    v_lshlrev_b32 v30, 16, v157
    v_and_b32 v157, s57, v157
    v_mul_f32 v30, v30, v31
    v_mul_f32 v157, v157, v31
    v_cvt_pk_bf16_f32 v157, v30, v157
    v_lshlrev_b32 v30, 16, v158
    v_and_b32 v158, s57, v158
    v_mul_f32 v30, v30, v31
    v_mul_f32 v158, v158, v31
    v_cvt_pk_bf16_f32 v158, v30, v158
    v_lshlrev_b32 v30, 16, v159
    v_and_b32 v159, s57, v159
    v_mul_f32 v30, v30, v31
    v_mul_f32 v159, v159, v31
    v_cvt_pk_bf16_f32 v159, v30, v159
    v_lshlrev_b32 v30, 16, v160
    v_and_b32 v160, s57, v160
    v_mul_f32 v30, v30, v31
    v_mul_f32 v160, v160, v31
    v_cvt_pk_bf16_f32 v160, v30, v160
    v_lshlrev_b32 v30, 16, v161
    v_and_b32 v161, s57, v161
    v_mul_f32 v30, v30, v31
    v_mul_f32 v161, v161, v31
    v_cvt_pk_bf16_f32 v161, v30, v161
    v_lshlrev_b32 v30, 16, v162
    v_and_b32 v162, s57, v162
    v_mul_f32 v30, v30, v31
    v_mul_f32 v162, v162, v31
    v_cvt_pk_bf16_f32 v162, v30, v162
    v_lshlrev_b32 v30, 16, v163
    v_and_b32 v163, s57, v163
    v_mul_f32 v30, v30, v31
    v_mul_f32 v163, v163, v31
    v_cvt_pk_bf16_f32 v163, v30, v163
    v_lshlrev_b32 v30, 16, v164
    v_and_b32 v164, s57, v164
    v_mul_f32 v30, v30, v31
    v_mul_f32 v164, v164, v31
    v_cvt_pk_bf16_f32 v164, v30, v164
    v_lshlrev_b32 v30, 16, v165
    v_and_b32 v165, s57, v165
    v_mul_f32 v30, v30, v31
    v_mul_f32 v165, v165, v31
    v_cvt_pk_bf16_f32 v165, v30, v165
    v_lshlrev_b32 v30, 16, v166
    v_and_b32 v166, s57, v166
    v_mul_f32 v30, v30, v31
    v_mul_f32 v166, v166, v31
    v_cvt_pk_bf16_f32 v166, v30, v166
    v_lshlrev_b32 v30, 16, v167
    v_and_b32 v167, s57, v167
    v_mul_f32 v30, v30, v31
    v_mul_f32 v167, v167, v31
    v_cvt_pk_bf16_f32 v167, v30, v167
    v_lshlrev_b32 v30, 16, v168
    v_and_b32 v168, s57, v168
    v_mul_f32 v30, v30, v31
    v_mul_f32 v168, v168, v31
    v_cvt_pk_bf16_f32 v168, v30, v168
    v_lshlrev_b32 v30, 16, v169
    v_and_b32 v169, s57, v169
    v_mul_f32 v30, v30, v31
    v_mul_f32 v169, v169, v31
    v_cvt_pk_bf16_f32 v169, v30, v169
    v_lshlrev_b32 v30, 16, v170
    v_and_b32 v170, s57, v170
    v_mul_f32 v30, v30, v31
    v_mul_f32 v170, v170, v31
    v_cvt_pk_bf16_f32 v170, v30, v170
    v_lshlrev_b32 v30, 16, v171
    v_and_b32 v171, s57, v171
    v_mul_f32 v30, v30, v31
    v_mul_f32 v171, v171, v31
    v_cvt_pk_bf16_f32 v171, v30, v171
    v_lshlrev_b32 v30, 16, v172
    v_and_b32 v172, s57, v172
    v_mul_f32 v30, v30, v31
    v_mul_f32 v172, v172, v31
    v_cvt_pk_bf16_f32 v172, v30, v172
    v_lshlrev_b32 v30, 16, v173
    v_and_b32 v173, s57, v173
    v_mul_f32 v30, v30, v31
    v_mul_f32 v173, v173, v31
    v_cvt_pk_bf16_f32 v173, v30, v173
    v_lshlrev_b32 v30, 16, v174
    v_and_b32 v174, s57, v174
    v_mul_f32 v30, v30, v31
    v_mul_f32 v174, v174, v31
    v_cvt_pk_bf16_f32 v174, v30, v174
    v_lshlrev_b32 v30, 16, v175
    v_and_b32 v175, s57, v175
    v_mul_f32 v30, v30, v31
    v_mul_f32 v175, v175, v31
    v_cvt_pk_bf16_f32 v175, v30, v175
    v_lshlrev_b32 v30, 16, v176
    v_and_b32 v176, s57, v176
    v_mul_f32 v30, v30, v31
    v_mul_f32 v176, v176, v31
    v_cvt_pk_bf16_f32 v176, v30, v176
    v_lshlrev_b32 v30, 16, v177
    v_and_b32 v177, s57, v177
    v_mul_f32 v30, v30, v31
    v_mul_f32 v177, v177, v31
    v_cvt_pk_bf16_f32 v177, v30, v177
    v_lshlrev_b32 v30, 16, v178
    v_and_b32 v178, s57, v178
    v_mul_f32 v30, v30, v31
    v_mul_f32 v178, v178, v31
    v_cvt_pk_bf16_f32 v178, v30, v178
    v_lshlrev_b32 v30, 16, v179
    v_and_b32 v179, s57, v179
    v_mul_f32 v30, v30, v31
    v_mul_f32 v179, v179, v31
    v_cvt_pk_bf16_f32 v179, v30, v179
    v_lshlrev_b32 v30, 16, v180
    v_and_b32 v180, s57, v180
    v_mul_f32 v30, v30, v31
    v_mul_f32 v180, v180, v31
    v_cvt_pk_bf16_f32 v180, v30, v180
    v_lshlrev_b32 v30, 16, v181
    v_and_b32 v181, s57, v181
    v_mul_f32 v30, v30, v31
    v_mul_f32 v181, v181, v31
    v_cvt_pk_bf16_f32 v181, v30, v181
    v_lshlrev_b32 v30, 16, v182
    v_and_b32 v182, s57, v182
    v_mul_f32 v30, v30, v31
    v_mul_f32 v182, v182, v31
    v_cvt_pk_bf16_f32 v182, v30, v182
    v_lshlrev_b32 v30, 16, v183
    v_and_b32 v183, s57, v183
    v_mul_f32 v30, v30, v31
    v_mul_f32 v183, v183, v31
    v_cvt_pk_bf16_f32 v183, v30, v183
    v_lshlrev_b32 v30, 16, v184
    v_and_b32 v184, s57, v184
    v_mul_f32 v30, v30, v31
    v_mul_f32 v184, v184, v31
    v_cvt_pk_bf16_f32 v184, v30, v184
    v_lshlrev_b32 v30, 16, v185
    v_and_b32 v185, s57, v185
    v_mul_f32 v30, v30, v31
    v_mul_f32 v185, v185, v31
    v_cvt_pk_bf16_f32 v185, v30, v185
    v_lshlrev_b32 v30, 16, v186
    v_and_b32 v186, s57, v186
    v_mul_f32 v30, v30, v31
    v_mul_f32 v186, v186, v31
    v_cvt_pk_bf16_f32 v186, v30, v186
    v_lshlrev_b32 v30, 16, v187
    v_and_b32 v187, s57, v187
    v_mul_f32 v30, v30, v31
    v_mul_f32 v187, v187, v31
    v_cvt_pk_bf16_f32 v187, v30, v187
    v_lshlrev_b32 v30, 16, v188
    v_and_b32 v188, s57, v188
    v_mul_f32 v30, v30, v31
    v_mul_f32 v188, v188, v31
    v_cvt_pk_bf16_f32 v188, v30, v188
    v_lshlrev_b32 v30, 16, v189
    v_and_b32 v189, s57, v189
    v_mul_f32 v30, v30, v31
    v_mul_f32 v189, v189, v31
    v_cvt_pk_bf16_f32 v189, v30, v189
    v_lshlrev_b32 v30, 16, v190
    v_and_b32 v190, s57, v190
    v_mul_f32 v30, v30, v31
    v_mul_f32 v190, v190, v31
    v_cvt_pk_bf16_f32 v190, v30, v190
    v_lshlrev_b32 v30, 16, v191
    v_and_b32 v191, s57, v191
    v_mul_f32 v30, v30, v31
    v_mul_f32 v191, v191, v31
    v_cvt_pk_bf16_f32 v191, v30, v191
    v_lshlrev_b32 v30, 16, v192
    v_and_b32 v192, s57, v192
    v_mul_f32 v30, v30, v31
    v_mul_f32 v192, v192, v31
    v_cvt_pk_bf16_f32 v192, v30, v192
    v_lshlrev_b32 v30, 16, v193
    v_and_b32 v193, s57, v193
    v_mul_f32 v30, v30, v31
    v_mul_f32 v193, v193, v31
    v_cvt_pk_bf16_f32 v193, v30, v193
    v_lshlrev_b32 v30, 16, v194
    v_and_b32 v194, s57, v194
    v_mul_f32 v30, v30, v31
    v_mul_f32 v194, v194, v31
    v_cvt_pk_bf16_f32 v194, v30, v194
    v_lshlrev_b32 v30, 16, v195
    v_and_b32 v195, s57, v195
    v_mul_f32 v30, v30, v31
    v_mul_f32 v195, v195, v31
    v_cvt_pk_bf16_f32 v195, v30, v195
    v_lshlrev_b32 v30, 16, v196
    v_and_b32 v196, s57, v196
    v_mul_f32 v30, v30, v31
    v_mul_f32 v196, v196, v31
    v_cvt_pk_bf16_f32 v196, v30, v196
    v_lshlrev_b32 v30, 16, v197
    v_and_b32 v197, s57, v197
    v_mul_f32 v30, v30, v31
    v_mul_f32 v197, v197, v31
    v_cvt_pk_bf16_f32 v197, v30, v197
    v_lshlrev_b32 v30, 16, v198
    v_and_b32 v198, s57, v198
    v_mul_f32 v30, v30, v31
    v_mul_f32 v198, v198, v31
    v_cvt_pk_bf16_f32 v198, v30, v198
    v_lshlrev_b32 v30, 16, v199
    v_and_b32 v199, s57, v199
    v_mul_f32 v30, v30, v31
    v_mul_f32 v199, v199, v31
    v_cvt_pk_bf16_f32 v199, v30, v199
    v_lshlrev_b32 v30, 16, v200
    v_and_b32 v200, s57, v200
    v_mul_f32 v30, v30, v31
    v_mul_f32 v200, v200, v31
    v_cvt_pk_bf16_f32 v200, v30, v200
    v_lshlrev_b32 v30, 16, v201
    v_and_b32 v201, s57, v201
    v_mul_f32 v30, v30, v31
    v_mul_f32 v201, v201, v31
    v_cvt_pk_bf16_f32 v201, v30, v201
    v_lshlrev_b32 v30, 16, v202
    v_and_b32 v202, s57, v202
    v_mul_f32 v30, v30, v31
    v_mul_f32 v202, v202, v31
    v_cvt_pk_bf16_f32 v202, v30, v202
    v_lshlrev_b32 v30, 16, v203
    v_and_b32 v203, s57, v203
    v_mul_f32 v30, v30, v31
    v_mul_f32 v203, v203, v31
    v_cvt_pk_bf16_f32 v203, v30, v203
    v_lshlrev_b32 v30, 16, v204
    v_and_b32 v204, s57, v204
    v_mul_f32 v30, v30, v31
    v_mul_f32 v204, v204, v31
    v_cvt_pk_bf16_f32 v204, v30, v204
    v_lshlrev_b32 v30, 16, v205
    v_and_b32 v205, s57, v205
    v_mul_f32 v30, v30, v31
    v_mul_f32 v205, v205, v31
    v_cvt_pk_bf16_f32 v205, v30, v205
    v_lshlrev_b32 v30, 16, v206
    v_and_b32 v206, s57, v206
    v_mul_f32 v30, v30, v31
    v_mul_f32 v206, v206, v31
    v_cvt_pk_bf16_f32 v206, v30, v206
    v_lshlrev_b32 v30, 16, v207
    v_and_b32 v207, s57, v207
    v_mul_f32 v30, v30, v31
    v_mul_f32 v207, v207, v31
    v_cvt_pk_bf16_f32 v207, v30, v207
    v_lshlrev_b32 v30, 16, v208
    v_and_b32 v208, s57, v208
    v_mul_f32 v30, v30, v31
    v_mul_f32 v208, v208, v31
    v_cvt_pk_bf16_f32 v208, v30, v208
    v_lshlrev_b32 v30, 16, v209
    v_and_b32 v209, s57, v209
    v_mul_f32 v30, v30, v31
    v_mul_f32 v209, v209, v31
    v_cvt_pk_bf16_f32 v209, v30, v209
    v_lshlrev_b32 v30, 16, v210
    v_and_b32 v210, s57, v210
    v_mul_f32 v30, v30, v31
    v_mul_f32 v210, v210, v31
    v_cvt_pk_bf16_f32 v210, v30, v210
    v_lshlrev_b32 v30, 16, v211
    v_and_b32 v211, s57, v211
    v_mul_f32 v30, v30, v31
    v_mul_f32 v211, v211, v31
    v_cvt_pk_bf16_f32 v211, v30, v211
    v_lshlrev_b32 v30, 16, v212
    v_and_b32 v212, s57, v212
    v_mul_f32 v30, v30, v31
    v_mul_f32 v212, v212, v31
    v_cvt_pk_bf16_f32 v212, v30, v212
    v_lshlrev_b32 v30, 16, v213
    v_and_b32 v213, s57, v213
    v_mul_f32 v30, v30, v31
    v_mul_f32 v213, v213, v31
    v_cvt_pk_bf16_f32 v213, v30, v213
    v_lshlrev_b32 v30, 16, v214
    v_and_b32 v214, s57, v214
    v_mul_f32 v30, v30, v31
    v_mul_f32 v214, v214, v31
    v_cvt_pk_bf16_f32 v214, v30, v214
    v_lshlrev_b32 v30, 16, v215
    v_and_b32 v215, s57, v215
    v_mul_f32 v30, v30, v31
    v_mul_f32 v215, v215, v31
    v_cvt_pk_bf16_f32 v215, v30, v215
    v_lshlrev_b32 v30, 16, v216
    v_and_b32 v216, s57, v216
    v_mul_f32 v30, v30, v31
    v_mul_f32 v216, v216, v31
    v_cvt_pk_bf16_f32 v216, v30, v216
    v_lshlrev_b32 v30, 16, v217
    v_and_b32 v217, s57, v217
    v_mul_f32 v30, v30, v31
    v_mul_f32 v217, v217, v31
    v_cvt_pk_bf16_f32 v217, v30, v217
    v_lshlrev_b32 v30, 16, v218
    v_and_b32 v218, s57, v218
    v_mul_f32 v30, v30, v31
    v_mul_f32 v218, v218, v31
    v_cvt_pk_bf16_f32 v218, v30, v218
    v_lshlrev_b32 v30, 16, v219
    v_and_b32 v219, s57, v219
    v_mul_f32 v30, v30, v31
    v_mul_f32 v219, v219, v31
    v_cvt_pk_bf16_f32 v219, v30, v219
    v_lshlrev_b32 v30, 16, v220
    v_and_b32 v220, s57, v220
    v_mul_f32 v30, v30, v31
    v_mul_f32 v220, v220, v31
    v_cvt_pk_bf16_f32 v220, v30, v220
    v_lshlrev_b32 v30, 16, v221
    v_and_b32 v221, s57, v221
    v_mul_f32 v30, v30, v31
    v_mul_f32 v221, v221, v31
    v_cvt_pk_bf16_f32 v221, v30, v221
    v_lshlrev_b32 v30, 16, v222
    v_and_b32 v222, s57, v222
    v_mul_f32 v30, v30, v31
    v_mul_f32 v222, v222, v31
    v_cvt_pk_bf16_f32 v222, v30, v222
    v_lshlrev_b32 v30, 16, v223
    v_and_b32 v223, s57, v223
    v_mul_f32 v30, v30, v31
    v_mul_f32 v223, v223, v31
    v_cvt_pk_bf16_f32 v223, v30, v223
    v_lshlrev_b32 v30, 16, v224
    v_and_b32 v224, s57, v224
    v_mul_f32 v30, v30, v31
    v_mul_f32 v224, v224, v31
    v_cvt_pk_bf16_f32 v224, v30, v224
    v_lshlrev_b32 v30, 16, v225
    v_and_b32 v225, s57, v225
    v_mul_f32 v30, v30, v31
    v_mul_f32 v225, v225, v31
    v_cvt_pk_bf16_f32 v225, v30, v225
    v_lshlrev_b32 v30, 16, v226
    v_and_b32 v226, s57, v226
    v_mul_f32 v30, v30, v31
    v_mul_f32 v226, v226, v31
    v_cvt_pk_bf16_f32 v226, v30, v226
    v_lshlrev_b32 v30, 16, v227
    v_and_b32 v227, s57, v227
    v_mul_f32 v30, v30, v31
    v_mul_f32 v227, v227, v31
    v_cvt_pk_bf16_f32 v227, v30, v227
    v_lshlrev_b32 v30, 16, v228
    v_and_b32 v228, s57, v228
    v_mul_f32 v30, v30, v31
    v_mul_f32 v228, v228, v31
    v_cvt_pk_bf16_f32 v228, v30, v228
    v_lshlrev_b32 v30, 16, v229
    v_and_b32 v229, s57, v229
    v_mul_f32 v30, v30, v31
    v_mul_f32 v229, v229, v31
    v_cvt_pk_bf16_f32 v229, v30, v229
    v_lshlrev_b32 v30, 16, v230
    v_and_b32 v230, s57, v230
    v_mul_f32 v30, v30, v31
    v_mul_f32 v230, v230, v31
    v_cvt_pk_bf16_f32 v230, v30, v230
    v_lshlrev_b32 v30, 16, v231
    v_and_b32 v231, s57, v231
    v_mul_f32 v30, v30, v31
    v_mul_f32 v231, v231, v31
    v_cvt_pk_bf16_f32 v231, v30, v231
    v_lshlrev_b32 v30, 16, v232
    v_and_b32 v232, s57, v232
    v_mul_f32 v30, v30, v31
    v_mul_f32 v232, v232, v31
    v_cvt_pk_bf16_f32 v232, v30, v232
    v_lshlrev_b32 v30, 16, v233
    v_and_b32 v233, s57, v233
    v_mul_f32 v30, v30, v31
    v_mul_f32 v233, v233, v31
    v_cvt_pk_bf16_f32 v233, v30, v233
    v_lshlrev_b32 v30, 16, v234
    v_and_b32 v234, s57, v234
    v_mul_f32 v30, v30, v31
    v_mul_f32 v234, v234, v31
    v_cvt_pk_bf16_f32 v234, v30, v234
    v_lshlrev_b32 v30, 16, v235
    v_and_b32 v235, s57, v235
    v_mul_f32 v30, v30, v31
    v_mul_f32 v235, v235, v31
    v_cvt_pk_bf16_f32 v235, v30, v235
    v_lshlrev_b32 v30, 16, v236
    v_and_b32 v236, s57, v236
    v_mul_f32 v30, v30, v31
    v_mul_f32 v236, v236, v31
    v_cvt_pk_bf16_f32 v236, v30, v236
    v_lshlrev_b32 v30, 16, v237
    v_and_b32 v237, s57, v237
    v_mul_f32 v30, v30, v31
    v_mul_f32 v237, v237, v31
    v_cvt_pk_bf16_f32 v237, v30, v237
    v_lshlrev_b32 v30, 16, v238
    v_and_b32 v238, s57, v238
    v_mul_f32 v30, v30, v31
    v_mul_f32 v238, v238, v31
    v_cvt_pk_bf16_f32 v238, v30, v238
    v_lshlrev_b32 v30, 16, v239
    v_and_b32 v239, s57, v239
    v_mul_f32 v30, v30, v31
    v_mul_f32 v239, v239, v31
    v_cvt_pk_bf16_f32 v239, v30, v239
    v_lshlrev_b32 v30, 16, v240
    v_and_b32 v240, s57, v240
    v_mul_f32 v30, v30, v31
    v_mul_f32 v240, v240, v31
    v_cvt_pk_bf16_f32 v240, v30, v240
    v_lshlrev_b32 v30, 16, v241
    v_and_b32 v241, s57, v241
    v_mul_f32 v30, v30, v31
    v_mul_f32 v241, v241, v31
    v_cvt_pk_bf16_f32 v241, v30, v241
    v_lshlrev_b32 v30, 16, v242
    v_and_b32 v242, s57, v242
    v_mul_f32 v30, v30, v31
    v_mul_f32 v242, v242, v31
    v_cvt_pk_bf16_f32 v242, v30, v242
    v_lshlrev_b32 v30, 16, v243
    v_and_b32 v243, s57, v243
    v_mul_f32 v30, v30, v31
    v_mul_f32 v243, v243, v31
    v_cvt_pk_bf16_f32 v243, v30, v243
    v_lshlrev_b32 v30, 16, v244
    v_and_b32 v244, s57, v244
    v_mul_f32 v30, v30, v31
    v_mul_f32 v244, v244, v31
    v_cvt_pk_bf16_f32 v244, v30, v244
    v_lshlrev_b32 v30, 16, v245
    v_and_b32 v245, s57, v245
    v_mul_f32 v30, v30, v31
    v_mul_f32 v245, v245, v31
    v_cvt_pk_bf16_f32 v245, v30, v245
    v_lshlrev_b32 v30, 16, v246
    v_and_b32 v246, s57, v246
    v_mul_f32 v30, v30, v31
    v_mul_f32 v246, v246, v31
    v_cvt_pk_bf16_f32 v246, v30, v246
    v_lshlrev_b32 v30, 16, v247
    v_and_b32 v247, s57, v247
    v_mul_f32 v30, v30, v31
    v_mul_f32 v247, v247, v31
    v_cvt_pk_bf16_f32 v247, v30, v247
    v_lshlrev_b32 v30, 16, v248
    v_and_b32 v248, s57, v248
    v_mul_f32 v30, v30, v31
    v_mul_f32 v248, v248, v31
    v_cvt_pk_bf16_f32 v248, v30, v248
    v_lshlrev_b32 v30, 16, v249
    v_and_b32 v249, s57, v249
    v_mul_f32 v30, v30, v31
    v_mul_f32 v249, v249, v31
    v_cvt_pk_bf16_f32 v249, v30, v249
    v_lshlrev_b32 v30, 16, v250
    v_and_b32 v250, s57, v250
    v_mul_f32 v30, v30, v31
    v_mul_f32 v250, v250, v31
    v_cvt_pk_bf16_f32 v250, v30, v250
    v_lshlrev_b32 v30, 16, v251
    v_and_b32 v251, s57, v251
    v_mul_f32 v30, v30, v31
    v_mul_f32 v251, v251, v31
    v_cvt_pk_bf16_f32 v251, v30, v251
    v_lshlrev_b32 v30, 16, v252
    v_and_b32 v252, s57, v252
    v_mul_f32 v30, v30, v31
    v_mul_f32 v252, v252, v31
    v_cvt_pk_bf16_f32 v252, v30, v252
    v_lshlrev_b32 v30, 16, v253
    v_and_b32 v253, s57, v253
    v_mul_f32 v30, v30, v31
    v_mul_f32 v253, v253, v31
    v_cvt_pk_bf16_f32 v253, v30, v253
    v_lshlrev_b32 v30, 16, v254
    v_and_b32 v254, s57, v254
    v_mul_f32 v30, v30, v31
    v_mul_f32 v254, v254, v31
    v_cvt_pk_bf16_f32 v254, v30, v254
    v_lshlrev_b32 v30, 16, v255
    v_and_b32 v255, s57, v255
    v_mul_f32 v30, v30, v31
    v_mul_f32 v255, v255, v31
    v_cvt_pk_bf16_f32 v255, v30, v255
    v_fma_f32 v32, v32, s59, -v26
    v_fma_f32 v33, v33, s59, -v26
    v_fma_f32 v34, v34, s59, -v26
    v_fma_f32 v35, v35, s59, -v26
    v_fma_f32 v36, v36, s59, -v26
    v_fma_f32 v37, v37, s59, -v26
    v_fma_f32 v38, v38, s59, -v26
    v_fma_f32 v39, v39, s59, -v26
    v_fma_f32 v40, v40, s59, -v26
    v_fma_f32 v41, v41, s59, -v26
    v_fma_f32 v42, v42, s59, -v26
    v_fma_f32 v43, v43, s59, -v26
    v_fma_f32 v44, v44, s59, -v26
    v_fma_f32 v45, v45, s59, -v26
    v_fma_f32 v46, v46, s59, -v26
    v_fma_f32 v47, v47, s59, -v26
    v_exp_f32 v32, v32
    v_exp_f32 v33, v33
    v_exp_f32 v34, v34
    v_exp_f32 v35, v35
    v_exp_f32 v36, v36
    v_exp_f32 v37, v37
    v_exp_f32 v38, v38
    v_exp_f32 v39, v39
    v_exp_f32 v40, v40
    v_exp_f32 v41, v41
    v_exp_f32 v42, v42
    v_exp_f32 v43, v43
    v_exp_f32 v44, v44
    v_exp_f32 v45, v45
    v_exp_f32 v46, v46
    v_exp_f32 v47, v47
    s_nop 0
    v_add_f32 v28, v32, v33
    v_add_f32 v28, v28, v34
    v_add_f32 v28, v28, v35
    v_add_f32 v28, v28, v36
    v_add_f32 v28, v28, v37
    v_add_f32 v28, v28, v38
    v_add_f32 v28, v28, v39
    v_add_f32 v28, v28, v40
    v_add_f32 v28, v28, v41
    v_add_f32 v28, v28, v42
    v_add_f32 v28, v28, v43
    v_add_f32 v28, v28, v44
    v_add_f32 v28, v28, v45
    v_add_f32 v28, v28, v46
    v_add_f32 v28, v28, v47
    s_setpc_b64 s[74:75]
C_gs1:
    buffer_wbl2 sc1
    s_waitcnt vmcnt(0)
    buffer_store_dword v1, v0, s[36:39], s50 offen sc1
    s_branch C_gb1
C_asx1:
    buffer_inv sc1
    s_waitcnt vmcnt(0)
    s_branch C_abx1
C_gs2:
    buffer_wbl2 sc1
    s_waitcnt vmcnt(0)
    buffer_store_dword v1, v0, s[36:39], s50 offen sc1
    s_branch C_gb2
C_asx2:
    buffer_inv sc1
    s_waitcnt vmcnt(0)
    s_branch C_abx2
C_r2:
    v_xor_b32 v96, s61, v96
    v_xor_b32 v97, s61, v97
    v_xor_b32 v98, s61, v98
    v_xor_b32 v99, s61, v99
    v_xor_b32 v100, s61, v100
    v_xor_b32 v101, s61, v101
    v_xor_b32 v102, s61, v102
    v_xor_b32 v103, s61, v103
    v_xor_b32 v104, s61, v104
    v_xor_b32 v105, s61, v105
    v_xor_b32 v106, s61, v106
    v_xor_b32 v107, s61, v107
    v_xor_b32 v108, s61, v108
    v_xor_b32 v109, s61, v109
    v_xor_b32 v110, s61, v110
    v_xor_b32 v111, s61, v111
    v_xor_b32 v112, s61, v112
    v_xor_b32 v113, s61, v113
    v_xor_b32 v114, s61, v114
    v_xor_b32 v115, s61, v115
    v_xor_b32 v116, s61, v116
    v_xor_b32 v117, s61, v117
    v_xor_b32 v118, s61, v118
    v_xor_b32 v119, s61, v119
    v_xor_b32 v120, s61, v120
    v_xor_b32 v121, s61, v121
    v_xor_b32 v122, s61, v122
    v_xor_b32 v123, s61, v123
    v_xor_b32 v124, s61, v124
    v_xor_b32 v125, s61, v125
    v_xor_b32 v126, s61, v126
    v_xor_b32 v127, s61, v127
    v_min_u32 v48, v96, v97
    v_min3_u32 v48, v98, v99, v48
    v_min3_u32 v48, v100, v101, v48
    v_min3_u32 v48, v102, v103, v48
    v_min3_u32 v48, v104, v105, v48
    v_min3_u32 v48, v106, v107, v48
    v_min3_u32 v48, v108, v109, v48
    v_min3_u32 v48, v110, v111, v48
    v_min3_u32 v48, v112, v113, v48
    v_min3_u32 v48, v114, v115, v48
    v_min3_u32 v48, v116, v117, v48
    v_min3_u32 v48, v118, v119, v48
    v_min3_u32 v48, v120, v121, v48
    v_min3_u32 v48, v122, v123, v48
    v_min3_u32 v48, v124, v125, v48
    v_min3_u32 v48, v126, v127, v48
    v_cmp_eq_u32 vcc, 0, v48
    s_sub_u32 s73, s73, 8
    s_cbranch_scc1 C_r1
    s_cbranch_vccz C_r1
    s_branch C_r0
CODE_END:
.section .rodata,"a"
.p2align 6
.amdhsa_kernel standalone__gqa_block_cached__near_ridge_kernel
.amdhsa_next_free_vgpr 512
.amdhsa_next_free_sgpr 102
.amdhsa_accum_offset 256
.amdhsa_group_segment_fixed_size 0
.amdhsa_kernarg_size 64
.amdhsa_user_sgpr_count 2
.amdhsa_user_sgpr_kernarg_segment_ptr 1
.amdhsa_system_sgpr_workgroup_id_x 1
.end_amdhsa_kernel
```
